```python
import torch

def _softmax(x, axis=-1):
    return torch.softmax(x, dim=axis)
def _gelu(x):
    return torch.nn.functional.gelu(x, approximate="tanh")
def _silu(x):
    return torch.nn.functional.silu(x)
def _sigmoid(x):
    return torch.sigmoid(x)
def _layernorm(x, axis=-1, eps=1e-5):
    m = x.mean(dim=axis, keepdim=True)
    v = x.var(dim=axis, keepdim=True, unbiased=False)
    return (x - m) / torch.sqrt(v + eps)
def _scatter_add(tgt, idx, src, axis=0):
    return tgt.clone().index_add_(axis, idx, src)
def _segment_sum(src, seg, n):
    out = torch.zeros((n,) + src.shape[1:], dtype=src.dtype)
    return out.index_add_(0, seg, src)
def _pad(x, pw):
    flat = tuple(v for pair in reversed(pw) for v in pair)
    return torch.nn.functional.pad(x, flat)

kernel_name = 'sequential_preLN__spectral_gfnet__glu_gated_glu__prompt'

def setup_inputs():

    _w = (lambda a: (lambda t: t.to(torch.bfloat16) if t.is_floating_point() else t)(torch.as_tensor(a)))
    def _A_setup():
        B, S, D = 1, 2048, 576
        Df = D // 2 + 1
        return {
            "x": _w((lambda *s: torch.randn(*s, dtype=torch.bfloat16) * 0.05)(B, S, D)),
            "w_r": _w((lambda *s: torch.randn(*s, dtype=torch.bfloat16) * 0.4)(S, Df) * 0.02),
            "w_i": _w((lambda *s: torch.randn(*s, dtype=torch.bfloat16) * 0.4)(S, Df) * 0.02),
        }
    _A_in = _A_setup()

    def _B_setup():
        B, S, D, F = 1, 2048, 576, 4608
        return {
            "x": _w((lambda *s: torch.randn(*s, dtype=torch.bfloat16) * 0.05)(B, S, D)),
            "w_gate": _w((lambda *s: torch.randn(*s, dtype=torch.bfloat16) * 0.05)(D, F)),
            "w_up": _w((lambda *s: torch.randn(*s, dtype=torch.bfloat16) * 0.05)(D, F)),
            "w_down": _w((lambda *s: torch.randn(*s, dtype=torch.bfloat16) * 0.05)(F, D)),
        }
    _B_in = _B_setup()

    return {
        "A_x": _A_in["x"],
        "A_w_r": _A_in["w_r"],
        "A_w_i": _A_in["w_i"],
        "B_x": _B_in["x"],
        "B_w_gate": _B_in["w_gate"],
        "B_w_up": _B_in["w_up"],
        "B_w_down": _B_in["w_down"],
    }

def reference(A_x, A_w_r, A_w_i, B_x, B_w_gate, B_w_up, B_w_down):
    def _A_ref(x, w_r, w_i):
        B, S, D = x.shape
        X = (lambda x, axes=(-2,-1): torch.fft.rfft2(x.float(), dim=axes))(x, axes=(-2, -1))
        W = w_r + 1j * w_i
        X = X * W
        y = (lambda x, s, axes=(-2,-1): torch.fft.irfft2(x, s=s, dim=axes).to(torch.bfloat16))(X, (S, D), axes=(-2, -1))
        return y

    def _B_ref(x, w_gate, w_up, w_down):
        g = torch.einsum("bsd,df->bsf", x, w_gate)
        u = torch.einsum("bsd,df->bsf", x, w_up)
        h = _sigmoid(g) * u
        return torch.einsum("bsf,fd->bsd", h, w_down)

    x = A_x
    h = x + _A_ref(_layernorm(x, axis=-1), A_w_r, A_w_i)
    h2 = h + _B_ref(_layernorm(h, axis=-1), B_w_gate, B_w_up, B_w_down)
    return h2
```

```asm
; @launch kernel=p1_kernel grid=(256,1,1) block=(512,1,1) lds=84544
; @launch kernel=pf_kernel grid=(256,1,1) block=(512,1,1) lds=163840
.amdgcn_target "amdgcn-amd-amdhsa--gfx950"
.text
.globl p1_kernel
.p2align 8
.type p1_kernel,@function
p1_kernel:
s_setprio 3
s_load_dwordx4 s[44:47], s[0:1], 0
s_load_dwordx2 s[48:49], s[0:1], 16
s_load_dwordx2 s[6:7], s[0:1], 72
s_cmp_ge_u32 s2, 256
s_cbranch_scc1 p1_end
v_lshrrev_b32 v1, 6, v0
v_and_b32 v0, 63, v0
v_readfirstlane_b32 s3, v1
v_lshrrev_b32 v2, 4, v0
v_and_b32 v3, 15, v0
s_and_b32 s30, s3, 3
s_lshr_b32 s50, s3, 2
s_lshr_b32 s51, s2, 6
s_and_b32 s31, s2, 63
s_lshl_b32 s32, s51, 1
s_add_u32 s32, s32, s50
s_lshl_b32 s2, s32, 6
s_add_u32 s2, s2, s31
s_cmp_ge_u32 s32, 5
s_cbranch_scc1 p1_side
v_lshrrev_b32 v4, 3, v0
v_and_b32 v5, 7, v0
s_lshl_b32 s3, s30, 9
s_add_u32 s3, s3, s31
v_lshl_add_u32 v6, v4, 6, s3
v_mul_u32_u24 v6, 1152, v6
v_lshlrev_b32 v4, 1, v4
v_and_b32 v4, 4, v4
v_xor_b32 v5, v5, v4
v_lshl_add_u32 v6, v5, 4, v6
s_mul_i32 s34, s30, 9216
s_waitcnt lgkmcnt(0)
s_mov_b32 s8, s44
s_mov_b32 s9, s45
s_mov_b32 s10, 2359296
s_mov_b32 s11, 0x20000
s_cmp_lg_u32 s50, 0
s_cbranch_scc1 p1_x2
s_add_u32 m0, s34, 0
s_nop 0
buffer_load_dwordx4 v6, s[8:11], 0 offen offset:0  lds
s_add_u32 m0, s34, 896
s_nop 0
buffer_load_dwordx4 v6, s[8:11], 0 offen offset:128  lds
s_add_u32 m0, s34, 1792
s_nop 0
buffer_load_dwordx4 v6, s[8:11], 0 offen offset:256  lds
s_add_u32 m0, s34, 2688
s_nop 0
buffer_load_dwordx4 v6, s[8:11], 0 offen offset:384  lds
s_add_u32 m0, s34, 3584
s_nop 0
buffer_load_dwordx4 v6, s[8:11], 0 offen offset:512  lds
s_cmp_lg_u32 s51, 2
s_cbranch_scc1 p1_x3
p1_x2:
s_add_u32 m0, s34, 4480
s_nop 0
buffer_load_dwordx4 v6, s[8:11], 0 offen offset:640  lds
s_add_u32 m0, s34, 5376
s_nop 0
buffer_load_dwordx4 v6, s[8:11], 0 offen offset:768  lds
s_add_u32 m0, s34, 6272
s_nop 0
buffer_load_dwordx4 v6, s[8:11], 0 offen offset:896  lds
s_add_u32 m0, s34, 7168
s_nop 0
buffer_load_dwordx4 v6, s[8:11], 0 offen offset:1024  lds
p1_x3:
s_setprio 0
s_add_u32 s12, s6, 0
s_addc_u32 s13, s7, 0
s_mov_b32 s14, 2621440
s_mov_b32 s15, 0x20000
v_and_b32 v7, 3, v0
v_lshrrev_b32 v9, 2, v0
v_lshlrev_b32 v9, 3, v9
v_lshlrev_b32 v4, 5, v7
v_and_b32 v4, 64, v4
v_lshl_add_u32 v7, v7, 7, s34
v_xor_b32 v8, v9, v4
v_add_u32 v8, v8, v7
v_xor_b32 v5, 64, v8
v_lshrrev_b32 v4, 1, v2
v_lshl_add_u32 v5, v4, 10, v5
v_lshl_add_u32 v7, v4, 12, v8
s_lshl_b32 s3, s32, 4
v_add_u32 v13, s3, v3
v_cvt_f32_u32 v9, v13
v_lshlrev_b32 v11, 4, v0
s_mul_i32 s3, s50, 14336
s_add_u32 s3, s3, 36864
v_add_u32 v11, s3, v11
s_lshr_b32 s3, s30, 1
s_lshl_b32 s3, s3, 10
s_and_b32 s4, s30, 1
s_lshl_b32 s4, s4, 3
s_add_u32 s3, s3, s4
v_add_u32 v10, s3, v11
s_lshl_b32 s3, s30, 9
s_add_u32 s3, s3, s31
v_lshl_add_u32 v12, v2, 7, s3
v_mul_u32_u24 v12, 1280, v12
v_lshl_add_u32 v12, v13, 4, v12
v_cvt_f32_u32 v14, v2
v_mul_f32 v15, 0x3be38e39, v9
v_mul_f32 v14, 4.0, v14
v_mul_f32 v16, v14, v15
v_lshlrev_b32 v17, 31, v13
v_lshrrev_b32 v18, 16, v17
v_or_b32 v17, v17, v18
v_lshrrev_b32 v18, 1, v2
v_cvt_f32_u32 v18, v18
v_mul_f32 v18, 0x42800000, v18
v_fma_f32 v18, v18, v15, v16
s_lshl_b32 s3, s30, 1
s_cmp_ge_u32 s30, 2
s_cselect_b32 s4, 12, 0
s_add_u32 s4, s4, s3
v_cvt_f32_u32 v19, s4
v_fma_f32 v16, v19, v15, v16
s_and_b32 s3, s3, 2
v_cvt_f32_u32 v19, s3
v_fma_f32 v18, v19, v15, v18
s_lshl_b32 s4, s30, 2
v_add_u32 v19, s4, v11
s_lshl_b32 s3, s3, 1
v_add_u32 v1, s3, v11
v_fmamk_f32 v132, v15, 0x00000000, v16
v_add_f32 v133, v132, v15
v_cos_f32 v134, v132
v_cos_f32 v135, v133
v_sin_f32 v132, v132
v_sin_f32 v133, v133
v_cvt_pk_bf16_f32 v28, v134, v135
v_cvt_pk_bf16_f32 v46, -v132, -v133
ds_write_b32 v19, v28 offset:8192
ds_write_b32 v19, v46 offset:9216
v_fmamk_f32 v132, v15, 0x42000000, v16
v_add_f32 v133, v132, v15
v_cos_f32 v134, v132
v_cos_f32 v135, v133
v_sin_f32 v132, v132
v_sin_f32 v133, v133
v_cvt_pk_bf16_f32 v29, v134, v135
v_cvt_pk_bf16_f32 v47, -v132, -v133
ds_write_b32 v19, v29 offset:10240
ds_write_b32 v19, v47 offset:11264
v_fmamk_f32 v132, v15, 0x42800000, v18
v_add_f32 v133, v132, v15
v_cos_f32 v134, v132
v_cos_f32 v135, v133
v_sin_f32 v132, v132
v_sin_f32 v133, v133
v_cvt_pk_bf16_f32 v30, v134, v135
v_cvt_pk_bf16_f32 v48, -v132, -v133
ds_write_b32 v1, v30 offset:12288
ds_write_b32 v1, v48 offset:13312
v_mov_b32 v124, 1.0
v_mov_b32 v128, 0
v_mul_f32 v132, 0x3ae38e39, v9
v_cos_f32 v125, v132
v_sin_f32 v129, v132
v_mul_f32 v132, 0x3b638e39, v9
v_cos_f32 v126, v132
v_sin_f32 v130, v132
v_mul_f32 v132, 0x3baaaaab, v9
v_cos_f32 v127, v132
v_sin_f32 v131, v132
v_lshrrev_b32 v14, 1, v3
s_lshl_b32 s3, s30, 3
v_add_u32 v14, s3, v14
v_lshl_add_u32 v15, v2, 6, s31
v_mul_u32_u24 v15, v14, v15
v_and_b32 v16, 1, v3
v_lshl_add_u32 v15, v16, 9, v15
v_cvt_f32_u32 v15, v15
v_mul_f32 v15, 0x3a000000, v15
v_cvt_f32_u32 v14, v14
v_fmamk_f32 v132, v14, 0x00000000, v15
v_cos_f32 v133, v132
v_sin_f32 v132, v132
s_nop 0
v_cvt_pk_bf16_f32 v116, v133, v132
v_fmamk_f32 v132, v14, 0x3e000000, v15
v_cos_f32 v133, v132
v_sin_f32 v132, v132
s_nop 0
v_cvt_pk_bf16_f32 v117, v133, v132
v_fmamk_f32 v132, v14, 0x3e800000, v15
v_cos_f32 v133, v132
v_sin_f32 v132, v132
s_nop 0
v_cvt_pk_bf16_f32 v118, v133, v132
v_fmamk_f32 v132, v14, 0x3ec00000, v15
v_cos_f32 v133, v132
v_sin_f32 v132, v132
s_nop 0
v_cvt_pk_bf16_f32 v119, v133, v132
v_fmamk_f32 v132, v14, 0x3f000000, v15
v_cos_f32 v133, v132
v_sin_f32 v132, v132
s_nop 0
v_cvt_pk_bf16_f32 v120, v133, v132
v_fmamk_f32 v132, v14, 0x3f200000, v15
v_cos_f32 v133, v132
v_sin_f32 v132, v132
s_nop 0
v_cvt_pk_bf16_f32 v121, v133, v132
v_fmamk_f32 v132, v14, 0x3f400000, v15
v_cos_f32 v133, v132
v_sin_f32 v132, v132
s_nop 0
v_cvt_pk_bf16_f32 v122, v133, v132
v_fmamk_f32 v132, v14, 0x3f600000, v15
v_cos_f32 v133, v132
v_sin_f32 v132, v132
s_nop 0
v_cvt_pk_bf16_f32 v123, v133, v132
s_waitcnt lgkmcnt(0)
s_barrier
ds_read_b128 v[28:31], v11 offset:8192
ds_read_b128 v[32:35], v11 offset:10240
ds_read_b64 v[44:45], v11 offset:12288
ds_read_b128 v[46:49], v11 offset:9216
ds_read_b128 v[50:53], v11 offset:11264
ds_read_b64 v[62:63], v11 offset:13312
s_waitcnt lgkmcnt(5)
v_xor_b32 v36, v17, v28
v_xor_b32 v37, v17, v29
v_xor_b32 v38, v17, v30
v_xor_b32 v39, v17, v31
s_waitcnt lgkmcnt(4)
v_xor_b32 v40, v17, v32
v_xor_b32 v41, v17, v33
v_xor_b32 v42, v17, v34
v_xor_b32 v43, v17, v35
s_waitcnt lgkmcnt(2)
v_xor_b32 v54, v17, v46
v_xor_b32 v55, v17, v47
v_xor_b32 v56, v17, v48
v_xor_b32 v57, v17, v49
s_waitcnt lgkmcnt(1)
v_xor_b32 v58, v17, v50
v_xor_b32 v59, v17, v51
v_xor_b32 v60, v17, v52
v_xor_b32 v61, v17, v53
s_mov_b32 s36, 0x22222222
s_mov_b32 s37, s36
s_lshl_b64 s[38:39], s[36:37], 1
s_lshl_b64 s[40:41], s[36:37], 2
v_mov_b32 v20, 0x3f803f80
v_mov_b32 v21, 0x3f803f80
v_mov_b32 v22, 0x3f803f80
v_mov_b32 v23, 0x3f803f80
v_lshlrev_b32 v18, 4, v2
s_waitcnt vmcnt(0)
s_barrier
ds_read_b64_tr_b16 v[64:65], v8 offset:0
ds_read_b64_tr_b16 v[66:67], v8 offset:1024
ds_read_b64_tr_b16 v[68:69], v8 offset:2048
ds_read_b64_tr_b16 v[70:71], v8 offset:3072
ds_read_b64_tr_b16 v[72:73], v5 offset:4096
ds_read_b64_tr_b16 v[74:75], v5 offset:5120
ds_read_b64_tr_b16 v[76:77], v5 offset:6144
ds_read_b64_tr_b16 v[78:79], v5 offset:7168
ds_read_b64_tr_b16 v[80:81], v7 offset:4096
ds_read_b64_tr_b16 v[82:83], v8 offset:512
ds_read_b64_tr_b16 v[84:85], v8 offset:1536
ds_read_b64_tr_b16 v[86:87], v8 offset:2560
ds_read_b64_tr_b16 v[88:89], v8 offset:3584
ds_read_b64_tr_b16 v[90:91], v5 offset:4608
ds_read_b64_tr_b16 v[92:93], v5 offset:5632
ds_read_b64_tr_b16 v[94:95], v5 offset:6656
ds_read_b64_tr_b16 v[96:97], v5 offset:7680
ds_read_b64_tr_b16 v[98:99], v7 offset:4608
s_waitcnt lgkmcnt(15)
v_mfma_f32_16x16x32_bf16 v[100:103], v[64:67], v[28:31], 0
v_mfma_f32_16x16x32_bf16 v[104:107], v[64:67], v[46:49], 0
v_mfma_f32_4x4x4_16b_bf16 v[136:139], v[64:65], v[64:65], 0
v_mfma_f32_16x16x32_bf16 v[24:27], v[64:67], v[20:23], 0
s_nop 0
v_mfma_f32_4x4x4_16b_bf16 v[136:139], v[66:67], v[66:67], v[136:139]
s_waitcnt lgkmcnt(14)
v_mfma_f32_16x16x32_bf16 v[100:103], v[68:71], v[32:35], v[100:103]
v_mfma_f32_4x4x4_16b_bf16 v[136:139], v[68:69], v[68:69], v[136:139]
v_mfma_f32_16x16x32_bf16 v[104:107], v[68:71], v[50:53], v[104:107]
v_mfma_f32_16x16x32_bf16 v[24:27], v[68:71], v[20:23], v[24:27]
v_mfma_f32_4x4x4_16b_bf16 v[136:139], v[70:71], v[70:71], v[136:139]
s_waitcnt lgkmcnt(12)
v_mfma_f32_16x16x32_bf16 v[100:103], v[72:75], v[36:39], v[100:103]
v_mfma_f32_4x4x4_16b_bf16 v[136:139], v[72:73], v[72:73], v[136:139]
v_mfma_f32_16x16x32_bf16 v[104:107], v[72:75], v[54:57], v[104:107]
s_nop 0
v_mfma_f32_4x4x4_16b_bf16 v[136:139], v[74:75], v[74:75], v[136:139]
v_mfma_f32_16x16x32_bf16 v[24:27], v[72:75], v[20:23], v[24:27]
s_waitcnt lgkmcnt(10)
v_mfma_f32_16x16x32_bf16 v[100:103], v[76:79], v[40:43], v[100:103]
v_mfma_f32_4x4x4_16b_bf16 v[136:139], v[76:77], v[76:77], v[136:139]
v_mfma_f32_16x16x32_bf16 v[104:107], v[76:79], v[58:61], v[104:107]
s_nop 0
v_mfma_f32_4x4x4_16b_bf16 v[136:139], v[78:79], v[78:79], v[136:139]
v_mfma_f32_16x16x32_bf16 v[24:27], v[76:79], v[20:23], v[24:27]
s_waitcnt lgkmcnt(9)
v_mfma_f32_4x4x4_16b_bf16 v[136:139], v[80:81], v[80:81], v[136:139]
v_mfma_f32_16x16x16_bf16 v[100:103], v[80:81], v[44:45], v[100:103]
v_mfma_f32_16x16x16_bf16 v[104:107], v[80:81], v[62:63], v[104:107]
s_nop 1
v_mfma_f32_16x16x16_bf16 v[24:27], v[80:81], v[20:21], v[24:27]
s_waitcnt lgkmcnt(7)
v_mfma_f32_16x16x32_bf16 v[108:111], v[82:85], v[28:31], 0
v_mfma_f32_4x4x4_16b_bf16 v[140:143], v[82:83], v[82:83], 0
v_mfma_f32_16x16x32_bf16 v[112:115], v[82:85], v[46:49], 0
s_nop 0
v_mfma_f32_4x4x4_16b_bf16 v[140:143], v[84:85], v[84:85], v[140:143]
v_mfma_f32_16x16x32_bf16 v[132:135], v[82:85], v[20:23], 0
s_waitcnt lgkmcnt(6)
v_mfma_f32_4x4x4_16b_bf16 v[140:143], v[86:87], v[86:87], v[140:143]
s_waitcnt lgkmcnt(5)
v_mfma_f32_16x16x32_bf16 v[108:111], v[86:89], v[32:35], v[108:111]
v_mfma_f32_4x4x4_16b_bf16 v[140:143], v[88:89], v[88:89], v[140:143]
v_mfma_f32_16x16x32_bf16 v[112:115], v[86:89], v[50:53], v[112:115]
s_waitcnt lgkmcnt(4)
v_mfma_f32_4x4x4_16b_bf16 v[140:143], v[90:91], v[90:91], v[140:143]
v_mfma_f32_16x16x32_bf16 v[132:135], v[86:89], v[20:23], v[132:135]
s_waitcnt lgkmcnt(3)
v_mfma_f32_4x4x4_16b_bf16 v[140:143], v[92:93], v[92:93], v[140:143]
v_mfma_f32_16x16x32_bf16 v[108:111], v[90:93], v[36:39], v[108:111]
s_waitcnt lgkmcnt(2)
v_mfma_f32_4x4x4_16b_bf16 v[140:143], v[94:95], v[94:95], v[140:143]
v_mfma_f32_16x16x32_bf16 v[112:115], v[90:93], v[54:57], v[112:115]
s_waitcnt lgkmcnt(1)
v_mfma_f32_4x4x4_16b_bf16 v[140:143], v[96:97], v[96:97], v[140:143]
v_mfma_f32_16x16x32_bf16 v[132:135], v[90:93], v[20:23], v[132:135]
s_waitcnt lgkmcnt(0)
v_mfma_f32_4x4x4_16b_bf16 v[140:143], v[98:99], v[98:99], v[140:143]
v_mfma_f32_16x16x32_bf16 v[108:111], v[94:97], v[40:43], v[108:111]
v_cndmask_b32 v16, v136, v137, s[36:37]
v_mfma_f32_16x16x32_bf16 v[112:115], v[94:97], v[58:61], v[112:115]
v_cndmask_b32 v16, v16, v138, s[38:39]
v_cndmask_b32 v16, v16, v139, s[40:41]
v_mfma_f32_16x16x32_bf16 v[132:135], v[94:97], v[20:23], v[132:135]
v_cndmask_b32 v17, v140, v141, s[36:37]
v_mfma_f32_16x16x16_bf16 v[108:111], v[98:99], v[44:45], v[108:111]
v_cndmask_b32 v17, v17, v142, s[38:39]
v_cndmask_b32 v17, v17, v143, s[40:41]
v_mfma_f32_16x16x16_bf16 v[112:115], v[98:99], v[62:63], v[112:115]
s_nop 0
v_permlane32_swap_b32 v16, v17
v_add_f32 v16, v16, v17
v_mfma_f32_16x16x16_bf16 v[132:135], v[98:99], v[20:21], v[132:135]
s_nop 0
v_add_f32_dpp v16, v16, v16 quad_perm:[1,0,3,2] row_mask:0xf bank_mask:0xf
s_nop 1
v_add_f32_dpp v16, v16, v16 quad_perm:[2,3,0,1] row_mask:0xf bank_mask:0xf
v_mov_b32 v17, v16
s_nop 1
v_permlane16_swap_b32 v16, v17
v_add_f32 v16, v16, v17
ds_bpermute_b32 v14, v18, v16
ds_bpermute_b32 v15, v18, v16 offset:128
v_pk_mul_f32 v[64:65], v[124:125], v[100:101]
v_pk_mul_f32 v[66:67], v[126:127], v[102:103]
v_pk_mul_f32 v[68:69], v[124:125], v[104:105]
v_pk_mul_f32 v[70:71], v[126:127], v[106:107]
v_pk_fma_f32 v[64:65], v[128:129], v[104:105], v[64:65]
v_pk_fma_f32 v[66:67], v[130:131], v[106:107], v[66:67]
v_pk_fma_f32 v[68:69], v[128:129], v[100:101], v[68:69] neg_lo:[1,0,0] neg_hi:[1,0,0]
v_pk_fma_f32 v[70:71], v[130:131], v[102:103], v[70:71] neg_lo:[1,0,0] neg_hi:[1,0,0]
v_pk_add_f32 v[72:73], v[64:65], v[66:67]
v_pk_add_f32 v[74:75], v[68:69], v[70:71]
v_pk_add_f32 v[76:77], v[64:65], v[66:67] neg_lo:[0,1] neg_hi:[0,1]
v_pk_add_f32 v[78:79], v[68:69], v[70:71] neg_lo:[0,1] neg_hi:[0,1]
v_pk_mul_f32 v[80:81], v[124:125], v[108:109]
v_pk_mul_f32 v[82:83], v[126:127], v[110:111]
v_pk_mul_f32 v[84:85], v[124:125], v[112:113]
v_pk_mul_f32 v[86:87], v[126:127], v[114:115]
v_pk_fma_f32 v[80:81], v[128:129], v[112:113], v[80:81]
v_pk_fma_f32 v[82:83], v[130:131], v[114:115], v[82:83]
v_pk_fma_f32 v[84:85], v[128:129], v[108:109], v[84:85] neg_lo:[1,0,0] neg_hi:[1,0,0]
v_pk_fma_f32 v[86:87], v[130:131], v[110:111], v[86:87] neg_lo:[1,0,0] neg_hi:[1,0,0]
v_pk_add_f32 v[88:89], v[80:81], v[82:83]
v_pk_add_f32 v[90:91], v[84:85], v[86:87]
v_pk_add_f32 v[92:93], v[80:81], v[82:83] neg_lo:[0,1] neg_hi:[0,1]
v_pk_add_f32 v[94:95], v[84:85], v[86:87] neg_lo:[0,1] neg_hi:[0,1]
v_pk_add_f32 v[24:25], v[24:25], v[26:27]
v_pk_add_f32 v[132:133], v[132:133], v[134:135]
v_add_f32 v24, v24, v25
v_add_f32 v25, v132, v133
s_mov_b32 s4, 0x3ae38e39
s_mov_b32 s5, s4
v_pk_mul_f32 v[24:25], v[24:25], s[4:5]
v_pk_mul_f32 v[24:25], v[24:25], v[24:25]
s_waitcnt lgkmcnt(0)
v_pk_fma_f32 v[14:15], v[14:15], s[4:5], v[24:25] neg_lo:[0,0,1] neg_hi:[0,0,1]
v_max_f32 v14, 0, v14
v_max_f32 v15, 0, v15
v_add_f32 v14, 0x3727c5ac, v14
v_add_f32 v15, 0x3727c5ac, v15
v_rsq_f32 v16, v15
v_rsq_f32 v17, v15
v_rsq_f32 v15, v14
v_rsq_f32 v14, v14
s_nop 0
v_pk_mul_f32 v[72:73], v[72:73], v[14:15]
v_pk_mul_f32 v[74:75], v[74:75], v[14:15]
v_pk_mul_f32 v[76:77], v[76:77], v[14:15]
v_pk_mul_f32 v[78:79], v[78:79], v[14:15]
v_add_f32 v64, v72, v73
v_add_f32 v65, v74, v75
v_add_f32 v66, v76, v79
v_sub_f32 v67, v78, v77
v_sub_f32 v68, v72, v73
v_sub_f32 v69, v74, v75
v_sub_f32 v70, v76, v79
v_add_f32 v71, v78, v77
v_cvt_pk_bf16_f32 v20, v64, v65
v_cvt_pk_bf16_f32 v22, v66, v67
v_cvt_pk_bf16_f32 v24, v68, v69
v_cvt_pk_bf16_f32 v26, v70, v71
v_pk_mul_f32 v[88:89], v[88:89], v[16:17]
v_pk_mul_f32 v[90:91], v[90:91], v[16:17]
v_pk_mul_f32 v[92:93], v[92:93], v[16:17]
v_pk_mul_f32 v[94:95], v[94:95], v[16:17]
v_add_f32 v80, v88, v89
v_add_f32 v81, v90, v91
v_add_f32 v82, v92, v95
v_sub_f32 v83, v94, v93
v_sub_f32 v84, v88, v89
v_sub_f32 v85, v90, v91
v_sub_f32 v86, v92, v95
v_add_f32 v87, v94, v93
v_cvt_pk_bf16_f32 v21, v80, v81
v_cvt_pk_bf16_f32 v23, v82, v83
v_cvt_pk_bf16_f32 v25, v84, v85
v_cvt_pk_bf16_f32 v27, v86, v87
ds_write_b64 v10, v[20:21] offset:0
ds_write_b64 v10, v[22:23] offset:2048
ds_write_b64 v10, v[24:25] offset:4096
ds_write_b64 v10, v[26:27] offset:6144
s_waitcnt lgkmcnt(0)
s_barrier
ds_read_b128 v[28:31], v11 offset:0
ds_read_b128 v[32:35], v11 offset:1024
ds_read_b128 v[36:39], v11 offset:2048
ds_read_b128 v[40:43], v11 offset:3072
ds_read_b128 v[44:47], v11 offset:4096
ds_read_b128 v[48:51], v11 offset:5120
ds_read_b128 v[52:55], v11 offset:6144
ds_read_b128 v[56:59], v11 offset:7168
s_waitcnt lgkmcnt(7)
v_mfma_f32_16x16x32_bf16 v[100:103], v[116:119], v[28:31], 0
s_waitcnt lgkmcnt(5)
v_mfma_f32_16x16x32_bf16 v[104:107], v[116:119], v[36:39], 0
s_waitcnt lgkmcnt(3)
v_mfma_f32_16x16x32_bf16 v[108:111], v[116:119], v[44:47], 0
s_waitcnt lgkmcnt(1)
v_mfma_f32_16x16x32_bf16 v[112:115], v[116:119], v[52:55], 0
v_mfma_f32_16x16x32_bf16 v[100:103], v[120:123], v[32:35], v[100:103]
v_mfma_f32_16x16x32_bf16 v[104:107], v[120:123], v[40:43], v[104:107]
v_mfma_f32_16x16x32_bf16 v[108:111], v[120:123], v[48:51], v[108:111]
s_waitcnt lgkmcnt(0)
v_mfma_f32_16x16x32_bf16 v[112:115], v[120:123], v[56:59], v[112:115]
s_mov_b32 s3, 81920
s_nop 2
v_cvt_pk_bf16_f32 v20, v100, v101
v_cvt_pk_bf16_f32 v21, v104, v105
v_cvt_pk_bf16_f32 v22, v108, v109
s_nop 0
v_cvt_pk_bf16_f32 v23, v112, v113
v_and_b32 v20, -2, v20
buffer_store_dwordx4 v[20:23], v12, s[12:15], 0 offen sc1
v_cvt_pk_bf16_f32 v24, v102, v103
v_cvt_pk_bf16_f32 v25, v106, v107
v_cvt_pk_bf16_f32 v26, v110, v111
v_cvt_pk_bf16_f32 v27, v114, v115
v_and_b32 v24, -2, v24
buffer_store_dwordx4 v[24:27], v12, s[12:15], s3 offen sc1
s_endpgm
p1_side:
s_cmp_ge_u32 s2, 448
s_cbranch_scc1 p1_tab
s_sub_u32 s3, s2, 320
s_and_b32 s32, s3, 7
s_lshl_b32 s32, s32, 2
s_bfe_u32 s4, s3, 0x20003
s_add_u32 s32, s32, s4
s_lshr_b32 s31, s3, 5
s_lshl_b32 s3, s31, 9
s_add_u32 s33, s32, s3
s_and_b32 s3, s30, 1
s_mul_i32 s4, s3, 138
s_cmp_eq_u32 s3, 0
s_cselect_b32 s34, 1, -1
v_lshrrev_b32 v4, 5, v0
v_lshl_add_u32 v6, v4, 5, s33
v_mul_lo_u32 v6, v6, s34
s_lshl_b32 s35, s34, 6
v_and_b32 v5, 1, v2
v_mul_u32_u24 v5, 288, v5
v_add_u32 v5, s4, v5
v_mov_b32 v12, 1073741824
v_lshlrev_b32 v7, 2, v2
v_and_b32 v7, 4, v7
v_sub_u32 v7, v3, v7
v_cmp_gt_u32 vcc, 11, v7
v_lshlrev_b32 v7, 4, v7
s_nop 0
v_cndmask_b32 v12, v12, v7, vcc
s_movk_i32 s36, 578
s_mul_i32 s38, s30, 8336
s_add_u32 s38, s38, 51200
s_waitcnt lgkmcnt(0)
s_cmp_lt_u32 s30, 2
s_cselect_b32 s8, s46, s48
s_cselect_b32 s9, s47, s49
s_mov_b32 s10, 1183744
s_mov_b32 s11, 0x20000
v_and_b32 v8, 2047, v6
v_mad_u32_u24 v8, v8, s36, v5
v_and_b32 v8, -16, v8
s_add_u32 m0, s38, 0
v_add_u32 v8, v8, v12
buffer_load_dwordx4 v8, s[8:11], 0 offen  lds
v_add_u32 v6, s35, v6
v_and_b32 v8, 2047, v6
v_mad_u32_u24 v8, v8, s36, v5
v_and_b32 v8, -16, v8
s_add_u32 m0, s38, 1040
v_add_u32 v8, v8, v12
buffer_load_dwordx4 v8, s[8:11], 0 offen  lds
v_add_u32 v6, s35, v6
v_and_b32 v8, 2047, v6
v_mad_u32_u24 v8, v8, s36, v5
v_and_b32 v8, -16, v8
s_add_u32 m0, s38, 2080
v_add_u32 v8, v8, v12
buffer_load_dwordx4 v8, s[8:11], 0 offen  lds
v_add_u32 v6, s35, v6
v_and_b32 v8, 2047, v6
v_mad_u32_u24 v8, v8, s36, v5
v_and_b32 v8, -16, v8
s_add_u32 m0, s38, 3120
v_add_u32 v8, v8, v12
buffer_load_dwordx4 v8, s[8:11], 0 offen  lds
v_add_u32 v6, s35, v6
v_and_b32 v8, 2047, v6
v_mad_u32_u24 v8, v8, s36, v5
v_and_b32 v8, -16, v8
s_add_u32 m0, s38, 4160
v_add_u32 v8, v8, v12
buffer_load_dwordx4 v8, s[8:11], 0 offen  lds
v_add_u32 v6, s35, v6
v_and_b32 v8, 2047, v6
v_mad_u32_u24 v8, v8, s36, v5
v_and_b32 v8, -16, v8
s_add_u32 m0, s38, 5200
v_add_u32 v8, v8, v12
buffer_load_dwordx4 v8, s[8:11], 0 offen  lds
v_add_u32 v6, s35, v6
v_and_b32 v8, 2047, v6
v_mad_u32_u24 v8, v8, s36, v5
v_and_b32 v8, -16, v8
s_add_u32 m0, s38, 6240
v_add_u32 v8, v8, v12
buffer_load_dwordx4 v8, s[8:11], 0 offen  lds
v_add_u32 v6, s35, v6
v_and_b32 v8, 2047, v6
v_mad_u32_u24 v8, v8, s36, v5
v_and_b32 v8, -16, v8
s_add_u32 m0, s38, 7280
v_add_u32 v8, v8, v12
buffer_load_dwordx4 v8, s[8:11], 0 offen  lds
v_add_u32 v6, s35, v6
s_add_u32 s16, s6, 3145728
s_addc_u32 s17, s7, 0
s_mov_b32 s18, 2490368
s_mov_b32 s19, 0x20000
v_lshrrev_b32 v4, 2, v3
s_lshl_b32 s3, s30, 2
v_add_u32 v4, s3, v4
v_and_b32 v10, 3, v3
v_sub_u32 v13, 75, v4
v_cmp_gt_u32 vcc, 2, v10
s_nop 1
v_cndmask_b32 v13, v13, v4, vcc
v_mov_b32 v14, 0xffffffe0
v_cndmask_b32 v14, v14, 32, vcc
v_bfrev_b32 v15, 1
v_cndmask_b32 v15, v15, 0, vcc
v_mov_b32 v16, 8336
v_cndmask_b32 v16, v16, 0, vcc
v_lshl_add_u32 v16, v13, 1, v16
v_mul_u32_u24 v17, 2080, v2
v_add_u32 v16, v16, v17
v_lshrrev_b32 v17, 1, v10
v_xor_b32 v17, v17, v10
v_and_b32 v17, 1, v17
v_mul_u32_u24 v17, 320, v17
v_add_u32 v16, v16, v17
v_sub_u32 v17, 5, s33
v_mov_b32 v18, s33
v_cndmask_b32 v17, v17, v18, vcc
v_lshlrev_b32 v17, 1, v17
v_and_b32 v17, 14, v17
v_add_u32 v84, v16, v17
v_add_u32 v84, 51200, v84
v_or_b32 v11, v10, v4
v_cmp_eq_u32 s[40:41], 0, v11
s_mul_i32 s3, s32, 19
s_add_u32 s3, s3, s30
s_lshl_b32 s3, s3, 12
s_lshl_b32 s4, s31, 10
s_add_u32 s37, s3, s4
v_lshlrev_b32 v93, 4, v0
s_barrier
s_barrier
s_waitcnt vmcnt(0)
s_barrier
ds_read_u16 v20, v84 offset:0
ds_read_u16 v24, v84 offset:16672
ds_read_u16 v21, v84 offset:512
ds_read_u16 v25, v84 offset:17184
ds_read_u16 v22, v84 offset:1040
ds_read_u16 v26, v84 offset:17712
ds_read_u16 v23, v84 offset:1552
ds_read_u16 v27, v84 offset:18224
v_add_u32 v84, v84, v14
ds_read_u16 v32, v84 offset:0
ds_read_u16 v36, v84 offset:16672
ds_read_u16 v33, v84 offset:512
ds_read_u16 v37, v84 offset:17184
ds_read_u16 v34, v84 offset:1040
ds_read_u16 v38, v84 offset:17712
ds_read_u16 v35, v84 offset:1552
ds_read_u16 v39, v84 offset:18224
v_add_u32 v84, v84, v14
ds_read_u16 v44, v84 offset:0
ds_read_u16 v48, v84 offset:16672
ds_read_u16 v45, v84 offset:512
ds_read_u16 v49, v84 offset:17184
ds_read_u16 v46, v84 offset:1040
ds_read_u16 v50, v84 offset:17712
ds_read_u16 v47, v84 offset:1552
ds_read_u16 v51, v84 offset:18224
v_add_u32 v84, v84, v14
ds_read_u16 v56, v84 offset:0
ds_read_u16 v60, v84 offset:16672
ds_read_u16 v57, v84 offset:512
ds_read_u16 v61, v84 offset:17184
ds_read_u16 v58, v84 offset:1040
ds_read_u16 v62, v84 offset:17712
ds_read_u16 v59, v84 offset:1552
ds_read_u16 v63, v84 offset:18224
v_add_u32 v84, v84, v14
ds_read_u16 v68, v84 offset:0
ds_read_u16 v72, v84 offset:16672
ds_read_u16 v69, v84 offset:512
ds_read_u16 v73, v84 offset:17184
ds_read_u16 v70, v84 offset:1040
ds_read_u16 v74, v84 offset:17712
ds_read_u16 v71, v84 offset:1552
ds_read_u16 v75, v84 offset:18224
v_cmp_lt_u32 vcc, 8, v4
s_waitcnt lgkmcnt(15)
v_lshl_or_b32 v28, v24, 16, v20
v_xor_b32 v28, v15, v28
v_lshl_or_b32 v29, v25, 16, v21
v_xor_b32 v29, v15, v29
v_lshl_or_b32 v30, v26, 16, v22
v_xor_b32 v30, v15, v30
v_lshl_or_b32 v31, v27, 16, v23
v_xor_b32 v31, v15, v31
v_cndmask_b32 v28, v28, 0, s[40:41]
v_cndmask_b32 v29, v29, 0, s[40:41]
v_cndmask_b32 v30, v30, 0, s[40:41]
v_cndmask_b32 v31, v31, 0, s[40:41]
buffer_store_dwordx4 v[28:31], v93, s[16:19], s37 offen sc1
s_add_u32 s37, s37, 16384
v_lshl_or_b32 v40, v36, 16, v32
v_xor_b32 v40, v15, v40
v_lshl_or_b32 v41, v37, 16, v33
v_xor_b32 v41, v15, v41
v_lshl_or_b32 v42, v38, 16, v34
v_xor_b32 v42, v15, v42
v_lshl_or_b32 v43, v39, 16, v35
v_xor_b32 v43, v15, v43
buffer_store_dwordx4 v[40:43], v93, s[16:19], s37 offen sc1
s_add_u32 s37, s37, 16384
v_lshl_or_b32 v52, v48, 16, v44
v_xor_b32 v52, v15, v52
v_lshl_or_b32 v53, v49, 16, v45
v_xor_b32 v53, v15, v53
v_lshl_or_b32 v54, v50, 16, v46
v_xor_b32 v54, v15, v54
v_lshl_or_b32 v55, v51, 16, v47
v_xor_b32 v55, v15, v55
buffer_store_dwordx4 v[52:55], v93, s[16:19], s37 offen sc1
s_add_u32 s37, s37, 16384
s_waitcnt lgkmcnt(14)
v_lshl_or_b32 v64, v60, 16, v56
v_xor_b32 v64, v15, v64
s_waitcnt lgkmcnt(12)
v_lshl_or_b32 v65, v61, 16, v57
v_xor_b32 v65, v15, v65
s_waitcnt lgkmcnt(10)
v_lshl_or_b32 v66, v62, 16, v58
v_xor_b32 v66, v15, v66
s_waitcnt lgkmcnt(8)
v_lshl_or_b32 v67, v63, 16, v59
v_xor_b32 v67, v15, v67
buffer_store_dwordx4 v[64:67], v93, s[16:19], s37 offen sc1
s_add_u32 s37, s37, 16384
s_cmp_eq_u32 s30, 3
s_cbranch_scc1 p1_wend
s_waitcnt lgkmcnt(6)
v_lshl_or_b32 v76, v72, 16, v68
v_xor_b32 v76, v15, v76
s_waitcnt lgkmcnt(4)
v_lshl_or_b32 v77, v73, 16, v69
v_xor_b32 v77, v15, v77
s_waitcnt lgkmcnt(2)
v_lshl_or_b32 v78, v74, 16, v70
v_xor_b32 v78, v15, v78
s_waitcnt lgkmcnt(0)
v_lshl_or_b32 v79, v75, 16, v71
v_xor_b32 v79, v15, v79
v_cndmask_b32 v76, v76, 0, vcc
v_cndmask_b32 v77, v77, 0, vcc
v_cndmask_b32 v78, v78, 0, vcc
v_cndmask_b32 v79, v79, 0, vcc
buffer_store_dwordx4 v[76:79], v93, s[16:19], s37 offen sc1
s_add_u32 s37, s37, 16384
p1_wend:
s_endpgm
p1_tab:
s_cmp_ge_u32 s2, 464
s_cbranch_scc1 p1_pf
s_sub_u32 s3, s2, 448
s_lshl_b32 s3, s3, 2
s_add_u32 s31, s3, s30
s_cmp_ge_u32 s31, 61
s_cbranch_scc1 p1_end
s_lshr_b32 s32, s31, 2
s_and_b32 s33, s31, 3
s_mov_b32 s34, 0x3c800000
s_cmp_lt_u32 s31, 16
s_cbranch_scc1 p1_tabA
s_sub_u32 s3, s31, 16
s_mul_i32 s32, s3, 52
s_lshr_b32 s32, s32, 8
s_mul_i32 s4, s32, 5
s_sub_u32 s33, s3, s4
s_mov_b32 s34, 0x3be38e39
p1_tabA:
s_lshl_b32 s32, s32, 4
s_lshl_b32 s33, s33, 4
v_add_u32 v4, s32, v3
v_lshl_add_u32 v5, v2, 2, s33
s_waitcnt lgkmcnt(0)
s_add_u32 s8, s6, 5767168
s_addc_u32 s9, s7, 0
s_mov_b32 s10, 62464
s_mov_b32 s11, 0x20000
v_add_u32 v6, 0, v5
v_mul_u32_u24 v7, v6, v4
v_cvt_f32_u32 v7, v7
v_mul_f32 v7, s34, v7
v_fract_f32 v7, v7
v_cos_f32 v8, v7
v_sin_f32 v9, v7
s_cmp_lt_u32 s31, 16
s_cbranch_scc1 p1_tabB0
v_mov_b32 v10, 0x35e38e39
v_mov_b32 v11, 0x35638e39
v_cmp_eq_u32 vcc, 0, v6
s_nop 1
v_cndmask_b32 v10, v10, v11, vcc
v_cmp_eq_u32 vcc, 72, v6
s_nop 1
v_cndmask_b32 v10, v10, v11, vcc
v_cmp_gt_u32 vcc, 73, v6
s_nop 1
v_cndmask_b32 v10, 0, v10, vcc
v_mul_f32 v8, v8, v10
v_mul_f32 v9, -v9, v10
p1_tabB0:
v_cvt_pk_bf16_f32 v12, v8, v9
v_add_u32 v6, 1, v5
v_mul_u32_u24 v7, v6, v4
v_cvt_f32_u32 v7, v7
v_mul_f32 v7, s34, v7
v_fract_f32 v7, v7
v_cos_f32 v8, v7
v_sin_f32 v9, v7
s_cmp_lt_u32 s31, 16
s_cbranch_scc1 p1_tabB1
v_mov_b32 v10, 0x35e38e39
v_mov_b32 v11, 0x35638e39
v_cmp_eq_u32 vcc, 0, v6
s_nop 1
v_cndmask_b32 v10, v10, v11, vcc
v_cmp_eq_u32 vcc, 72, v6
s_nop 1
v_cndmask_b32 v10, v10, v11, vcc
v_cmp_gt_u32 vcc, 73, v6
s_nop 1
v_cndmask_b32 v10, 0, v10, vcc
v_mul_f32 v8, v8, v10
v_mul_f32 v9, -v9, v10
p1_tabB1:
v_cvt_pk_bf16_f32 v13, v8, v9
v_add_u32 v6, 2, v5
v_mul_u32_u24 v7, v6, v4
v_cvt_f32_u32 v7, v7
v_mul_f32 v7, s34, v7
v_fract_f32 v7, v7
v_cos_f32 v8, v7
v_sin_f32 v9, v7
s_cmp_lt_u32 s31, 16
s_cbranch_scc1 p1_tabB2
v_mov_b32 v10, 0x35e38e39
v_mov_b32 v11, 0x35638e39
v_cmp_eq_u32 vcc, 0, v6
s_nop 1
v_cndmask_b32 v10, v10, v11, vcc
v_cmp_eq_u32 vcc, 72, v6
s_nop 1
v_cndmask_b32 v10, v10, v11, vcc
v_cmp_gt_u32 vcc, 73, v6
s_nop 1
v_cndmask_b32 v10, 0, v10, vcc
v_mul_f32 v8, v8, v10
v_mul_f32 v9, -v9, v10
p1_tabB2:
v_cvt_pk_bf16_f32 v14, v8, v9
v_add_u32 v6, 3, v5
v_mul_u32_u24 v7, v6, v4
v_cvt_f32_u32 v7, v7
v_mul_f32 v7, s34, v7
v_fract_f32 v7, v7
v_cos_f32 v8, v7
v_sin_f32 v9, v7
s_cmp_lt_u32 s31, 16
s_cbranch_scc1 p1_tabB3
v_mov_b32 v10, 0x35e38e39
v_mov_b32 v11, 0x35638e39
v_cmp_eq_u32 vcc, 0, v6
s_nop 1
v_cndmask_b32 v10, v10, v11, vcc
v_cmp_eq_u32 vcc, 72, v6
s_nop 1
v_cndmask_b32 v10, v10, v11, vcc
v_cmp_gt_u32 vcc, 73, v6
s_nop 1
v_cndmask_b32 v10, 0, v10, vcc
v_mul_f32 v8, v8, v10
v_mul_f32 v9, -v9, v10
p1_tabB3:
v_cvt_pk_bf16_f32 v15, v8, v9
v_lshlrev_b32 v4, 4, v0
s_lshl_b32 s3, s31, 10
buffer_store_dwordx4 v[12:15], v4, s[8:11], s3 offen sc1
s_endpgm
p1_pf:
s_cmp_ge_u32 s2, 480
s_cbranch_scc1 p1_end
s_getpc_b64 s[4:5]
p1_pc:
s_add_u32 s4, s4, pf_kernel-p1_pc
s_addc_u32 s5, s5, 0
s_lshl_b32 s3, s30, 6
v_add_u32 v4, s3, v0
s_sub_u32 s3, s2, 464
s_lshr_b32 s3, s3, 3
s_lshl_b32 s3, s3, 15
v_lshl_add_u32 v5, v4, 7, s3
v_min_u32 v5, pf_code_end-pf_kernel-4, v5
global_load_dword v6, v5, s[4:5]
s_waitcnt lgkmcnt(0)
s_add_u32 s8, s6, 12582912
s_addc_u32 s9, s7, 0
s_mov_b32 s10, 327680
s_mov_b32 s11, 0x20000
s_and_b32 s3, s2, 15
s_mul_i32 s3, s3, 12288
v_lshlrev_b32 v4, 4, v4
v_mov_b32 v8, 0
v_mov_b32 v9, 0
v_mov_b32 v10, 0
v_mov_b32 v11, 0
buffer_store_dwordx4 v[8:11], v4, s[8:11], s3 offen sc1
s_add_u32 s3, s3, 4096
buffer_store_dwordx4 v[8:11], v4, s[8:11], s3 offen sc1
s_add_u32 s3, s3, 4096
buffer_store_dwordx4 v[8:11], v4, s[8:11], s3 offen sc1
s_add_u32 s3, s3, 4096
p1_end:
s_endpgm
p1_code_end:

.section .rodata,"a"
.p2align 6
.amdhsa_kernel p1_kernel
  .amdhsa_next_free_vgpr 144
  .amdhsa_next_free_sgpr 96
  .amdhsa_accum_offset 144
  .amdhsa_group_segment_fixed_size 0
  .amdhsa_kernarg_size 80
  .amdhsa_user_sgpr_count 2
  .amdhsa_user_sgpr_kernarg_segment_ptr 1
  .amdhsa_system_sgpr_workgroup_id_x 1
  .amdhsa_float_denorm_mode_32 3
.end_amdhsa_kernel

.text
.globl pf_kernel
.p2align 8
.type pf_kernel,@function
pf_kernel:
s_load_dwordx2 s[6:7], s[0:1], 72
s_load_dwordx2 s[8:9], s[0:1], 32
s_load_dwordx2 s[12:13], s[0:1], 40
s_load_dwordx2 s[48:49], s[0:1], 0
s_load_dwordx2 s[16:17], s[0:1], 48
s_load_dwordx2 s[40:41], s[0:1], 56
s_cmp_ge_u32 s2, 256
s_cbranch_scc1 pf_end
v_lshrrev_b32 v5, 6, v0
v_and_b32 v0, 63, v0
v_readfirstlane_b32 s56, v5
s_lshr_b32 s3, s2, 3
s_and_b32 s57, s3, 15
s_lshr_b32 s97, s3, 4
s_and_b32 s98, s2, 7
s_lshl_b32 s4, s98, 1
s_add_u32 s58, s4, s97
v_lshlrev_b32 v1, 4, v0
v_mov_b32 v26, 0
v_mov_b32 v37, 0
v_mov_b32 v2, 0
v_mov_b32 v3, 0
v_mov_b32 v4, 0
v_mov_b32 v47, 0
v_mov_b32 v30, 0
s_and_b32 s3, s98, 3
s_lshl_b32 s99, s57, 2
s_add_u32 s99, s99, s3
s_lshr_b32 s3, s98, 2
s_and_b32 s4, s57, 1
s_cmp_eq_u32 s3, s4
s_cselect_b32 s92, 1, 0
s_lshl_b32 s3, s97, 3
s_lshr_b32 s4, s57, 1
s_add_u32 s81, s3, s4
s_waitcnt lgkmcnt(0)
s_add_u32 s44, s6, 0
s_addc_u32 s45, s7, 0
s_mov_b32 s46, 5829632
s_mov_b32 s47, 0x20000
s_mov_b32 s96, 0
s_lshl_b32 s3, s81, 1
s_sub_u32 s4, s56, 5
s_add_u32 s3, s3, s4
s_cmp_lt_u32 s4, 2
s_cselect_b32 s3, s3, 64+12
s_mul_i32 s4, s81, 3
s_add_u32 s4, s4, s56
s_add_u32 s4, s4, 32
s_cmp_lt_u32 s56, 3
s_cselect_b32 s4, s4, 64+12
s_cmp_eq_u32 s92, 0
s_cselect_b32 s3, s4, s3
s_cmp_ge_u32 s3, 76
s_cbranch_scc1 pf_other
s_mul_i32 s4, s3, 27
s_lshr_b32 s4, s4, 9
s_mul_i32 s5, s4, 19
s_sub_u32 s81, s3, s5
s_lshl_b32 s3, s98, 2
s_add_u32 s82, s3, s4
v_lshrrev_b32 v2, 4, v0
v_and_b32 v3, 15, v0
v_mul_u32_u24 v4, 5120, v2
v_lshl_add_u32 v4, v3, 2, v4
s_mul_i32 s83, s82, 81920
s_lshl_b32 s3, s81, 6
s_add_u32 s83, s83, s3
s_mov_b32 s84, s83
buffer_load_dword v56, v4, s[44:47], s83 offen offset:0
buffer_load_dword v57, v4, s[44:47], s83 offen offset:1280
buffer_load_dword v58, v4, s[44:47], s83 offen offset:2560
buffer_load_dword v59, v4, s[44:47], s83 offen offset:3840
s_add_u32 s83, s83, 20480
buffer_load_dword v60, v4, s[44:47], s83 offen offset:0
buffer_load_dword v61, v4, s[44:47], s83 offen offset:1280
buffer_load_dword v62, v4, s[44:47], s83 offen offset:2560
buffer_load_dword v63, v4, s[44:47], s83 offen offset:3840
s_add_u32 s83, s83, 20480
buffer_load_dword v64, v4, s[44:47], s83 offen offset:0
buffer_load_dword v65, v4, s[44:47], s83 offen offset:1280
buffer_load_dword v66, v4, s[44:47], s83 offen offset:2560
buffer_load_dword v67, v4, s[44:47], s83 offen offset:3840
s_add_u32 s83, s83, 20480
buffer_load_dword v68, v4, s[44:47], s83 offen offset:0
buffer_load_dword v69, v4, s[44:47], s83 offen offset:1280
buffer_load_dword v70, v4, s[44:47], s83 offen offset:2560
buffer_load_dword v71, v4, s[44:47], s83 offen offset:3840
s_mov_b32 s3, 5767168
buffer_load_dwordx4 v[88:91], v1, s[44:47], s3 offen offset:0
buffer_load_dwordx4 v[92:95], v1, s[44:47], s3 offen offset:1024
buffer_load_dwordx4 v[96:99], v1, s[44:47], s3 offen offset:2048
buffer_load_dwordx4 v[100:103], v1, s[44:47], s3 offen offset:3072
s_mov_b32 s3, 5771264
buffer_load_dwordx4 v[104:107], v1, s[44:47], s3 offen offset:0
buffer_load_dwordx4 v[108:111], v1, s[44:47], s3 offen offset:1024
buffer_load_dwordx4 v[112:115], v1, s[44:47], s3 offen offset:2048
buffer_load_dwordx4 v[116:119], v1, s[44:47], s3 offen offset:3072
s_mov_b32 s3, 5775360
buffer_load_dwordx4 v[120:123], v1, s[44:47], s3 offen offset:0
buffer_load_dwordx4 v[124:127], v1, s[44:47], s3 offen offset:1024
buffer_load_dwordx4 v[128:131], v1, s[44:47], s3 offen offset:2048
buffer_load_dwordx4 v[132:135], v1, s[44:47], s3 offen offset:3072
s_mov_b32 s3, 5779456
buffer_load_dwordx4 v[136:139], v1, s[44:47], s3 offen offset:0
buffer_load_dwordx4 v[140:143], v1, s[44:47], s3 offen offset:1024
buffer_load_dwordx4 v[144:147], v1, s[44:47], s3 offen offset:2048
buffer_load_dwordx4 v[148:151], v1, s[44:47], s3 offen offset:3072
s_mul_i32 s3, s82, 19
s_add_u32 s3, s3, s81
s_lshl_b32 s3, s3, 12
s_add_u32 s3, s3, 3145728
buffer_load_dwordx4 v[152:155], v1, s[44:47], s3 offen offset:0
buffer_load_dwordx4 v[156:159], v1, s[44:47], s3 offen offset:1024
buffer_load_dwordx4 v[160:163], v1, s[44:47], s3 offen offset:2048
buffer_load_dwordx4 v[164:167], v1, s[44:47], s3 offen offset:3072
v_mul_u32_u24 v6, 1280, v3
v_lshl_add_u32 v6, v2, 4, v6
s_brev_b32 s85, 1
s_mov_b32 s86, 0xffff0000
v_lshrrev_b32 v34, 4, v0
v_and_b32 v35, 15, v0
s_lshl_b32 s3, s56, 4
v_add_u32 v36, s3, v35
v_lshlrev_b32 v36, 4, v36
v_mul_u32_u24 v42, 327680, v34
v_add_u32 v36, v36, v42
s_mul_i32 s100, s99, 1280
s_lshl_b32 s3, s97, 4
v_add_u32 v38, s3, v35
v_lshl_add_u32 v38, v38, 6, s99
v_mul_u32_u24 v39, 1152, v38
v_lshl_add_u32 v39, v34, 5, v39
s_lshl_b32 s101, s56, 7
s_mov_b32 s50, 2359296
s_mov_b32 s51, 0x20000
s_add_u32 s52, s6, 5767168
s_addc_u32 s53, s7, 0
s_mov_b32 s54, 62464
s_mov_b32 s55, 0x20000
s_add_u32 s20, s6, 6291456
s_addc_u32 s21, s7, 0
s_mov_b32 s22, 2359296
s_mov_b32 s23, 0x20000
s_add_u32 s36, s6, 9437184
s_addc_u32 s37, s7, 0
s_mov_b32 s38, 2359296
s_mov_b32 s39, 0x20000
s_add_u32 s28, s6, 12582912
s_addc_u32 s29, s7, 0
s_mov_b32 s30, 327680
s_mov_b32 s31, 0x20000
s_mov_b32 s10, 5308416
s_mov_b32 s11, 0x20000
s_mov_b32 s14, 5308416
s_mov_b32 s15, 0x20000
s_mov_b32 s18, 5308416
s_mov_b32 s19, 0x20000
s_mov_b32 s42, 2359296
s_mov_b32 s43, 0x20000
s_add_u32 s24, s6, 13631488
s_addc_u32 s25, s7, 0
s_mov_b32 s26, 37748736
s_mov_b32 s27, 0x20000
s_bitcmp0_b32 s56, 1
s_cselect_b32 s32, s8, s12
s_cselect_b32 s33, s9, s13
s_mov_b32 s34, 5308416
s_mov_b32 s35, 0x20000
s_waitcnt vmcnt(35)
v_alignbit_b32 v72, v56, v56, 16
v_xor_b32 v72, s85, v72
s_waitcnt vmcnt(34)
v_alignbit_b32 v73, v57, v57, 16
v_xor_b32 v73, s85, v73
s_waitcnt vmcnt(33)
v_alignbit_b32 v74, v58, v58, 16
v_xor_b32 v74, s85, v74
s_waitcnt vmcnt(32)
v_alignbit_b32 v75, v59, v59, 16
v_xor_b32 v75, s85, v75
s_waitcnt vmcnt(31)
v_alignbit_b32 v76, v60, v60, 16
v_xor_b32 v76, s85, v76
s_waitcnt vmcnt(30)
v_alignbit_b32 v77, v61, v61, 16
v_xor_b32 v77, s85, v77
s_waitcnt vmcnt(29)
v_alignbit_b32 v78, v62, v62, 16
v_xor_b32 v78, s85, v78
s_waitcnt vmcnt(28)
v_alignbit_b32 v79, v63, v63, 16
v_xor_b32 v79, s85, v79
s_waitcnt vmcnt(27)
v_alignbit_b32 v80, v64, v64, 16
v_xor_b32 v80, s85, v80
s_waitcnt vmcnt(26)
v_alignbit_b32 v81, v65, v65, 16
v_xor_b32 v81, s85, v81
s_waitcnt vmcnt(25)
v_alignbit_b32 v82, v66, v66, 16
v_xor_b32 v82, s85, v82
s_waitcnt vmcnt(24)
v_alignbit_b32 v83, v67, v67, 16
v_xor_b32 v83, s85, v83
s_waitcnt vmcnt(23)
v_alignbit_b32 v84, v68, v68, 16
v_xor_b32 v84, s85, v84
s_waitcnt vmcnt(22)
v_alignbit_b32 v85, v69, v69, 16
v_xor_b32 v85, s85, v85
s_waitcnt vmcnt(21)
v_alignbit_b32 v86, v70, v70, 16
v_xor_b32 v86, s85, v86
s_waitcnt vmcnt(20)
v_alignbit_b32 v87, v71, v71, 16
v_xor_b32 v87, s85, v87
s_barrier
s_waitcnt vmcnt(19)
v_mfma_f32_16x16x32_bf16 v[168:171], v[88:91], v[56:59], 0
v_mfma_f32_16x16x32_bf16 v[184:187], v[88:91], v[72:75], 0
s_waitcnt vmcnt(18)
v_mfma_f32_16x16x32_bf16 v[168:171], v[92:95], v[60:63], v[168:171]
v_mfma_f32_16x16x32_bf16 v[184:187], v[92:95], v[76:79], v[184:187]
s_waitcnt vmcnt(17)
v_mfma_f32_16x16x32_bf16 v[168:171], v[96:99], v[64:67], v[168:171]
v_mfma_f32_16x16x32_bf16 v[184:187], v[96:99], v[80:83], v[184:187]
s_waitcnt vmcnt(16)
v_mfma_f32_16x16x32_bf16 v[168:171], v[100:103], v[68:71], v[168:171]
v_mfma_f32_16x16x32_bf16 v[184:187], v[100:103], v[84:87], v[184:187]
s_waitcnt vmcnt(15)
v_mfma_f32_16x16x32_bf16 v[172:175], v[104:107], v[56:59], 0
s_waitcnt vmcnt(3)
v_lshlrev_b32 v200, 16, v152
v_lshlrev_b32 v201, 16, v153
v_and_b32 v202, s86, v152
v_mfma_f32_16x16x32_bf16 v[188:191], v[104:107], v[72:75], 0
v_and_b32 v203, s86, v153
v_pk_mul_f32 v[204:205], v[168:169], v[200:201]
v_pk_mul_f32 v[206:207], v[168:169], v[202:203]
v_mfma_f32_16x16x32_bf16 v[172:175], v[108:111], v[60:63], v[172:175]
v_pk_fma_f32 v[204:205], v[184:185], v[202:203], v[204:205] neg_lo:[1,0,0] neg_hi:[1,0,0]
v_pk_fma_f32 v[206:207], v[184:185], v[200:201], v[206:207]
v_cvt_pk_bf16_f32 v152, v204, -v206
v_mfma_f32_16x16x32_bf16 v[188:191], v[108:111], v[76:79], v[188:191]
v_cvt_pk_bf16_f32 v153, v205, -v207
v_cvt_pk_bf16_f32 v168, v206, v204
v_cvt_pk_bf16_f32 v169, v207, v205
v_mfma_f32_16x16x32_bf16 v[172:175], v[112:115], v[64:67], v[172:175]
v_lshlrev_b32 v200, 16, v154
v_lshlrev_b32 v201, 16, v155
v_and_b32 v202, s86, v154
v_mfma_f32_16x16x32_bf16 v[188:191], v[112:115], v[80:83], v[188:191]
v_and_b32 v203, s86, v155
v_pk_mul_f32 v[204:205], v[170:171], v[200:201]
v_pk_mul_f32 v[206:207], v[170:171], v[202:203]
v_mfma_f32_16x16x32_bf16 v[172:175], v[116:119], v[68:71], v[172:175]
v_pk_fma_f32 v[204:205], v[186:187], v[202:203], v[204:205] neg_lo:[1,0,0] neg_hi:[1,0,0]
v_pk_fma_f32 v[206:207], v[186:187], v[200:201], v[206:207]
v_cvt_pk_bf16_f32 v154, v204, -v206
v_mfma_f32_16x16x32_bf16 v[188:191], v[116:119], v[84:87], v[188:191]
v_cvt_pk_bf16_f32 v155, v205, -v207
v_cvt_pk_bf16_f32 v170, v206, v204
v_cvt_pk_bf16_f32 v171, v207, v205
v_mfma_f32_16x16x32_bf16 v[176:179], v[120:123], v[56:59], 0
s_waitcnt vmcnt(2)
v_lshlrev_b32 v200, 16, v156
v_lshlrev_b32 v201, 16, v157
v_and_b32 v202, s86, v156
v_mfma_f32_16x16x32_bf16 v[192:195], v[120:123], v[72:75], 0
v_and_b32 v203, s86, v157
v_pk_mul_f32 v[204:205], v[172:173], v[200:201]
v_pk_mul_f32 v[206:207], v[172:173], v[202:203]
v_mfma_f32_16x16x32_bf16 v[176:179], v[124:127], v[60:63], v[176:179]
v_pk_fma_f32 v[204:205], v[188:189], v[202:203], v[204:205] neg_lo:[1,0,0] neg_hi:[1,0,0]
v_pk_fma_f32 v[206:207], v[188:189], v[200:201], v[206:207]
v_cvt_pk_bf16_f32 v156, v204, -v206
v_mfma_f32_16x16x32_bf16 v[192:195], v[124:127], v[76:79], v[192:195]
v_cvt_pk_bf16_f32 v157, v205, -v207
v_cvt_pk_bf16_f32 v172, v206, v204
v_cvt_pk_bf16_f32 v173, v207, v205
v_mfma_f32_16x16x32_bf16 v[176:179], v[128:131], v[64:67], v[176:179]
v_lshlrev_b32 v200, 16, v158
v_lshlrev_b32 v201, 16, v159
v_and_b32 v202, s86, v158
v_mfma_f32_16x16x32_bf16 v[192:195], v[128:131], v[80:83], v[192:195]
v_and_b32 v203, s86, v159
v_pk_mul_f32 v[204:205], v[174:175], v[200:201]
v_pk_mul_f32 v[206:207], v[174:175], v[202:203]
v_mfma_f32_16x16x32_bf16 v[176:179], v[132:135], v[68:71], v[176:179]
v_pk_fma_f32 v[204:205], v[190:191], v[202:203], v[204:205] neg_lo:[1,0,0] neg_hi:[1,0,0]
v_pk_fma_f32 v[206:207], v[190:191], v[200:201], v[206:207]
v_cvt_pk_bf16_f32 v158, v204, -v206
v_mfma_f32_16x16x32_bf16 v[192:195], v[132:135], v[84:87], v[192:195]
v_cvt_pk_bf16_f32 v159, v205, -v207
v_cvt_pk_bf16_f32 v174, v206, v204
v_cvt_pk_bf16_f32 v175, v207, v205
v_mfma_f32_16x16x32_bf16 v[180:183], v[136:139], v[56:59], 0
s_waitcnt vmcnt(1)
v_lshlrev_b32 v200, 16, v160
v_lshlrev_b32 v201, 16, v161
v_and_b32 v202, s86, v160
v_mfma_f32_16x16x32_bf16 v[196:199], v[136:139], v[72:75], 0
v_and_b32 v203, s86, v161
v_pk_mul_f32 v[204:205], v[176:177], v[200:201]
v_pk_mul_f32 v[206:207], v[176:177], v[202:203]
v_mfma_f32_16x16x32_bf16 v[180:183], v[140:143], v[60:63], v[180:183]
v_pk_fma_f32 v[204:205], v[192:193], v[202:203], v[204:205] neg_lo:[1,0,0] neg_hi:[1,0,0]
v_pk_fma_f32 v[206:207], v[192:193], v[200:201], v[206:207]
v_cvt_pk_bf16_f32 v160, v204, -v206
v_mfma_f32_16x16x32_bf16 v[196:199], v[140:143], v[76:79], v[196:199]
v_cvt_pk_bf16_f32 v161, v205, -v207
v_cvt_pk_bf16_f32 v176, v206, v204
v_cvt_pk_bf16_f32 v177, v207, v205
v_mfma_f32_16x16x32_bf16 v[180:183], v[144:147], v[64:67], v[180:183]
v_lshlrev_b32 v200, 16, v162
v_lshlrev_b32 v201, 16, v163
v_and_b32 v202, s86, v162
v_mfma_f32_16x16x32_bf16 v[196:199], v[144:147], v[80:83], v[196:199]
v_and_b32 v203, s86, v163
v_pk_mul_f32 v[204:205], v[178:179], v[200:201]
v_pk_mul_f32 v[206:207], v[178:179], v[202:203]
v_mfma_f32_16x16x32_bf16 v[180:183], v[148:151], v[68:71], v[180:183]
v_pk_fma_f32 v[204:205], v[194:195], v[202:203], v[204:205] neg_lo:[1,0,0] neg_hi:[1,0,0]
v_pk_fma_f32 v[206:207], v[194:195], v[200:201], v[206:207]
v_cvt_pk_bf16_f32 v162, v204, -v206
v_mfma_f32_16x16x32_bf16 v[196:199], v[148:151], v[84:87], v[196:199]
v_cvt_pk_bf16_f32 v163, v205, -v207
v_cvt_pk_bf16_f32 v178, v206, v204
v_cvt_pk_bf16_f32 v179, v207, v205
s_waitcnt vmcnt(0)
v_lshlrev_b32 v200, 16, v164
v_lshlrev_b32 v201, 16, v165
v_and_b32 v202, s86, v164
v_and_b32 v203, s86, v165
v_pk_mul_f32 v[204:205], v[180:181], v[200:201]
v_pk_mul_f32 v[206:207], v[180:181], v[202:203]
v_pk_fma_f32 v[204:205], v[196:197], v[202:203], v[204:205] neg_lo:[1,0,0] neg_hi:[1,0,0]
v_pk_fma_f32 v[206:207], v[196:197], v[200:201], v[206:207]
v_cvt_pk_bf16_f32 v164, v204, -v206
v_cvt_pk_bf16_f32 v165, v205, -v207
v_cvt_pk_bf16_f32 v180, v206, v204
v_cvt_pk_bf16_f32 v181, v207, v205
v_lshlrev_b32 v200, 16, v166
v_lshlrev_b32 v201, 16, v167
v_and_b32 v202, s86, v166
v_and_b32 v203, s86, v167
v_pk_mul_f32 v[204:205], v[182:183], v[200:201]
v_pk_mul_f32 v[206:207], v[182:183], v[202:203]
v_pk_fma_f32 v[204:205], v[198:199], v[202:203], v[204:205] neg_lo:[1,0,0] neg_hi:[1,0,0]
v_pk_fma_f32 v[206:207], v[198:199], v[200:201], v[206:207]
v_cvt_pk_bf16_f32 v166, v204, -v206
v_cvt_pk_bf16_f32 v167, v205, -v207
v_cvt_pk_bf16_f32 v182, v206, v204
v_cvt_pk_bf16_f32 v183, v207, v205
v_mfma_f32_16x16x32_bf16 v[56:59], v[152:155], v[88:91], 0
v_mfma_f32_16x16x32_bf16 v[72:75], v[168:171], v[88:91], 0
v_mfma_f32_16x16x32_bf16 v[56:59], v[156:159], v[92:95], v[56:59]
v_mfma_f32_16x16x32_bf16 v[72:75], v[172:175], v[92:95], v[72:75]
v_mfma_f32_16x16x32_bf16 v[56:59], v[160:163], v[96:99], v[56:59]
v_mfma_f32_16x16x32_bf16 v[72:75], v[176:179], v[96:99], v[72:75]
v_mfma_f32_16x16x32_bf16 v[56:59], v[164:167], v[100:103], v[56:59]
v_mfma_f32_16x16x32_bf16 v[72:75], v[180:183], v[100:103], v[72:75]
v_mfma_f32_16x16x32_bf16 v[60:63], v[152:155], v[104:107], 0
v_mfma_f32_16x16x32_bf16 v[76:79], v[168:171], v[104:107], 0
v_mfma_f32_16x16x32_bf16 v[60:63], v[156:159], v[108:111], v[60:63]
v_mfma_f32_16x16x32_bf16 v[76:79], v[172:175], v[108:111], v[76:79]
s_nop 3
v_cvt_pk_bf16_f32 v184, v56, v72
v_mfma_f32_16x16x32_bf16 v[60:63], v[160:163], v[112:115], v[60:63]
v_cvt_pk_bf16_f32 v185, v57, v73
v_mfma_f32_16x16x32_bf16 v[76:79], v[176:179], v[112:115], v[76:79]
v_cvt_pk_bf16_f32 v186, v58, v74
v_mfma_f32_16x16x32_bf16 v[60:63], v[164:167], v[116:119], v[60:63]
v_cvt_pk_bf16_f32 v187, v59, v75
v_mfma_f32_16x16x32_bf16 v[76:79], v[180:183], v[116:119], v[76:79]
v_or_b32 v184, 1, v184
buffer_store_dwordx4 v[184:187], v6, s[44:47], s84 offen sc1
s_add_u32 s84, s84, 20480
v_mfma_f32_16x16x32_bf16 v[64:67], v[152:155], v[120:123], 0
v_mfma_f32_16x16x32_bf16 v[80:83], v[168:171], v[120:123], 0
v_mfma_f32_16x16x32_bf16 v[64:67], v[156:159], v[124:127], v[64:67]
v_mfma_f32_16x16x32_bf16 v[80:83], v[172:175], v[124:127], v[80:83]
s_nop 0
v_cvt_pk_bf16_f32 v188, v60, v76
v_mfma_f32_16x16x32_bf16 v[64:67], v[160:163], v[128:131], v[64:67]
v_cvt_pk_bf16_f32 v189, v61, v77
v_mfma_f32_16x16x32_bf16 v[80:83], v[176:179], v[128:131], v[80:83]
v_cvt_pk_bf16_f32 v190, v62, v78
v_mfma_f32_16x16x32_bf16 v[64:67], v[164:167], v[132:135], v[64:67]
v_cvt_pk_bf16_f32 v191, v63, v79
v_mfma_f32_16x16x32_bf16 v[80:83], v[180:183], v[132:135], v[80:83]
v_or_b32 v188, 1, v188
buffer_store_dwordx4 v[188:191], v6, s[44:47], s84 offen sc1
s_add_u32 s84, s84, 20480
v_mfma_f32_16x16x32_bf16 v[68:71], v[152:155], v[136:139], 0
v_mfma_f32_16x16x32_bf16 v[84:87], v[168:171], v[136:139], 0
v_mfma_f32_16x16x32_bf16 v[68:71], v[156:159], v[140:143], v[68:71]
v_mfma_f32_16x16x32_bf16 v[84:87], v[172:175], v[140:143], v[84:87]
s_nop 0
v_cvt_pk_bf16_f32 v192, v64, v80
v_mfma_f32_16x16x32_bf16 v[68:71], v[160:163], v[144:147], v[68:71]
v_cvt_pk_bf16_f32 v193, v65, v81
v_mfma_f32_16x16x32_bf16 v[84:87], v[176:179], v[144:147], v[84:87]
v_cvt_pk_bf16_f32 v194, v66, v82
v_mfma_f32_16x16x32_bf16 v[68:71], v[164:167], v[148:151], v[68:71]
v_cvt_pk_bf16_f32 v195, v67, v83
v_mfma_f32_16x16x32_bf16 v[84:87], v[180:183], v[148:151], v[84:87]
v_or_b32 v192, 1, v192
buffer_store_dwordx4 v[192:195], v6, s[44:47], s84 offen sc1
s_add_u32 s84, s84, 20480
s_nop 4
v_cvt_pk_bf16_f32 v196, v68, v84
v_cvt_pk_bf16_f32 v197, v69, v85
v_cvt_pk_bf16_f32 v198, v70, v86
v_cvt_pk_bf16_f32 v199, v71, v87
v_or_b32 v196, 1, v196
buffer_store_dwordx4 v[196:199], v6, s[44:47], s84 offen sc1
s_add_u32 s84, s84, 20480
s_waitcnt vmcnt(0)
s_barrier
s_cmp_eq_u32 s92, 0
s_cbranch_scc1 pf_fin
s_and_b32 s59, s56, 1
s_bfe_u32 s80, s56, 0x10001
s_lshr_b32 s89, s56, 1
s_lshl_b32 s3, s56, 1
s_lshl_b32 s4, s3, 6
v_add_u32 v5, s4, v0
v_mul_u32_u24 v6, 1821, v5
v_lshrrev_b32 v6, 16, v6
v_mul_u32_u24 v7, 36, v6
v_sub_u32 v5, v5, v7
v_lshrrev_b32 v7, 2, v6
v_and_b32 v7, 2, v7
v_xor_b32 v5, v5, v7
v_lshlrev_b32 v5, 4, v5
v_and_b32 v7, 24, v6
v_add_u32 v6, v6, v7
v_mul_u32_u24 v6, 9216, v6
v_add_u32 v2, v5, v6
s_add_u32 s3, s3, 1
s_lshl_b32 s4, s3, 6
v_add_u32 v5, s4, v0
v_mul_u32_u24 v6, 1821, v5
v_lshrrev_b32 v6, 16, v6
v_mul_u32_u24 v7, 36, v6
v_sub_u32 v5, v5, v7
v_lshrrev_b32 v7, 2, v6
v_and_b32 v7, 2, v7
v_xor_b32 v5, v5, v7
v_lshlrev_b32 v5, 4, v5
v_and_b32 v7, 24, v6
v_add_u32 v6, v6, v7
v_mul_u32_u24 v6, 9216, v6
v_add_u32 v3, v5, v6
s_add_u32 s3, s59, 16
s_lshl_b32 s4, s3, 6
v_add_u32 v5, s4, v0
v_mul_u32_u24 v6, 1821, v5
v_lshrrev_b32 v6, 16, v6
v_mul_u32_u24 v7, 36, v6
v_sub_u32 v5, v5, v7
v_lshrrev_b32 v7, 2, v6
v_and_b32 v7, 2, v7
v_xor_b32 v5, v5, v7
v_lshlrev_b32 v5, 4, v5
v_and_b32 v7, 24, v6
v_add_u32 v6, v6, v7
v_mul_u32_u24 v6, 9216, v6
v_add_u32 v4, v5, v6
s_mul_i32 s81, s58, 576
s_lshl_b32 s3, s57, 3
s_add_u32 s3, s3, s56
s_mul_i32 s82, s3, 18432
s_lshl_b32 s84, s56, 10
s_lshl_b32 s83, s56, 11
s_add_u32 s83, s83, 8192
s_mul_i32 s3, s80, 18432
s_lshl_b32 s4, s59, 10
s_add_u32 s3, s3, s4
s_add_u32 s85, s3, 24576
s_mov_b32 s96, 1
buffer_load_dwordx4 v[192:195], v39, s[48:51], s101 offen
buffer_load_dwordx4 v[196:199], v39, s[48:51], s101 offen offset:16
s_mul_i32 s3, s56, 5120
s_add_u32 s3, s3, 16384
s_add_u32 s4, s3, 4096
buffer_load_dwordx4 v[152:155], v1, s[52:55], s3 offen offset:0
buffer_load_dwordx4 v[156:159], v1, s[52:55], s3 offen offset:1024
buffer_load_dwordx4 v[160:163], v1, s[52:55], s3 offen offset:2048
buffer_load_dwordx4 v[164:167], v1, s[52:55], s3 offen offset:3072
buffer_load_dwordx4 v[168:171], v1, s[52:55], s4 offen offset:0
s_cmp_lg_u32 s56, 1
s_cbranch_scc1 pf_rl4
buffer_load_dwordx4 v[200:203], v39, s[48:51], 0 offen offset:1024
buffer_load_dwordx4 v[204:207], v39, s[48:51], 0 offen offset:1040
s_mov_b32 s3, 57344
s_mov_b32 s4, 61440
buffer_load_dwordx4 v[172:175], v1, s[52:55], s3 offen offset:0
buffer_load_dwordx4 v[176:179], v1, s[52:55], s3 offen offset:1024
buffer_load_dwordx4 v[180:183], v1, s[52:55], s3 offen offset:2048
buffer_load_dwordx4 v[184:187], v1, s[52:55], s3 offen offset:3072
buffer_load_dwordx4 v[188:191], v1, s[52:55], s4 offen offset:0
pf_rl4:
s_branch pf_bulk
pf_other:
v_lshrrev_b32 v34, 4, v0
v_and_b32 v35, 15, v0
s_lshl_b32 s3, s56, 4
v_add_u32 v36, s3, v35
v_lshlrev_b32 v36, 4, v36
v_mul_u32_u24 v42, 327680, v34
v_add_u32 v36, v36, v42
s_mul_i32 s100, s99, 1280
s_lshl_b32 s3, s97, 4
v_add_u32 v38, s3, v35
v_lshl_add_u32 v38, v38, 6, s99
v_mul_u32_u24 v39, 1152, v38
v_lshl_add_u32 v39, v34, 5, v39
s_lshl_b32 s101, s56, 7
s_mov_b32 s50, 2359296
s_mov_b32 s51, 0x20000
s_add_u32 s52, s6, 5767168
s_addc_u32 s53, s7, 0
s_mov_b32 s54, 62464
s_mov_b32 s55, 0x20000
s_add_u32 s20, s6, 6291456
s_addc_u32 s21, s7, 0
s_mov_b32 s22, 2359296
s_mov_b32 s23, 0x20000
s_add_u32 s36, s6, 9437184
s_addc_u32 s37, s7, 0
s_mov_b32 s38, 2359296
s_mov_b32 s39, 0x20000
s_add_u32 s28, s6, 12582912
s_addc_u32 s29, s7, 0
s_mov_b32 s30, 327680
s_mov_b32 s31, 0x20000
s_mov_b32 s10, 5308416
s_mov_b32 s11, 0x20000
s_mov_b32 s14, 5308416
s_mov_b32 s15, 0x20000
s_mov_b32 s18, 5308416
s_mov_b32 s19, 0x20000
s_mov_b32 s42, 2359296
s_mov_b32 s43, 0x20000
s_add_u32 s24, s6, 13631488
s_addc_u32 s25, s7, 0
s_mov_b32 s26, 37748736
s_mov_b32 s27, 0x20000
s_bitcmp0_b32 s56, 1
s_cselect_b32 s32, s8, s12
s_cselect_b32 s33, s9, s13
s_mov_b32 s34, 5308416
s_mov_b32 s35, 0x20000
s_cmp_eq_u32 s92, 0
s_cbranch_scc1 pf_nocol
s_cmp_lt_u32 s56, 5
s_cbranch_scc1 pf_rows
pf_nocol:
s_and_b32 s59, s56, 1
s_bfe_u32 s80, s56, 0x10001
s_lshr_b32 s89, s56, 1
s_lshl_b32 s3, s56, 1
s_lshl_b32 s4, s3, 6
v_add_u32 v5, s4, v0
v_mul_u32_u24 v6, 1821, v5
v_lshrrev_b32 v6, 16, v6
v_mul_u32_u24 v7, 36, v6
v_sub_u32 v5, v5, v7
v_lshrrev_b32 v7, 2, v6
v_and_b32 v7, 2, v7
v_xor_b32 v5, v5, v7
v_lshlrev_b32 v5, 4, v5
v_and_b32 v7, 24, v6
v_add_u32 v6, v6, v7
v_mul_u32_u24 v6, 9216, v6
v_add_u32 v2, v5, v6
s_add_u32 s3, s3, 1
s_lshl_b32 s4, s3, 6
v_add_u32 v5, s4, v0
v_mul_u32_u24 v6, 1821, v5
v_lshrrev_b32 v6, 16, v6
v_mul_u32_u24 v7, 36, v6
v_sub_u32 v5, v5, v7
v_lshrrev_b32 v7, 2, v6
v_and_b32 v7, 2, v7
v_xor_b32 v5, v5, v7
v_lshlrev_b32 v5, 4, v5
v_and_b32 v7, 24, v6
v_add_u32 v6, v6, v7
v_mul_u32_u24 v6, 9216, v6
v_add_u32 v3, v5, v6
s_add_u32 s3, s59, 16
s_lshl_b32 s4, s3, 6
v_add_u32 v5, s4, v0
v_mul_u32_u24 v6, 1821, v5
v_lshrrev_b32 v6, 16, v6
v_mul_u32_u24 v7, 36, v6
v_sub_u32 v5, v5, v7
v_lshrrev_b32 v7, 2, v6
v_and_b32 v7, 2, v7
v_xor_b32 v5, v5, v7
v_lshlrev_b32 v5, 4, v5
v_and_b32 v7, 24, v6
v_add_u32 v6, v6, v7
v_mul_u32_u24 v6, 9216, v6
v_add_u32 v4, v5, v6
s_mul_i32 s81, s58, 576
s_lshl_b32 s3, s57, 3
s_add_u32 s3, s3, s56
s_mul_i32 s82, s3, 18432
s_lshl_b32 s84, s56, 10
s_lshl_b32 s83, s56, 11
s_add_u32 s83, s83, 8192
s_mul_i32 s3, s80, 18432
s_lshl_b32 s4, s59, 10
s_add_u32 s3, s3, s4
s_add_u32 s85, s3, 24576
s_mov_b32 s96, 1
s_barrier
s_cmp_eq_u32 s92, 0
s_cbranch_scc1 pf_ib
buffer_load_dwordx4 v[192:195], v39, s[48:51], s101 offen
buffer_load_dwordx4 v[196:199], v39, s[48:51], s101 offen offset:16
s_mul_i32 s3, s56, 5120
s_add_u32 s3, s3, 16384
s_add_u32 s4, s3, 4096
buffer_load_dwordx4 v[152:155], v1, s[52:55], s3 offen offset:0
buffer_load_dwordx4 v[156:159], v1, s[52:55], s3 offen offset:1024
buffer_load_dwordx4 v[160:163], v1, s[52:55], s3 offen offset:2048
buffer_load_dwordx4 v[164:167], v1, s[52:55], s3 offen offset:3072
buffer_load_dwordx4 v[168:171], v1, s[52:55], s4 offen offset:0
s_cmp_lg_u32 s56, 1
s_cbranch_scc1 pf_rl1
buffer_load_dwordx4 v[200:203], v39, s[48:51], 0 offen offset:1024
buffer_load_dwordx4 v[204:207], v39, s[48:51], 0 offen offset:1040
s_mov_b32 s3, 57344
s_mov_b32 s4, 61440
buffer_load_dwordx4 v[172:175], v1, s[52:55], s3 offen offset:0
buffer_load_dwordx4 v[176:179], v1, s[52:55], s3 offen offset:1024
buffer_load_dwordx4 v[180:183], v1, s[52:55], s3 offen offset:2048
buffer_load_dwordx4 v[184:187], v1, s[52:55], s3 offen offset:3072
buffer_load_dwordx4 v[188:191], v1, s[52:55], s4 offen offset:0
pf_rl1:
s_barrier
pf_bulk:
s_branch pf_noA
pf_ib:
s_barrier
s_branch pf_fin
pf_rows:
v_cvt_f32_u32 v42, v38
v_mul_f32 v42, 0x3a000000, v42
v_cvt_f32_u32 v43, v34
v_mul_f32 v43, 4.0, v43
v_mul_f32 v41, v42, v43
v_fmamk_f32 v44, v42, 0x00000000, v41
v_cos_f32 v45, v44
v_sin_f32 v44, v44
s_nop 0
v_cvt_pk_bf16_f32 v80, v45, -v44
v_cvt_pk_bf16_f32 v88, v44, v45
v_fmamk_f32 v44, v42, 0x3f800000, v41
v_cos_f32 v45, v44
v_sin_f32 v44, v44
s_nop 0
v_cvt_pk_bf16_f32 v81, v45, -v44
v_cvt_pk_bf16_f32 v89, v44, v45
v_fmamk_f32 v44, v42, 0x40000000, v41
v_cos_f32 v45, v44
v_sin_f32 v44, v44
s_nop 0
v_cvt_pk_bf16_f32 v82, v45, -v44
v_cvt_pk_bf16_f32 v90, v44, v45
v_fmamk_f32 v44, v42, 0x40400000, v41
v_cos_f32 v45, v44
v_sin_f32 v44, v44
s_nop 0
v_cvt_pk_bf16_f32 v83, v45, -v44
v_cvt_pk_bf16_f32 v91, v44, v45
v_fmamk_f32 v44, v42, 0x41800000, v41
v_cos_f32 v45, v44
v_sin_f32 v44, v44
s_nop 0
v_cvt_pk_bf16_f32 v84, v45, -v44
v_cvt_pk_bf16_f32 v92, v44, v45
v_fmamk_f32 v44, v42, 0x41880000, v41
v_cos_f32 v45, v44
v_sin_f32 v44, v44
s_nop 0
v_cvt_pk_bf16_f32 v85, v45, -v44
v_cvt_pk_bf16_f32 v93, v44, v45
v_fmamk_f32 v44, v42, 0x41900000, v41
v_cos_f32 v45, v44
v_sin_f32 v44, v44
s_nop 0
v_cvt_pk_bf16_f32 v86, v45, -v44
v_cvt_pk_bf16_f32 v94, v44, v45
v_fmamk_f32 v44, v42, 0x41980000, v41
v_cos_f32 v45, v44
v_sin_f32 v44, v44
s_nop 0
v_cvt_pk_bf16_f32 v87, v45, -v44
v_cvt_pk_bf16_f32 v95, v44, v45
s_lshl_b32 s3, s56, 4
v_cvt_f32_u32 v42, s3
v_add_f32 v43, v43, v42
v_mul_f32 v44, 0x3ae38e39, v43
v_cos_f32 v128, v44
v_sin_f32 v132, v44
v_mul_f32 v44, 0x3b638e39, v43
v_cos_f32 v136, v44
v_sin_f32 v140, v44
v_mul_f32 v44, 0x3baaaaab, v43
v_cos_f32 v144, v44
v_sin_f32 v148, v44
v_add_f32 v43, 1.0, v43
v_mul_f32 v44, 0x3ae38e39, v43
v_cos_f32 v129, v44
v_sin_f32 v133, v44
v_mul_f32 v44, 0x3b638e39, v43
v_cos_f32 v137, v44
v_sin_f32 v141, v44
v_mul_f32 v44, 0x3baaaaab, v43
v_cos_f32 v145, v44
v_sin_f32 v149, v44
v_add_f32 v43, 1.0, v43
v_mul_f32 v44, 0x3ae38e39, v43
v_cos_f32 v130, v44
v_sin_f32 v134, v44
v_mul_f32 v44, 0x3b638e39, v43
v_cos_f32 v138, v44
v_sin_f32 v142, v44
v_mul_f32 v44, 0x3baaaaab, v43
v_cos_f32 v146, v44
v_sin_f32 v150, v44
v_add_f32 v43, 1.0, v43
v_mul_f32 v44, 0x3ae38e39, v43
v_cos_f32 v131, v44
v_sin_f32 v135, v44
v_mul_f32 v44, 0x3b638e39, v43
v_cos_f32 v139, v44
v_sin_f32 v143, v44
v_mul_f32 v44, 0x3baaaaab, v43
v_cos_f32 v147, v44
v_sin_f32 v151, v44
v_cmp_le_u32 vcc, 12, v35
s_cmp_eq_u32 s56, 4
s_cselect_b64 vcc, vcc, 0
v_cndmask_b32 v37, 0, 1, vcc
s_barrier
buffer_load_dwordx4 v[192:195], v39, s[48:51], s101 offen
buffer_load_dwordx4 v[196:199], v39, s[48:51], s101 offen offset:16
s_mul_i32 s3, s56, 5120
s_add_u32 s3, s3, 16384
s_add_u32 s4, s3, 4096
buffer_load_dwordx4 v[152:155], v1, s[52:55], s3 offen offset:0
buffer_load_dwordx4 v[156:159], v1, s[52:55], s3 offen offset:1024
buffer_load_dwordx4 v[160:163], v1, s[52:55], s3 offen offset:2048
buffer_load_dwordx4 v[164:167], v1, s[52:55], s3 offen offset:3072
buffer_load_dwordx4 v[168:171], v1, s[52:55], s4 offen offset:0
s_cmp_lg_u32 s56, 1
s_cbranch_scc1 pf_rl3
buffer_load_dwordx4 v[200:203], v39, s[48:51], 0 offen offset:1024
buffer_load_dwordx4 v[204:207], v39, s[48:51], 0 offen offset:1040
s_mov_b32 s3, 57344
s_mov_b32 s4, 61440
buffer_load_dwordx4 v[172:175], v1, s[52:55], s3 offen offset:0
buffer_load_dwordx4 v[176:179], v1, s[52:55], s3 offen offset:1024
buffer_load_dwordx4 v[180:183], v1, s[52:55], s3 offen offset:2048
buffer_load_dwordx4 v[184:187], v1, s[52:55], s3 offen offset:3072
buffer_load_dwordx4 v[188:191], v1, s[52:55], s4 offen offset:0
pf_rl3:
s_barrier
s_and_b32 s3, s56, 3
s_cmp_lg_u32 s3, 0
s_cbranch_scc1 pf_vp
s_setprio 2
pf_vp:
s_add_u32 s3, s100, 0
buffer_load_dwordx4 v[48:51], v36, s[44:47], s3 offen sc1
s_add_u32 s3, s100, 81920
buffer_load_dwordx4 v[52:55], v36, s[44:47], s3 offen sc1
s_add_u32 s3, s100, 163840
buffer_load_dwordx4 v[56:59], v36, s[44:47], s3 offen sc1
s_add_u32 s3, s100, 245760
buffer_load_dwordx4 v[60:63], v36, s[44:47], s3 offen sc1
s_add_u32 s3, s100, 1310720
buffer_load_dwordx4 v[64:67], v36, s[44:47], s3 offen sc1
s_add_u32 s3, s100, 1392640
buffer_load_dwordx4 v[68:71], v36, s[44:47], s3 offen sc1
s_add_u32 s3, s100, 1474560
buffer_load_dwordx4 v[72:75], v36, s[44:47], s3 offen sc1
s_add_u32 s3, s100, 1556480
buffer_load_dwordx4 v[76:79], v36, s[44:47], s3 offen sc1
s_waitcnt vmcnt(6)
v_and_b32 v42, v48, v52
s_waitcnt vmcnt(5)
v_and_b32 v42, v42, v56
s_waitcnt vmcnt(4)
v_and_b32 v42, v42, v60
s_waitcnt vmcnt(3)
v_and_b32 v42, v42, v64
s_waitcnt vmcnt(2)
v_and_b32 v42, v42, v68
s_waitcnt vmcnt(1)
v_and_b32 v42, v42, v72
s_waitcnt vmcnt(0)
v_and_b32 v42, v42, v76
v_or_b32 v42, v42, v37
v_and_b32 v42, 1, v42
v_cmp_eq_u32 vcc, 0, v42
s_cbranch_vccnz pf_v_slow
pf_v_ok:
v_swap_b32 v49, v52
v_swap_b32 v50, v56
v_swap_b32 v51, v60
v_swap_b32 v54, v57
v_swap_b32 v55, v61
v_swap_b32 v59, v62
v_swap_b32 v65, v68
v_swap_b32 v66, v72
v_swap_b32 v67, v76
v_swap_b32 v70, v73
v_swap_b32 v71, v77
v_swap_b32 v75, v78
v_mfma_f32_16x16x32_bf16 v[96:99], v[48:51], v[80:83], 0
v_mfma_f32_16x16x32_bf16 v[100:103], v[48:51], v[88:91], 0
v_mfma_f32_16x16x32_bf16 v[96:99], v[64:67], v[84:87], v[96:99]
v_mfma_f32_16x16x32_bf16 v[100:103], v[64:67], v[92:95], v[100:103]
v_mfma_f32_16x16x32_bf16 v[112:115], v[56:59], v[80:83], 0
v_mfma_f32_16x16x32_bf16 v[116:119], v[56:59], v[88:91], 0
v_mfma_f32_16x16x32_bf16 v[112:115], v[72:75], v[84:87], v[112:115]
v_mfma_f32_16x16x32_bf16 v[116:119], v[72:75], v[92:95], v[116:119]
v_mfma_f32_16x16x32_bf16 v[104:107], v[52:55], v[80:83], 0
v_mfma_f32_16x16x32_bf16 v[108:111], v[52:55], v[88:91], 0
v_mfma_f32_16x16x32_bf16 v[104:107], v[68:71], v[84:87], v[104:107]
v_mfma_f32_16x16x32_bf16 v[108:111], v[68:71], v[92:95], v[108:111]
v_mfma_f32_16x16x32_bf16 v[120:123], v[60:63], v[80:83], 0
v_mfma_f32_16x16x32_bf16 v[124:127], v[60:63], v[88:91], 0
v_mfma_f32_16x16x32_bf16 v[120:123], v[76:79], v[84:87], v[120:123]
v_mfma_f32_16x16x32_bf16 v[124:127], v[76:79], v[92:95], v[124:127]
v_pk_add_f32 v[64:65], v[96:97], v[112:113]
v_pk_add_f32 v[66:67], v[100:101], v[116:117]
s_nop 4
v_pk_add_f32 v[72:73], v[104:105], v[120:121]
v_pk_add_f32 v[74:75], v[108:109], v[124:125]
v_pk_add_f32 v[68:69], v[96:97], v[112:113] neg_lo:[0,1] neg_hi:[0,1]
v_pk_add_f32 v[70:71], v[100:101], v[116:117] neg_lo:[0,1] neg_hi:[0,1]
v_pk_add_f32 v[76:77], v[104:105], v[120:121] neg_lo:[0,1] neg_hi:[0,1]
v_pk_add_f32 v[78:79], v[108:109], v[124:125] neg_lo:[0,1] neg_hi:[0,1]
v_pk_add_f32 v[96:97], v[64:65], v[72:73]
v_pk_add_f32 v[100:101], v[66:67], v[74:75]
v_pk_add_f32 v[104:105], v[68:69], v[78:79] neg_lo:[0,1] neg_hi:[0,1]
v_pk_add_f32 v[108:109], v[70:71], v[76:77]
v_pk_add_f32 v[112:113], v[64:65], v[72:73] neg_lo:[0,1] neg_hi:[0,1]
v_pk_add_f32 v[116:117], v[66:67], v[74:75] neg_lo:[0,1] neg_hi:[0,1]
v_pk_add_f32 v[120:121], v[68:69], v[78:79]
v_pk_add_f32 v[124:125], v[70:71], v[76:77] neg_lo:[0,1] neg_hi:[0,1]
v_cvt_pk_bf16_f32 v48, v96, v100
v_cvt_pk_bf16_f32 v49, v97, v101
v_pk_mul_f32 v[68:69], v[128:129], v[104:105]
v_pk_mul_f32 v[70:71], v[128:129], v[108:109]
v_pk_mul_f32 v[72:73], v[136:137], v[112:113]
v_pk_mul_f32 v[74:75], v[136:137], v[116:117]
v_pk_mul_f32 v[76:77], v[144:145], v[120:121]
v_pk_mul_f32 v[78:79], v[144:145], v[124:125]
v_pk_fma_f32 v[68:69], v[132:133], v[108:109], v[68:69] neg_lo:[1,0,0] neg_hi:[1,0,0]
v_pk_fma_f32 v[70:71], v[132:133], v[104:105], v[70:71]
v_pk_fma_f32 v[72:73], v[140:141], v[116:117], v[72:73] neg_lo:[1,0,0] neg_hi:[1,0,0]
v_pk_fma_f32 v[74:75], v[140:141], v[112:113], v[74:75]
v_pk_fma_f32 v[76:77], v[148:149], v[124:125], v[76:77] neg_lo:[1,0,0] neg_hi:[1,0,0]
v_pk_fma_f32 v[78:79], v[148:149], v[120:121], v[78:79]
v_cvt_pk_bf16_f32 v52, v68, v70
v_cvt_pk_bf16_f32 v53, v69, v71
v_cvt_pk_bf16_f32 v56, v72, v74
v_cvt_pk_bf16_f32 v57, v73, v75
v_cvt_pk_bf16_f32 v60, v76, v78
v_cvt_pk_bf16_f32 v61, v77, v79
v_pk_add_f32 v[64:65], v[98:99], v[114:115]
v_pk_add_f32 v[66:67], v[102:103], v[118:119]
v_pk_add_f32 v[72:73], v[106:107], v[122:123]
v_pk_add_f32 v[74:75], v[110:111], v[126:127]
v_pk_add_f32 v[68:69], v[98:99], v[114:115] neg_lo:[0,1] neg_hi:[0,1]
v_pk_add_f32 v[70:71], v[102:103], v[118:119] neg_lo:[0,1] neg_hi:[0,1]
v_pk_add_f32 v[76:77], v[106:107], v[122:123] neg_lo:[0,1] neg_hi:[0,1]
v_pk_add_f32 v[78:79], v[110:111], v[126:127] neg_lo:[0,1] neg_hi:[0,1]
v_pk_add_f32 v[98:99], v[64:65], v[72:73]
v_pk_add_f32 v[102:103], v[66:67], v[74:75]
v_pk_add_f32 v[106:107], v[68:69], v[78:79] neg_lo:[0,1] neg_hi:[0,1]
v_pk_add_f32 v[110:111], v[70:71], v[76:77]
v_pk_add_f32 v[114:115], v[64:65], v[72:73] neg_lo:[0,1] neg_hi:[0,1]
v_pk_add_f32 v[118:119], v[66:67], v[74:75] neg_lo:[0,1] neg_hi:[0,1]
v_pk_add_f32 v[122:123], v[68:69], v[78:79]
v_pk_add_f32 v[126:127], v[70:71], v[76:77] neg_lo:[0,1] neg_hi:[0,1]
v_cvt_pk_bf16_f32 v50, v98, v102
v_cvt_pk_bf16_f32 v51, v99, v103
v_pk_mul_f32 v[68:69], v[130:131], v[106:107]
v_pk_mul_f32 v[70:71], v[130:131], v[110:111]
v_pk_mul_f32 v[72:73], v[138:139], v[114:115]
v_pk_mul_f32 v[74:75], v[138:139], v[118:119]
v_pk_mul_f32 v[76:77], v[146:147], v[122:123]
v_pk_mul_f32 v[78:79], v[146:147], v[126:127]
v_pk_fma_f32 v[68:69], v[134:135], v[110:111], v[68:69] neg_lo:[1,0,0] neg_hi:[1,0,0]
v_pk_fma_f32 v[70:71], v[134:135], v[106:107], v[70:71]
v_pk_fma_f32 v[72:73], v[142:143], v[118:119], v[72:73] neg_lo:[1,0,0] neg_hi:[1,0,0]
v_pk_fma_f32 v[74:75], v[142:143], v[114:115], v[74:75]
v_pk_fma_f32 v[76:77], v[150:151], v[126:127], v[76:77] neg_lo:[1,0,0] neg_hi:[1,0,0]
v_pk_fma_f32 v[78:79], v[150:151], v[122:123], v[78:79]
v_cvt_pk_bf16_f32 v54, v68, v70
v_cvt_pk_bf16_f32 v55, v69, v71
v_cvt_pk_bf16_f32 v58, v72, v74
v_cvt_pk_bf16_f32 v59, v73, v75
v_cvt_pk_bf16_f32 v62, v76, v78
v_cvt_pk_bf16_f32 v63, v77, v79
s_lshl_b32 s3, s56, 10
s_add_u32 s3, s3, 90112
v_add_u32 v41, s3, v1
ds_write_b128 v41, v[48:51] offset:0
ds_write_b128 v41, v[52:55] offset:5120
ds_write_b128 v41, v[56:59] offset:10240
ds_write_b128 v41, v[60:63] offset:15360
s_setprio 0
s_cmp_eq_u32 s56, 4
s_cbranch_scc1 pf_noA
pf_noA:
v_lshlrev_b32 v47, 6, v35
v_add_u32 v47, 110592, v47
v_lshrrev_b32 v46, 1, v34
v_lshl_add_u32 v46, v46, 2, v47
s_lshl_b32 s3, s56, 3
v_add_u32 v46, s3, v46
v_lshrrev_b32 v37, 1, v35
v_lshlrev_b32 v37, 7, v37
v_and_b32 v42, 1, v35
v_lshl_add_u32 v37, v42, 6, v37
v_lshl_add_u32 v37, v34, 4, v37
v_add_u32 v41, 90112, v1
s_lshl_b32 s3, s99, 1
s_add_u32 s3, s3, s97
s_mul_i32 s4, s3, 18432
s_lshl_b32 s5, s56, 11
s_add_u32 s50, s4, s5
s_add_u32 s100, s4, 16384
s_and_b32 s3, s3, 7
s_lshl_b32 s3, s3, 2
s_lshl_b32 s4, s57, 11
s_add_u32 s101, s3, s4
s_mov_b32 s5, 0xffff0000
s_cmp_eq_u32 s56, 1
s_cbranch_scc1 pf_fin2
s_waitcnt vmcnt(0)
v_lshlrev_b32 v96, 16, v192
v_and_b32 v100, s5, v192
v_lshlrev_b32 v104, 16, v193
v_and_b32 v108, s5, v193
v_lshlrev_b32 v97, 16, v194
v_and_b32 v101, s5, v194
v_lshlrev_b32 v105, 16, v195
v_and_b32 v109, s5, v195
v_lshlrev_b32 v98, 16, v196
v_and_b32 v102, s5, v196
v_lshlrev_b32 v106, 16, v197
v_and_b32 v110, s5, v197
v_lshlrev_b32 v99, 16, v198
v_and_b32 v103, s5, v198
v_lshlrev_b32 v107, 16, v199
v_and_b32 v111, s5, v199
s_waitcnt lgkmcnt(0)
s_barrier
ds_read_b128 v[48:51], v41 offset:0
ds_read_b128 v[52:55], v41 offset:5120
ds_read_b128 v[56:59], v41 offset:10240
ds_read_b128 v[60:63], v41 offset:15360
ds_read_b128 v[64:67], v41 offset:1024
ds_read_b128 v[68:71], v41 offset:6144
ds_read_b128 v[72:75], v41 offset:11264
s_waitcnt lgkmcnt(6)
v_mfma_f32_16x16x32_bf16 v[96:99], v[152:155], v[48:51], v[96:99]
ds_read_b128 v[76:79], v41 offset:16384
s_waitcnt lgkmcnt(6)
v_mfma_f32_16x16x32_bf16 v[100:103], v[152:155], v[52:55], v[100:103]
ds_read_b128 v[48:51], v41 offset:2048
s_waitcnt lgkmcnt(6)
v_mfma_f32_16x16x32_bf16 v[104:107], v[152:155], v[56:59], v[104:107]
ds_read_b128 v[52:55], v41 offset:7168
s_waitcnt lgkmcnt(6)
v_mfma_f32_16x16x32_bf16 v[108:111], v[152:155], v[60:63], v[108:111]
ds_read_b128 v[56:59], v41 offset:12288
s_waitcnt lgkmcnt(6)
v_mfma_f32_16x16x32_bf16 v[96:99], v[156:159], v[64:67], v[96:99]
ds_read_b128 v[60:63], v41 offset:17408
s_waitcnt lgkmcnt(6)
v_mfma_f32_16x16x32_bf16 v[100:103], v[156:159], v[68:71], v[100:103]
ds_read_b128 v[64:67], v41 offset:3072
s_waitcnt lgkmcnt(6)
v_mfma_f32_16x16x32_bf16 v[104:107], v[156:159], v[72:75], v[104:107]
ds_read_b128 v[68:71], v41 offset:8192
s_waitcnt lgkmcnt(6)
v_mfma_f32_16x16x32_bf16 v[108:111], v[156:159], v[76:79], v[108:111]
ds_read_b128 v[72:75], v41 offset:13312
s_waitcnt lgkmcnt(6)
v_mfma_f32_16x16x32_bf16 v[96:99], v[160:163], v[48:51], v[96:99]
ds_read_b128 v[76:79], v41 offset:18432
s_waitcnt lgkmcnt(6)
v_mfma_f32_16x16x32_bf16 v[100:103], v[160:163], v[52:55], v[100:103]
ds_read_b128 v[48:51], v41 offset:4096
s_waitcnt lgkmcnt(6)
v_mfma_f32_16x16x32_bf16 v[104:107], v[160:163], v[56:59], v[104:107]
ds_read_b128 v[52:55], v41 offset:9216
s_waitcnt lgkmcnt(6)
v_mfma_f32_16x16x32_bf16 v[108:111], v[160:163], v[60:63], v[108:111]
ds_read_b128 v[56:59], v41 offset:14336
s_waitcnt lgkmcnt(6)
v_mfma_f32_16x16x32_bf16 v[96:99], v[164:167], v[64:67], v[96:99]
ds_read_b128 v[60:63], v41 offset:19456
s_waitcnt lgkmcnt(6)
v_mfma_f32_16x16x32_bf16 v[100:103], v[164:167], v[68:71], v[100:103]
s_waitcnt lgkmcnt(5)
v_mfma_f32_16x16x32_bf16 v[104:107], v[164:167], v[72:75], v[104:107]
s_waitcnt lgkmcnt(4)
v_mfma_f32_16x16x32_bf16 v[108:111], v[164:167], v[76:79], v[108:111]
s_waitcnt lgkmcnt(3)
v_mfma_f32_16x16x32_bf16 v[96:99], v[168:171], v[48:51], v[96:99]
s_waitcnt lgkmcnt(2)
v_mfma_f32_16x16x32_bf16 v[100:103], v[168:171], v[52:55], v[100:103]
s_waitcnt lgkmcnt(1)
v_mfma_f32_16x16x32_bf16 v[104:107], v[168:171], v[56:59], v[104:107]
s_waitcnt lgkmcnt(0)
v_mfma_f32_16x16x32_bf16 v[108:111], v[168:171], v[60:63], v[108:111]
s_nop 1
v_mov_b64 v[42:43], v[96:97]
v_pk_mul_f32 v[44:45], v[96:97], v[96:97]
v_pk_add_f32 v[42:43], v[42:43], v[98:99]
v_pk_fma_f32 v[44:45], v[98:99], v[98:99], v[44:45]
v_pk_add_f32 v[42:43], v[42:43], v[100:101]
v_pk_fma_f32 v[44:45], v[100:101], v[100:101], v[44:45]
v_pk_add_f32 v[42:43], v[42:43], v[102:103]
v_pk_fma_f32 v[44:45], v[102:103], v[102:103], v[44:45]
v_pk_add_f32 v[42:43], v[42:43], v[104:105]
v_pk_fma_f32 v[44:45], v[104:105], v[104:105], v[44:45]
v_pk_add_f32 v[42:43], v[42:43], v[106:107]
v_pk_fma_f32 v[44:45], v[106:107], v[106:107], v[44:45]
v_pk_add_f32 v[42:43], v[42:43], v[108:109]
v_pk_fma_f32 v[44:45], v[108:109], v[108:109], v[44:45]
v_pk_add_f32 v[42:43], v[42:43], v[110:111]
v_pk_fma_f32 v[44:45], v[110:111], v[110:111], v[44:45]
v_add_f32 v42, v42, v43
v_add_f32 v44, v44, v45
s_nop 1
v_permlane32_swap_b32 v42, v44
v_add_f32 v42, v42, v44
v_mov_b32 v43, v42
s_nop 1
v_permlane16_swap_b32 v42, v43
v_add_f32 v42, v42, v43
ds_write_b32 v46, v42
v_cvt_pk_bf16_f32 v192, v96, v100
v_cvt_pk_bf16_f32 v193, v104, v108
v_cvt_pk_bf16_f32 v194, v97, v101
v_cvt_pk_bf16_f32 v195, v105, v109
v_cvt_pk_bf16_f32 v196, v98, v102
v_cvt_pk_bf16_f32 v197, v106, v110
v_cvt_pk_bf16_f32 v198, v99, v103
v_cvt_pk_bf16_f32 v199, v107, v111
s_waitcnt lgkmcnt(0)
s_barrier
ds_read_b128 v[48:51], v47 offset:0
ds_read_b128 v[52:55], v47 offset:16
ds_read_b128 v[56:59], v47 offset:32
ds_read_b128 v[60:63], v47 offset:48
v_lshl_add_u32 v46, v0, 7, s101
v_mov_b32 v47, 1073741824
v_cmp_gt_u32 vcc, 16, v0
s_nop 1
v_cndmask_b32 v47, v47, v46, vcc
v_mov_b32 v46, 1
s_waitcnt lgkmcnt(3)
v_pk_add_f32 v[48:49], v[48:49], v[50:51]
s_waitcnt lgkmcnt(2)
v_pk_add_f32 v[52:53], v[52:53], v[54:55]
s_waitcnt lgkmcnt(1)
v_pk_add_f32 v[56:57], v[56:57], v[58:59]
s_waitcnt lgkmcnt(0)
v_pk_add_f32 v[60:61], v[60:61], v[62:63]
v_pk_add_f32 v[48:49], v[48:49], v[52:53]
v_pk_add_f32 v[56:57], v[56:57], v[60:61]
v_pk_add_f32 v[48:49], v[48:49], v[56:57]
v_mul_f32 v42, 0x3ae38e39, v48
v_mul_f32 v43, v42, v42
v_fmamk_f32 v44, v49, 0x3ae38e39, v43
v_fma_f32 v44, -2.0, v43, v44
v_max_f32 v44, 0, v44
v_add_f32 v44, 0x3727c5ac, v44
v_rsq_f32 v44, v44
s_nop 0
v_mul_f32 v44, 0x3fb8aa3b, v44
v_mul_f32 v42, -v42, v44
v_mov_b32 v45, v44
v_mov_b32 v43, v42
s_cmp_eq_u32 s56, 0
s_cselect_b32 s4, 0x10001, 0
v_pk_fma_f32 v[96:97], v[96:97], v[44:45], v[42:43]
v_pk_fma_f32 v[98:99], v[98:99], v[44:45], v[42:43]
v_pk_fma_f32 v[100:101], v[100:101], v[44:45], v[42:43]
v_pk_fma_f32 v[102:103], v[102:103], v[44:45], v[42:43]
v_pk_fma_f32 v[104:105], v[104:105], v[44:45], v[42:43]
v_pk_fma_f32 v[106:107], v[106:107], v[44:45], v[42:43]
v_pk_fma_f32 v[108:109], v[108:109], v[44:45], v[42:43]
v_pk_fma_f32 v[110:111], v[110:111], v[44:45], v[42:43]
v_cvt_pk_bf16_f32 v48, v96, v100
v_cvt_pk_bf16_f32 v49, v104, v108
v_cvt_pk_bf16_f32 v50, v97, v101
v_cvt_pk_bf16_f32 v51, v105, v109
buffer_store_dwordx4 v[48:51], v1, s[20:23], s50 offen offset:0 sc1
v_cvt_pk_bf16_f32 v52, v98, v102
v_cvt_pk_bf16_f32 v53, v106, v110
v_cvt_pk_bf16_f32 v54, v99, v103
v_cvt_pk_bf16_f32 v55, v107, v111
buffer_store_dwordx4 v[52:55], v1, s[20:23], s50 offen offset:1024 sc1
pf_fin:
s_cmp_eq_u32 s96, 1
s_cbranch_scc1 pf_sudone
s_and_b32 s59, s56, 1
s_bfe_u32 s80, s56, 0x10001
s_lshr_b32 s89, s56, 1
s_lshl_b32 s3, s56, 1
s_lshl_b32 s4, s3, 6
v_add_u32 v5, s4, v0
v_mul_u32_u24 v6, 1821, v5
v_lshrrev_b32 v6, 16, v6
v_mul_u32_u24 v7, 36, v6
v_sub_u32 v5, v5, v7
v_lshrrev_b32 v7, 2, v6
v_and_b32 v7, 2, v7
v_xor_b32 v5, v5, v7
v_lshlrev_b32 v5, 4, v5
v_and_b32 v7, 24, v6
v_add_u32 v6, v6, v7
v_mul_u32_u24 v6, 9216, v6
v_add_u32 v2, v5, v6
s_add_u32 s3, s3, 1
s_lshl_b32 s4, s3, 6
v_add_u32 v5, s4, v0
v_mul_u32_u24 v6, 1821, v5
v_lshrrev_b32 v6, 16, v6
v_mul_u32_u24 v7, 36, v6
v_sub_u32 v5, v5, v7
v_lshrrev_b32 v7, 2, v6
v_and_b32 v7, 2, v7
v_xor_b32 v5, v5, v7
v_lshlrev_b32 v5, 4, v5
v_and_b32 v7, 24, v6
v_add_u32 v6, v6, v7
v_mul_u32_u24 v6, 9216, v6
v_add_u32 v3, v5, v6
s_add_u32 s3, s59, 16
s_lshl_b32 s4, s3, 6
v_add_u32 v5, s4, v0
v_mul_u32_u24 v6, 1821, v5
v_lshrrev_b32 v6, 16, v6
v_mul_u32_u24 v7, 36, v6
v_sub_u32 v5, v5, v7
v_lshrrev_b32 v7, 2, v6
v_and_b32 v7, 2, v7
v_xor_b32 v5, v5, v7
v_lshlrev_b32 v5, 4, v5
v_and_b32 v7, 24, v6
v_add_u32 v6, v6, v7
v_mul_u32_u24 v6, 9216, v6
v_add_u32 v4, v5, v6
s_mul_i32 s81, s58, 576
s_lshl_b32 s3, s57, 3
s_add_u32 s3, s3, s56
s_mul_i32 s82, s3, 18432
s_lshl_b32 s84, s56, 10
s_lshl_b32 s83, s56, 11
s_add_u32 s83, s83, 8192
s_mul_i32 s3, s80, 18432
s_lshl_b32 s4, s59, 10
s_add_u32 s3, s3, s4
s_add_u32 s85, s3, 24576
pf_sudone:
s_cmp_lg_u32 s92, 0
s_cbranch_scc1 pf_wdone
s_add_u32 m0, s83, 0
s_add_u32 s95, s81, 0
buffer_load_dwordx4 v2, s[8:11], s95 offen  lds
s_add_u32 m0, s83, 1024
s_nop 0
buffer_load_dwordx4 v3, s[8:11], s95 offen  lds
s_add_u32 m0, s83, 18432
s_nop 0
buffer_load_dwordx4 v2, s[12:15], s95 offen  lds
s_add_u32 m0, s83, 19456
s_nop 0
buffer_load_dwordx4 v3, s[12:15], s95 offen  lds
s_cmp_lt_u32 s56, 4
s_cbranch_scc1 pf_wc0
s_add_u32 m0, s85, 0
s_nop 0
buffer_load_dwordx4 v4, s[32:35], s95 offen  lds
pf_wc0:
s_add_u32 m0, s83, 45056
s_add_u32 s95, s81, 73728
buffer_load_dwordx4 v2, s[8:11], s95 offen  lds
s_add_u32 m0, s83, 46080
s_nop 0
buffer_load_dwordx4 v3, s[8:11], s95 offen  lds
s_add_u32 m0, s83, 63488
s_nop 0
buffer_load_dwordx4 v2, s[12:15], s95 offen  lds
s_add_u32 m0, s83, 64512
s_nop 0
buffer_load_dwordx4 v3, s[12:15], s95 offen  lds
s_cmp_lt_u32 s56, 4
s_cbranch_scc1 pf_wc1
s_add_u32 m0, s85, 45056
s_nop 0
buffer_load_dwordx4 v4, s[32:35], s95 offen  lds
pf_wc1:
pf_wdone:
s_cmp_eq_u32 s97, 0
s_cselect_b32 s44, s8, s12
s_cselect_b32 s45, s9, s13
s_mov_b32 s46, 5308416
s_mov_b32 s47, 0x20000
s_and_b32 s3, s56, 3
s_mul_i32 s3, s3, 5
v_add_u32 v31, s3, v0
v_cmp_lt_u32 vcc, 8, v31
s_nop 1
v_cndmask_b32 v5, 0, 1, vcc
v_mul_u32_u24 v6, 9, v5
v_sub_u32 v6, v31, v6
s_lshr_b32 s3, s56, 2
s_xor_b32 s3, s3, 1
s_xor_b32 s3, s3, s57
s_lshl_b32 s3, s3, 1
v_add_u32 v5, s3, v5
v_and_b32 v7, 24, v5
v_add_u32 v5, v5, v7
v_mul_u32_u24 v5, 9216, v5
v_lshl_add_u32 v5, v6, 7, v5
s_mul_i32 s3, s98, 1152
v_add_u32 v5, s3, v5
v_mov_b32 v6, 1073741824
v_cmp_gt_u32 vcc, 18, v31
s_nop 1
v_cndmask_b32 v5, v6, v5, vcc
v_cmp_gt_u32 vcc, 5, v0
s_nop 1
v_cndmask_b32 v31, v6, v5, vcc
s_cmp_eq_u32 s92, 0
s_cbranch_scc1 pf_p3done
s_waitcnt vmcnt(0)
s_barrier
s_cmp_lg_u32 s56, 0
s_cbranch_scc1 pf_p3sig
buffer_store_dword v46, v47, s[28:31], 0 offen sc1
pf_p3sig:
s_add_u32 m0, s83, 0
s_add_u32 s95, s81, 0
buffer_load_dwordx4 v2, s[8:11], s95 offen  lds
s_add_u32 m0, s83, 1024
s_nop 0
buffer_load_dwordx4 v3, s[8:11], s95 offen  lds
s_add_u32 m0, s83, 18432
s_nop 0
buffer_load_dwordx4 v2, s[12:15], s95 offen  lds
s_add_u32 m0, s83, 19456
s_nop 0
buffer_load_dwordx4 v3, s[12:15], s95 offen  lds
s_cmp_lt_u32 s56, 4
s_cbranch_scc1 pf_wd0
s_add_u32 m0, s85, 0
s_nop 0
buffer_load_dwordx4 v4, s[32:35], s95 offen  lds
pf_wd0:
s_add_u32 m0, s83, 45056
s_add_u32 s95, s81, 73728
buffer_load_dwordx4 v2, s[8:11], s95 offen  lds
s_add_u32 m0, s83, 46080
s_nop 0
buffer_load_dwordx4 v3, s[8:11], s95 offen  lds
s_add_u32 m0, s83, 63488
s_nop 0
buffer_load_dwordx4 v2, s[12:15], s95 offen  lds
s_add_u32 m0, s83, 64512
s_nop 0
buffer_load_dwordx4 v3, s[12:15], s95 offen  lds
s_cmp_lt_u32 s56, 4
s_cbranch_scc1 pf_wd1
s_add_u32 m0, s85, 45056
s_nop 0
buffer_load_dwordx4 v4, s[32:35], s95 offen  lds
pf_wd1:
pf_p3done:
s_cmp_ge_u32 s56, 4
s_cbranch_scc1 pf_p4
s_lshl_b32 s3, s57, 4
s_add_u32 s3, s3, s58
s_lshl_b32 s3, s3, 7
s_lshl_b32 s4, s56, 2
s_add_u32 s91, s3, s4
s_add_u32 s93, s91, 0
buffer_load_dword v27, v26, s[28:31], s93 offen sc1
v_lshrrev_b32 v5, 4, v0
v_bfe_u32 v6, v0, 2, 2
v_lshl_add_u32 v7, v5, 3, v6
v_mul_u32_u24 v7, 576, v7
v_and_b32 v14, 3, v0
v_lshl_add_u32 v7, v14, 3, v7
s_mul_i32 s3, s80, 9
s_add_u32 s3, s3, 0
s_lshl_b32 s4, s3, 5
s_add_u32 s4, s4, 8192
v_add_u32 v7, s4, v7
s_and_b32 s3, s3, 1
s_cmp_eq_u32 s3, 0
s_cselect_b32 s3, 32, -32
v_and_b32 v14, 1, v5
v_mul_i32_i24 v14, s3, v14
v_add_u32 v11, v7, v14
v_sub_u32 v14, v7, v14
s_lshl_b32 s3, s59, 12
s_add_u32 s3, s3, 0
v_add_u32 v8, s3, v1
v_add_u32 v9, 45056, v8
v_add_u32 v12, 45056, v11
v_add_u32 v15, 45056, v14
v_add_u32 v10, 90112, v8
v_add_u32 v13, 90112, v11
v_add_u32 v16, 90112, v14
v_lshrrev_b32 v17, 3, v0
v_mul_u32_u24 v17, 1152, v17
v_bfe_u32 v7, v0, 1, 2
v_xor_b32 v7, v7, v5
v_lshl_add_u32 v17, v7, 5, v17
v_and_b32 v7, 1, v0
v_lshl_add_u32 v17, v7, 4, v17
s_mul_i32 s3, s56, 4
s_sub_u32 s3, s3, 0
s_lshl_b32 s87, s3, 10
s_mul_i32 s3, s3, 9216
s_mul_i32 s86, s58, 331776
s_add_u32 s86, s86, s3
v_lshl_add_u32 v20, v5, 2, v6
v_bfe_u32 v7, v20, 1, 2
v_xor_b32 v7, s89, v7
v_lshlrev_b32 v7, 5, v7
v_lshl_add_u32 v20, v20, 7, v7
v_and_b32 v7, 3, v0
v_lshl_add_u32 v20, v7, 3, v20
v_add_u32 v21, 36864, v20
v_add_u32 v22, 90112, v20
v_add_u32 v23, 126976, v20
v_add_u32 v20, 0, v20
s_xor_b32 s3, s59, 0
s_mul_i32 s3, s3, 36864
s_add_u32 s3, s3, 90112
v_add_u32 v24, s3, v1
s_mul_i32 s3, s59, 36864
s_add_u32 s3, s3, 90112
s_mul_i32 s4, s80, 9
s_add_u32 s4, s4, 0
s_lshr_b32 s5, s4, 1
s_lshl_b32 s5, s5, 10
s_add_u32 s3, s3, s5
s_and_b32 s4, s4, 1
s_lshl_b32 s5, s4, 3
s_add_u32 s5, s5, s3
v_add_u32 v19, s5, v1
s_mul_i32 s5, s4, 1024
s_add_u32 s5, s5, s3
s_xor_b32 s4, s4, 1
s_lshl_b32 s4, s4, 3
s_add_u32 s5, s5, s4
v_add_u32 v25, s5, v1
v_bfe_u32 v7, v0, 1, 3
v_lshlrev_b32 v18, 10, v7
v_and_b32 v7, 1, v0
v_lshl_add_u32 v18, v7, 6, v18
v_lshl_add_u32 v18, v5, 4, v18
s_mul_i32 s90, s57, 2359296
s_mul_i32 s3, s58, 147456
s_add_u32 s88, s90, s3
s_lshl_b32 s4, s59, 13
s_add_u32 s88, s88, s4
s_lshl_b32 s4, s89, 8
s_add_u32 s88, s88, s4
s_cmp_lg_u32 s92, 0
s_cbranch_scc1 pf_aip
s_mov_b32 s94, 589824
buffer_load_dword v28, v31, s[44:47], s94 offen
s_mov_b32 s94, 663552
buffer_load_dword v28, v31, s[44:47], s94 offen
pf_aip:
s_waitcnt vmcnt(0)
v_cmp_eq_u32 vcc, 0, v27
s_cbranch_vccnz pf_ax_slow
pf_ax_ok:
s_add_u32 m0, s84, 0
s_add_u32 s94, s82, 0
buffer_load_dwordx4 v1, s[20:23], s94 offen sc1 lds
s_add_u32 m0, s84, 45056
s_add_u32 s94, s82, 1024
buffer_load_dwordx4 v1, s[20:23], s94 offen sc1 lds
s_waitcnt vmcnt(1)
s_cmp_eq_u32 s92, 0
s_cbranch_scc1 pf_ahl
buffer_store_dwordx4 v[192:195], v37, s[36:39], s50 offen offset:0 sc1
buffer_store_dwordx4 v[196:199], v37, s[36:39], s50 offen offset:1024 sc1
s_cmp_lg_u32 s56, 1
s_cbranch_scc1 pf_ahl
buffer_store_dwordx4 v[200:203], v37, s[36:39], s100 offen offset:0 sc1
buffer_store_dwordx4 v[204:207], v37, s[36:39], s100 offen offset:1024 sc1
pf_ahl:
s_barrier
ds_read_b128 v[64:67], v8 offset:0
ds_read_b128 v[68:71], v8 offset:1024
ds_read_b128 v[72:75], v8 offset:2048
ds_read_b128 v[76:79], v8 offset:3072
ds_read_b64_tr_b16 v[32:33], v11 offset:0
ds_read_b64_tr_b16 v[34:35], v11 offset:2304
ds_read_b64_tr_b16 v[36:37], v11 offset:18432
ds_read_b64_tr_b16 v[38:39], v11 offset:20736
ds_read_b64_tr_b16 v[40:41], v14 offset:32
ds_read_b64_tr_b16 v[42:43], v14 offset:2336
s_waitcnt lgkmcnt(4)
v_mfma_f32_16x16x32_bf16 v[96:99], v[32:35], v[64:67], 0
v_mfma_f32_16x16x32_bf16 v[100:103], v[32:35], v[68:71], 0
s_add_u32 m0, s84, 90112
s_add_u32 s94, s82, 2048
ds_read_b64_tr_b16 v[44:45], v14 offset:18464
v_mfma_f32_16x16x32_bf16 v[104:107], v[32:35], v[72:75], 0
buffer_load_dwordx4 v1, s[20:23], s94 offen sc1 lds
v_mfma_f32_16x16x32_bf16 v[108:111], v[32:35], v[76:79], 0
ds_read_b64_tr_b16 v[46:47], v14 offset:20768
s_waitcnt lgkmcnt(4)
v_mfma_f32_16x16x32_bf16 v[112:115], v[36:39], v[64:67], 0
s_add_u32 m0, s83, 90112
s_add_u32 s95, s81, 589824
v_mfma_f32_16x16x32_bf16 v[116:119], v[36:39], v[68:71], 0
buffer_load_dwordx4 v2, s[8:11], s95 offen  lds
ds_read_b64_tr_b16 v[48:49], v11 offset:64
v_mfma_f32_16x16x32_bf16 v[120:123], v[36:39], v[72:75], 0
v_mfma_f32_16x16x32_bf16 v[124:127], v[36:39], v[76:79], 0
s_add_u32 m0, s83, 91136
ds_read_b64_tr_b16 v[50:51], v11 offset:2368
s_waitcnt lgkmcnt(4)
v_mfma_f32_16x16x32_bf16 v[128:131], v[40:43], v[64:67], 0
buffer_load_dwordx4 v3, s[8:11], s95 offen  lds
v_mfma_f32_16x16x32_bf16 v[132:135], v[40:43], v[68:71], 0
ds_read_b64_tr_b16 v[52:53], v11 offset:18496
v_mfma_f32_16x16x32_bf16 v[136:139], v[40:43], v[72:75], 0
s_add_u32 m0, s83, 108544
v_mfma_f32_16x16x32_bf16 v[140:143], v[40:43], v[76:79], 0
buffer_load_dwordx4 v2, s[12:15], s95 offen  lds
ds_read_b64_tr_b16 v[54:55], v11 offset:20800
s_waitcnt lgkmcnt(4)
v_mfma_f32_16x16x32_bf16 v[144:147], v[44:47], v[64:67], 0
v_mfma_f32_16x16x32_bf16 v[148:151], v[44:47], v[68:71], 0
s_add_u32 m0, s83, 109568
ds_read_b64_tr_b16 v[56:57], v14 offset:96
v_mfma_f32_16x16x32_bf16 v[152:155], v[44:47], v[72:75], 0
buffer_load_dwordx4 v3, s[12:15], s95 offen  lds
v_mfma_f32_16x16x32_bf16 v[156:159], v[44:47], v[76:79], 0
ds_read_b64_tr_b16 v[58:59], v14 offset:2400
s_waitcnt lgkmcnt(4)
v_mfma_f32_16x16x32_bf16 v[160:163], v[48:51], v[64:67], 0
v_mfma_f32_16x16x32_bf16 v[164:167], v[48:51], v[68:71], 0
ds_read_b64_tr_b16 v[60:61], v14 offset:18528
v_mfma_f32_16x16x32_bf16 v[168:171], v[48:51], v[72:75], 0
v_mfma_f32_16x16x32_bf16 v[172:175], v[48:51], v[76:79], 0
ds_read_b64_tr_b16 v[62:63], v14 offset:20832
s_waitcnt lgkmcnt(4)
v_mfma_f32_16x16x32_bf16 v[176:179], v[52:55], v[64:67], 0
v_mfma_f32_16x16x32_bf16 v[180:183], v[52:55], v[68:71], 0
ds_read_b64_tr_b16 v[32:33], v11 offset:128
v_mfma_f32_16x16x32_bf16 v[184:187], v[52:55], v[72:75], 0
v_mfma_f32_16x16x32_bf16 v[188:191], v[52:55], v[76:79], 0
ds_read_b64_tr_b16 v[34:35], v11 offset:2432
s_waitcnt lgkmcnt(4)
v_mfma_f32_16x16x32_bf16 v[192:195], v[56:59], v[64:67], 0
v_mfma_f32_16x16x32_bf16 v[196:199], v[56:59], v[68:71], 0
ds_read_b64_tr_b16 v[36:37], v11 offset:18560
v_mfma_f32_16x16x32_bf16 v[200:203], v[56:59], v[72:75], 0
v_mfma_f32_16x16x32_bf16 v[204:207], v[56:59], v[76:79], 0
ds_read_b64_tr_b16 v[38:39], v11 offset:20864
s_waitcnt lgkmcnt(4)
v_mfma_f32_16x16x32_bf16 v[208:211], v[60:63], v[64:67], 0
v_mfma_f32_16x16x32_bf16 v[212:215], v[60:63], v[68:71], 0
v_mfma_f32_16x16x32_bf16 v[216:219], v[60:63], v[72:75], 0
v_mfma_f32_16x16x32_bf16 v[220:223], v[60:63], v[76:79], 0
s_waitcnt lgkmcnt(0)
s_waitcnt vmcnt(5)
s_barrier
ds_read_b128 v[80:83], v9 offset:0
ds_read_b128 v[84:87], v9 offset:1024
ds_read_b128 v[88:91], v9 offset:2048
ds_read_b128 v[92:95], v9 offset:3072
ds_read_b64_tr_b16 v[40:41], v12 offset:0
ds_read_b64_tr_b16 v[42:43], v12 offset:2304
ds_read_b64_tr_b16 v[44:45], v12 offset:18432
ds_read_b64_tr_b16 v[46:47], v12 offset:20736
ds_read_b64_tr_b16 v[48:49], v15 offset:32
ds_read_b64_tr_b16 v[50:51], v15 offset:2336
v_mfma_f32_16x16x32_bf16 v[224:227], v[32:35], v[64:67], 0
v_mfma_f32_16x16x32_bf16 v[228:231], v[32:35], v[68:71], 0
s_add_u32 m0, s84, 0
s_add_u32 s94, s82, 3072
v_mfma_f32_16x16x32_bf16 v[232:235], v[32:35], v[72:75], 0
buffer_load_dwordx4 v1, s[20:23], s94 offen sc1 lds
v_mfma_f32_16x16x32_bf16 v[236:239], v[32:35], v[76:79], 0
v_mfma_f32_16x16x32_bf16 v[240:243], v[36:39], v[64:67], 0
s_add_u32 m0, s83, 0
s_add_u32 s95, s81, 663552
v_mfma_f32_16x16x32_bf16 v[244:247], v[36:39], v[68:71], 0
buffer_load_dwordx4 v2, s[8:11], s95 offen  lds
v_mfma_f32_16x16x32_bf16 v[248:251], v[36:39], v[72:75], 0
v_mfma_f32_16x16x32_bf16 v[252:255], v[36:39], v[76:79], 0
s_add_u32 m0, s83, 1024
s_waitcnt lgkmcnt(4)
v_mfma_f32_16x16x32_bf16 v[96:99], v[40:43], v[80:83], v[96:99]
buffer_load_dwordx4 v3, s[8:11], s95 offen  lds
v_mfma_f32_16x16x32_bf16 v[100:103], v[40:43], v[84:87], v[100:103]
ds_read_b64_tr_b16 v[52:53], v15 offset:18464
v_mfma_f32_16x16x32_bf16 v[104:107], v[40:43], v[88:91], v[104:107]
s_add_u32 m0, s83, 18432
v_mfma_f32_16x16x32_bf16 v[108:111], v[40:43], v[92:95], v[108:111]
buffer_load_dwordx4 v2, s[12:15], s95 offen  lds
ds_read_b64_tr_b16 v[54:55], v15 offset:20768
s_waitcnt lgkmcnt(4)
v_mfma_f32_16x16x32_bf16 v[112:115], v[44:47], v[80:83], v[112:115]
v_mfma_f32_16x16x32_bf16 v[116:119], v[44:47], v[84:87], v[116:119]
s_add_u32 m0, s83, 19456
ds_read_b64_tr_b16 v[56:57], v12 offset:64
v_mfma_f32_16x16x32_bf16 v[120:123], v[44:47], v[88:91], v[120:123]
buffer_load_dwordx4 v3, s[12:15], s95 offen  lds
v_mfma_f32_16x16x32_bf16 v[124:127], v[44:47], v[92:95], v[124:127]
ds_read_b64_tr_b16 v[58:59], v12 offset:2368
s_waitcnt lgkmcnt(4)
v_mfma_f32_16x16x32_bf16 v[128:131], v[48:51], v[80:83], v[128:131]
v_mfma_f32_16x16x32_bf16 v[132:135], v[48:51], v[84:87], v[132:135]
ds_read_b64_tr_b16 v[60:61], v12 offset:18496
v_mfma_f32_16x16x32_bf16 v[136:139], v[48:51], v[88:91], v[136:139]
v_mfma_f32_16x16x32_bf16 v[140:143], v[48:51], v[92:95], v[140:143]
ds_read_b64_tr_b16 v[62:63], v12 offset:20800
s_waitcnt lgkmcnt(4)
v_mfma_f32_16x16x32_bf16 v[144:147], v[52:55], v[80:83], v[144:147]
v_mfma_f32_16x16x32_bf16 v[148:151], v[52:55], v[84:87], v[148:151]
ds_read_b64_tr_b16 v[32:33], v15 offset:96
v_mfma_f32_16x16x32_bf16 v[152:155], v[52:55], v[88:91], v[152:155]
v_mfma_f32_16x16x32_bf16 v[156:159], v[52:55], v[92:95], v[156:159]
ds_read_b64_tr_b16 v[34:35], v15 offset:2400
s_waitcnt lgkmcnt(4)
v_mfma_f32_16x16x32_bf16 v[160:163], v[56:59], v[80:83], v[160:163]
v_mfma_f32_16x16x32_bf16 v[164:167], v[56:59], v[84:87], v[164:167]
ds_read_b64_tr_b16 v[36:37], v15 offset:18528
v_mfma_f32_16x16x32_bf16 v[168:171], v[56:59], v[88:91], v[168:171]
v_mfma_f32_16x16x32_bf16 v[172:175], v[56:59], v[92:95], v[172:175]
ds_read_b64_tr_b16 v[38:39], v15 offset:20832
s_waitcnt lgkmcnt(4)
v_mfma_f32_16x16x32_bf16 v[176:179], v[60:63], v[80:83], v[176:179]
v_mfma_f32_16x16x32_bf16 v[180:183], v[60:63], v[84:87], v[180:183]
ds_read_b64_tr_b16 v[40:41], v12 offset:128
v_mfma_f32_16x16x32_bf16 v[184:187], v[60:63], v[88:91], v[184:187]
v_mfma_f32_16x16x32_bf16 v[188:191], v[60:63], v[92:95], v[188:191]
ds_read_b64_tr_b16 v[42:43], v12 offset:2432
s_waitcnt lgkmcnt(4)
v_mfma_f32_16x16x32_bf16 v[192:195], v[32:35], v[80:83], v[192:195]
v_mfma_f32_16x16x32_bf16 v[196:199], v[32:35], v[84:87], v[196:199]
ds_read_b64_tr_b16 v[44:45], v12 offset:18560
v_mfma_f32_16x16x32_bf16 v[200:203], v[32:35], v[88:91], v[200:203]
v_mfma_f32_16x16x32_bf16 v[204:207], v[32:35], v[92:95], v[204:207]
ds_read_b64_tr_b16 v[46:47], v12 offset:20864
s_waitcnt lgkmcnt(4)
v_mfma_f32_16x16x32_bf16 v[208:211], v[36:39], v[80:83], v[208:211]
v_mfma_f32_16x16x32_bf16 v[212:215], v[36:39], v[84:87], v[212:215]
v_mfma_f32_16x16x32_bf16 v[216:219], v[36:39], v[88:91], v[216:219]
v_mfma_f32_16x16x32_bf16 v[220:223], v[36:39], v[92:95], v[220:223]
s_waitcnt lgkmcnt(0)
s_waitcnt vmcnt(5)
s_barrier
ds_read_b128 v[64:67], v10 offset:0
ds_read_b128 v[68:71], v10 offset:1024
ds_read_b128 v[72:75], v10 offset:2048
ds_read_b128 v[76:79], v10 offset:3072
ds_read_b64_tr_b16 v[48:49], v13 offset:0
ds_read_b64_tr_b16 v[50:51], v13 offset:2304
ds_read_b64_tr_b16 v[52:53], v13 offset:18432
ds_read_b64_tr_b16 v[54:55], v13 offset:20736
ds_read_b64_tr_b16 v[56:57], v16 offset:32
ds_read_b64_tr_b16 v[58:59], v16 offset:2336
v_mfma_f32_16x16x32_bf16 v[224:227], v[40:43], v[80:83], v[224:227]
v_mfma_f32_16x16x32_bf16 v[228:231], v[40:43], v[84:87], v[228:231]
s_add_u32 m0, s84, 45056
s_add_u32 s94, s82, 4096
v_mfma_f32_16x16x32_bf16 v[232:235], v[40:43], v[88:91], v[232:235]
buffer_load_dwordx4 v1, s[20:23], s94 offen sc1 lds
v_mfma_f32_16x16x32_bf16 v[236:239], v[40:43], v[92:95], v[236:239]
v_mfma_f32_16x16x32_bf16 v[240:243], v[44:47], v[80:83], v[240:243]
s_add_u32 m0, s83, 45056
s_add_u32 s95, s81, 1179648
v_mfma_f32_16x16x32_bf16 v[244:247], v[44:47], v[84:87], v[244:247]
buffer_load_dwordx4 v2, s[8:11], s95 offen  lds
v_mfma_f32_16x16x32_bf16 v[248:251], v[44:47], v[88:91], v[248:251]
v_mfma_f32_16x16x32_bf16 v[252:255], v[44:47], v[92:95], v[252:255]
s_add_u32 m0, s83, 46080
s_waitcnt lgkmcnt(4)
v_mfma_f32_16x16x32_bf16 v[96:99], v[48:51], v[64:67], v[96:99]
buffer_load_dwordx4 v3, s[8:11], s95 offen  lds
v_mfma_f32_16x16x32_bf16 v[100:103], v[48:51], v[68:71], v[100:103]
ds_read_b64_tr_b16 v[60:61], v16 offset:18464
v_mfma_f32_16x16x32_bf16 v[104:107], v[48:51], v[72:75], v[104:107]
s_add_u32 m0, s83, 63488
v_mfma_f32_16x16x32_bf16 v[108:111], v[48:51], v[76:79], v[108:111]
buffer_load_dwordx4 v2, s[12:15], s95 offen  lds
ds_read_b64_tr_b16 v[62:63], v16 offset:20768
s_waitcnt lgkmcnt(4)
v_mfma_f32_16x16x32_bf16 v[112:115], v[52:55], v[64:67], v[112:115]
v_mfma_f32_16x16x32_bf16 v[116:119], v[52:55], v[68:71], v[116:119]
s_add_u32 m0, s83, 64512
ds_read_b64_tr_b16 v[32:33], v13 offset:64
v_mfma_f32_16x16x32_bf16 v[120:123], v[52:55], v[72:75], v[120:123]
buffer_load_dwordx4 v3, s[12:15], s95 offen  lds
v_mfma_f32_16x16x32_bf16 v[124:127], v[52:55], v[76:79], v[124:127]
ds_read_b64_tr_b16 v[34:35], v13 offset:2368
s_waitcnt lgkmcnt(4)
v_mfma_f32_16x16x32_bf16 v[128:131], v[56:59], v[64:67], v[128:131]
v_mfma_f32_16x16x32_bf16 v[132:135], v[56:59], v[68:71], v[132:135]
ds_read_b64_tr_b16 v[36:37], v13 offset:18496
v_mfma_f32_16x16x32_bf16 v[136:139], v[56:59], v[72:75], v[136:139]
v_mfma_f32_16x16x32_bf16 v[140:143], v[56:59], v[76:79], v[140:143]
ds_read_b64_tr_b16 v[38:39], v13 offset:20800
s_waitcnt lgkmcnt(4)
v_mfma_f32_16x16x32_bf16 v[144:147], v[60:63], v[64:67], v[144:147]
v_mfma_f32_16x16x32_bf16 v[148:151], v[60:63], v[68:71], v[148:151]
ds_read_b64_tr_b16 v[40:41], v16 offset:96
v_mfma_f32_16x16x32_bf16 v[152:155], v[60:63], v[72:75], v[152:155]
v_mfma_f32_16x16x32_bf16 v[156:159], v[60:63], v[76:79], v[156:159]
ds_read_b64_tr_b16 v[42:43], v16 offset:2400
s_waitcnt lgkmcnt(4)
v_mfma_f32_16x16x32_bf16 v[160:163], v[32:35], v[64:67], v[160:163]
v_mfma_f32_16x16x32_bf16 v[164:167], v[32:35], v[68:71], v[164:167]
ds_read_b64_tr_b16 v[44:45], v16 offset:18528
v_mfma_f32_16x16x32_bf16 v[168:171], v[32:35], v[72:75], v[168:171]
v_mfma_f32_16x16x32_bf16 v[172:175], v[32:35], v[76:79], v[172:175]
ds_read_b64_tr_b16 v[46:47], v16 offset:20832
s_waitcnt lgkmcnt(4)
v_mfma_f32_16x16x32_bf16 v[176:179], v[36:39], v[64:67], v[176:179]
v_mfma_f32_16x16x32_bf16 v[180:183], v[36:39], v[68:71], v[180:183]
ds_read_b64_tr_b16 v[48:49], v13 offset:128
v_mfma_f32_16x16x32_bf16 v[184:187], v[36:39], v[72:75], v[184:187]
v_mfma_f32_16x16x32_bf16 v[188:191], v[36:39], v[76:79], v[188:191]
ds_read_b64_tr_b16 v[50:51], v13 offset:2432
s_waitcnt lgkmcnt(4)
v_mfma_f32_16x16x32_bf16 v[192:195], v[40:43], v[64:67], v[192:195]
v_mfma_f32_16x16x32_bf16 v[196:199], v[40:43], v[68:71], v[196:199]
ds_read_b64_tr_b16 v[52:53], v13 offset:18560
v_mfma_f32_16x16x32_bf16 v[200:203], v[40:43], v[72:75], v[200:203]
v_mfma_f32_16x16x32_bf16 v[204:207], v[40:43], v[76:79], v[204:207]
ds_read_b64_tr_b16 v[54:55], v13 offset:20864
s_waitcnt lgkmcnt(4)
v_mfma_f32_16x16x32_bf16 v[208:211], v[44:47], v[64:67], v[208:211]
v_mfma_f32_16x16x32_bf16 v[212:215], v[44:47], v[68:71], v[212:215]
v_mfma_f32_16x16x32_bf16 v[216:219], v[44:47], v[72:75], v[216:219]
v_mfma_f32_16x16x32_bf16 v[220:223], v[44:47], v[76:79], v[220:223]
s_waitcnt lgkmcnt(0)
s_waitcnt vmcnt(5)
s_barrier
ds_read_b128 v[80:83], v8 offset:0
ds_read_b128 v[84:87], v8 offset:1024
ds_read_b128 v[88:91], v8 offset:2048
ds_read_b128 v[92:95], v8 offset:3072
ds_read_b64_tr_b16 v[56:57], v11 offset:0
ds_read_b64_tr_b16 v[58:59], v11 offset:2304
ds_read_b64_tr_b16 v[60:61], v11 offset:18432
ds_read_b64_tr_b16 v[62:63], v11 offset:20736
ds_read_b64_tr_b16 v[32:33], v14 offset:32
ds_read_b64_tr_b16 v[34:35], v14 offset:2336
v_mfma_f32_16x16x32_bf16 v[224:227], v[48:51], v[64:67], v[224:227]
v_mfma_f32_16x16x32_bf16 v[228:231], v[48:51], v[68:71], v[228:231]
s_add_u32 m0, s84, 90112
s_add_u32 s94, s82, 5120
v_mfma_f32_16x16x32_bf16 v[232:235], v[48:51], v[72:75], v[232:235]
buffer_load_dwordx4 v1, s[20:23], s94 offen sc1 lds
v_mfma_f32_16x16x32_bf16 v[236:239], v[48:51], v[76:79], v[236:239]
v_mfma_f32_16x16x32_bf16 v[240:243], v[52:55], v[64:67], v[240:243]
s_add_u32 m0, s83, 90112
s_add_u32 s95, s81, 1253376
v_mfma_f32_16x16x32_bf16 v[244:247], v[52:55], v[68:71], v[244:247]
buffer_load_dwordx4 v2, s[8:11], s95 offen  lds
v_mfma_f32_16x16x32_bf16 v[248:251], v[52:55], v[72:75], v[248:251]
v_mfma_f32_16x16x32_bf16 v[252:255], v[52:55], v[76:79], v[252:255]
s_add_u32 m0, s83, 91136
s_waitcnt lgkmcnt(4)
v_mfma_f32_16x16x32_bf16 v[96:99], v[56:59], v[80:83], v[96:99]
buffer_load_dwordx4 v3, s[8:11], s95 offen  lds
v_mfma_f32_16x16x32_bf16 v[100:103], v[56:59], v[84:87], v[100:103]
ds_read_b64_tr_b16 v[36:37], v14 offset:18464
v_mfma_f32_16x16x32_bf16 v[104:107], v[56:59], v[88:91], v[104:107]
s_add_u32 m0, s83, 108544
v_mfma_f32_16x16x32_bf16 v[108:111], v[56:59], v[92:95], v[108:111]
buffer_load_dwordx4 v2, s[12:15], s95 offen  lds
ds_read_b64_tr_b16 v[38:39], v14 offset:20768
s_waitcnt lgkmcnt(4)
v_mfma_f32_16x16x32_bf16 v[112:115], v[60:63], v[80:83], v[112:115]
v_mfma_f32_16x16x32_bf16 v[116:119], v[60:63], v[84:87], v[116:119]
s_add_u32 m0, s83, 109568
ds_read_b64_tr_b16 v[40:41], v11 offset:64
v_mfma_f32_16x16x32_bf16 v[120:123], v[60:63], v[88:91], v[120:123]
buffer_load_dwordx4 v3, s[12:15], s95 offen  lds
v_mfma_f32_16x16x32_bf16 v[124:127], v[60:63], v[92:95], v[124:127]
ds_read_b64_tr_b16 v[42:43], v11 offset:2368
s_waitcnt lgkmcnt(4)
v_mfma_f32_16x16x32_bf16 v[128:131], v[32:35], v[80:83], v[128:131]
v_mfma_f32_16x16x32_bf16 v[132:135], v[32:35], v[84:87], v[132:135]
ds_read_b64_tr_b16 v[44:45], v11 offset:18496
v_mfma_f32_16x16x32_bf16 v[136:139], v[32:35], v[88:91], v[136:139]
v_mfma_f32_16x16x32_bf16 v[140:143], v[32:35], v[92:95], v[140:143]
ds_read_b64_tr_b16 v[46:47], v11 offset:20800
s_waitcnt lgkmcnt(4)
v_mfma_f32_16x16x32_bf16 v[144:147], v[36:39], v[80:83], v[144:147]
v_mfma_f32_16x16x32_bf16 v[148:151], v[36:39], v[84:87], v[148:151]
ds_read_b64_tr_b16 v[48:49], v14 offset:96
v_mfma_f32_16x16x32_bf16 v[152:155], v[36:39], v[88:91], v[152:155]
v_mfma_f32_16x16x32_bf16 v[156:159], v[36:39], v[92:95], v[156:159]
ds_read_b64_tr_b16 v[50:51], v14 offset:2400
s_waitcnt lgkmcnt(4)
v_mfma_f32_16x16x32_bf16 v[160:163], v[40:43], v[80:83], v[160:163]
v_mfma_f32_16x16x32_bf16 v[164:167], v[40:43], v[84:87], v[164:167]
ds_read_b64_tr_b16 v[52:53], v14 offset:18528
v_mfma_f32_16x16x32_bf16 v[168:171], v[40:43], v[88:91], v[168:171]
v_mfma_f32_16x16x32_bf16 v[172:175], v[40:43], v[92:95], v[172:175]
ds_read_b64_tr_b16 v[54:55], v14 offset:20832
s_waitcnt lgkmcnt(4)
v_mfma_f32_16x16x32_bf16 v[176:179], v[44:47], v[80:83], v[176:179]
v_mfma_f32_16x16x32_bf16 v[180:183], v[44:47], v[84:87], v[180:183]
ds_read_b64_tr_b16 v[56:57], v11 offset:128
v_mfma_f32_16x16x32_bf16 v[184:187], v[44:47], v[88:91], v[184:187]
v_mfma_f32_16x16x32_bf16 v[188:191], v[44:47], v[92:95], v[188:191]
ds_read_b64_tr_b16 v[58:59], v11 offset:2432
s_waitcnt lgkmcnt(4)
v_mfma_f32_16x16x32_bf16 v[192:195], v[48:51], v[80:83], v[192:195]
v_mfma_f32_16x16x32_bf16 v[196:199], v[48:51], v[84:87], v[196:199]
ds_read_b64_tr_b16 v[60:61], v11 offset:18560
v_mfma_f32_16x16x32_bf16 v[200:203], v[48:51], v[88:91], v[200:203]
v_mfma_f32_16x16x32_bf16 v[204:207], v[48:51], v[92:95], v[204:207]
ds_read_b64_tr_b16 v[62:63], v11 offset:20864
s_waitcnt lgkmcnt(4)
v_mfma_f32_16x16x32_bf16 v[208:211], v[52:55], v[80:83], v[208:211]
v_mfma_f32_16x16x32_bf16 v[212:215], v[52:55], v[84:87], v[212:215]
v_mfma_f32_16x16x32_bf16 v[216:219], v[52:55], v[88:91], v[216:219]
v_mfma_f32_16x16x32_bf16 v[220:223], v[52:55], v[92:95], v[220:223]
s_waitcnt lgkmcnt(0)
s_waitcnt vmcnt(5)
s_barrier
ds_read_b128 v[64:67], v9 offset:0
ds_read_b128 v[68:71], v9 offset:1024
ds_read_b128 v[72:75], v9 offset:2048
ds_read_b128 v[76:79], v9 offset:3072
ds_read_b64_tr_b16 v[32:33], v12 offset:0
ds_read_b64_tr_b16 v[34:35], v12 offset:2304
ds_read_b64_tr_b16 v[36:37], v12 offset:18432
ds_read_b64_tr_b16 v[38:39], v12 offset:20736
ds_read_b64_tr_b16 v[40:41], v15 offset:32
ds_read_b64_tr_b16 v[42:43], v15 offset:2336
v_mfma_f32_16x16x32_bf16 v[224:227], v[56:59], v[80:83], v[224:227]
v_mfma_f32_16x16x32_bf16 v[228:231], v[56:59], v[84:87], v[228:231]
s_add_u32 m0, s84, 0
s_add_u32 s94, s82, 6144
v_mfma_f32_16x16x32_bf16 v[232:235], v[56:59], v[88:91], v[232:235]
buffer_load_dwordx4 v1, s[20:23], s94 offen sc1 lds
v_mfma_f32_16x16x32_bf16 v[236:239], v[56:59], v[92:95], v[236:239]
v_mfma_f32_16x16x32_bf16 v[240:243], v[60:63], v[80:83], v[240:243]
s_add_u32 m0, s83, 0
s_add_u32 s95, s81, 1769472
v_mfma_f32_16x16x32_bf16 v[244:247], v[60:63], v[84:87], v[244:247]
buffer_load_dwordx4 v2, s[8:11], s95 offen  lds
v_mfma_f32_16x16x32_bf16 v[248:251], v[60:63], v[88:91], v[248:251]
v_mfma_f32_16x16x32_bf16 v[252:255], v[60:63], v[92:95], v[252:255]
s_add_u32 m0, s83, 1024
s_waitcnt lgkmcnt(4)
v_mfma_f32_16x16x32_bf16 v[96:99], v[32:35], v[64:67], v[96:99]
buffer_load_dwordx4 v3, s[8:11], s95 offen  lds
v_mfma_f32_16x16x32_bf16 v[100:103], v[32:35], v[68:71], v[100:103]
ds_read_b64_tr_b16 v[44:45], v15 offset:18464
v_mfma_f32_16x16x32_bf16 v[104:107], v[32:35], v[72:75], v[104:107]
s_add_u32 m0, s83, 18432
v_mfma_f32_16x16x32_bf16 v[108:111], v[32:35], v[76:79], v[108:111]
buffer_load_dwordx4 v2, s[12:15], s95 offen  lds
ds_read_b64_tr_b16 v[46:47], v15 offset:20768
s_waitcnt lgkmcnt(4)
v_mfma_f32_16x16x32_bf16 v[112:115], v[36:39], v[64:67], v[112:115]
v_mfma_f32_16x16x32_bf16 v[116:119], v[36:39], v[68:71], v[116:119]
s_add_u32 m0, s83, 19456
ds_read_b64_tr_b16 v[48:49], v12 offset:64
v_mfma_f32_16x16x32_bf16 v[120:123], v[36:39], v[72:75], v[120:123]
buffer_load_dwordx4 v3, s[12:15], s95 offen  lds
v_mfma_f32_16x16x32_bf16 v[124:127], v[36:39], v[76:79], v[124:127]
ds_read_b64_tr_b16 v[50:51], v12 offset:2368
s_waitcnt lgkmcnt(4)
v_mfma_f32_16x16x32_bf16 v[128:131], v[40:43], v[64:67], v[128:131]
v_mfma_f32_16x16x32_bf16 v[132:135], v[40:43], v[68:71], v[132:135]
ds_read_b64_tr_b16 v[52:53], v12 offset:18496
v_mfma_f32_16x16x32_bf16 v[136:139], v[40:43], v[72:75], v[136:139]
v_mfma_f32_16x16x32_bf16 v[140:143], v[40:43], v[76:79], v[140:143]
ds_read_b64_tr_b16 v[54:55], v12 offset:20800
s_waitcnt lgkmcnt(4)
v_mfma_f32_16x16x32_bf16 v[144:147], v[44:47], v[64:67], v[144:147]
v_mfma_f32_16x16x32_bf16 v[148:151], v[44:47], v[68:71], v[148:151]
ds_read_b64_tr_b16 v[56:57], v15 offset:96
v_mfma_f32_16x16x32_bf16 v[152:155], v[44:47], v[72:75], v[152:155]
v_mfma_f32_16x16x32_bf16 v[156:159], v[44:47], v[76:79], v[156:159]
ds_read_b64_tr_b16 v[58:59], v15 offset:2400
s_waitcnt lgkmcnt(4)
v_mfma_f32_16x16x32_bf16 v[160:163], v[48:51], v[64:67], v[160:163]
v_mfma_f32_16x16x32_bf16 v[164:167], v[48:51], v[68:71], v[164:167]
ds_read_b64_tr_b16 v[60:61], v15 offset:18528
v_mfma_f32_16x16x32_bf16 v[168:171], v[48:51], v[72:75], v[168:171]
v_mfma_f32_16x16x32_bf16 v[172:175], v[48:51], v[76:79], v[172:175]
ds_read_b64_tr_b16 v[62:63], v15 offset:20832
s_waitcnt lgkmcnt(4)
v_mfma_f32_16x16x32_bf16 v[176:179], v[52:55], v[64:67], v[176:179]
v_mfma_f32_16x16x32_bf16 v[180:183], v[52:55], v[68:71], v[180:183]
ds_read_b64_tr_b16 v[32:33], v12 offset:128
v_mfma_f32_16x16x32_bf16 v[184:187], v[52:55], v[72:75], v[184:187]
v_mfma_f32_16x16x32_bf16 v[188:191], v[52:55], v[76:79], v[188:191]
ds_read_b64_tr_b16 v[34:35], v12 offset:2432
s_waitcnt lgkmcnt(4)
v_mfma_f32_16x16x32_bf16 v[192:195], v[56:59], v[64:67], v[192:195]
v_mfma_f32_16x16x32_bf16 v[196:199], v[56:59], v[68:71], v[196:199]
ds_read_b64_tr_b16 v[36:37], v12 offset:18560
v_mfma_f32_16x16x32_bf16 v[200:203], v[56:59], v[72:75], v[200:203]
v_mfma_f32_16x16x32_bf16 v[204:207], v[56:59], v[76:79], v[204:207]
ds_read_b64_tr_b16 v[38:39], v12 offset:20864
s_waitcnt lgkmcnt(4)
v_mfma_f32_16x16x32_bf16 v[208:211], v[60:63], v[64:67], v[208:211]
v_mfma_f32_16x16x32_bf16 v[212:215], v[60:63], v[68:71], v[212:215]
v_mfma_f32_16x16x32_bf16 v[216:219], v[60:63], v[72:75], v[216:219]
v_mfma_f32_16x16x32_bf16 v[220:223], v[60:63], v[76:79], v[220:223]
s_waitcnt lgkmcnt(0)
s_waitcnt vmcnt(5)
s_barrier
ds_read_b128 v[80:83], v10 offset:0
ds_read_b128 v[84:87], v10 offset:1024
ds_read_b128 v[88:91], v10 offset:2048
ds_read_b128 v[92:95], v10 offset:3072
ds_read_b64_tr_b16 v[40:41], v13 offset:0
ds_read_b64_tr_b16 v[42:43], v13 offset:2304
ds_read_b64_tr_b16 v[44:45], v13 offset:18432
ds_read_b64_tr_b16 v[46:47], v13 offset:20736
ds_read_b64_tr_b16 v[48:49], v16 offset:32
ds_read_b64_tr_b16 v[50:51], v16 offset:2336
v_mfma_f32_16x16x32_bf16 v[224:227], v[32:35], v[64:67], v[224:227]
v_mfma_f32_16x16x32_bf16 v[228:231], v[32:35], v[68:71], v[228:231]
s_add_u32 m0, s84, 45056
s_add_u32 s94, s82, 7168
v_mfma_f32_16x16x32_bf16 v[232:235], v[32:35], v[72:75], v[232:235]
buffer_load_dwordx4 v1, s[20:23], s94 offen sc1 lds
v_mfma_f32_16x16x32_bf16 v[236:239], v[32:35], v[76:79], v[236:239]
v_mfma_f32_16x16x32_bf16 v[240:243], v[36:39], v[64:67], v[240:243]
s_add_u32 m0, s83, 45056
s_add_u32 s95, s81, 1843200
v_mfma_f32_16x16x32_bf16 v[244:247], v[36:39], v[68:71], v[244:247]
buffer_load_dwordx4 v2, s[8:11], s95 offen  lds
v_mfma_f32_16x16x32_bf16 v[248:251], v[36:39], v[72:75], v[248:251]
v_mfma_f32_16x16x32_bf16 v[252:255], v[36:39], v[76:79], v[252:255]
s_add_u32 m0, s83, 46080
s_waitcnt lgkmcnt(4)
v_mfma_f32_16x16x32_bf16 v[96:99], v[40:43], v[80:83], v[96:99]
buffer_load_dwordx4 v3, s[8:11], s95 offen  lds
v_mfma_f32_16x16x32_bf16 v[100:103], v[40:43], v[84:87], v[100:103]
ds_read_b64_tr_b16 v[52:53], v16 offset:18464
v_mfma_f32_16x16x32_bf16 v[104:107], v[40:43], v[88:91], v[104:107]
s_add_u32 m0, s83, 63488
v_mfma_f32_16x16x32_bf16 v[108:111], v[40:43], v[92:95], v[108:111]
buffer_load_dwordx4 v2, s[12:15], s95 offen  lds
ds_read_b64_tr_b16 v[54:55], v16 offset:20768
s_waitcnt lgkmcnt(4)
v_mfma_f32_16x16x32_bf16 v[112:115], v[44:47], v[80:83], v[112:115]
v_mfma_f32_16x16x32_bf16 v[116:119], v[44:47], v[84:87], v[116:119]
s_add_u32 m0, s83, 64512
ds_read_b64_tr_b16 v[56:57], v13 offset:64
v_mfma_f32_16x16x32_bf16 v[120:123], v[44:47], v[88:91], v[120:123]
buffer_load_dwordx4 v3, s[12:15], s95 offen  lds
v_mfma_f32_16x16x32_bf16 v[124:127], v[44:47], v[92:95], v[124:127]
ds_read_b64_tr_b16 v[58:59], v13 offset:2368
s_waitcnt lgkmcnt(4)
v_mfma_f32_16x16x32_bf16 v[128:131], v[48:51], v[80:83], v[128:131]
v_mfma_f32_16x16x32_bf16 v[132:135], v[48:51], v[84:87], v[132:135]
ds_read_b64_tr_b16 v[60:61], v13 offset:18496
v_mfma_f32_16x16x32_bf16 v[136:139], v[48:51], v[88:91], v[136:139]
v_mfma_f32_16x16x32_bf16 v[140:143], v[48:51], v[92:95], v[140:143]
ds_read_b64_tr_b16 v[62:63], v13 offset:20800
s_waitcnt lgkmcnt(4)
v_mfma_f32_16x16x32_bf16 v[144:147], v[52:55], v[80:83], v[144:147]
v_mfma_f32_16x16x32_bf16 v[148:151], v[52:55], v[84:87], v[148:151]
ds_read_b64_tr_b16 v[32:33], v16 offset:96
v_mfma_f32_16x16x32_bf16 v[152:155], v[52:55], v[88:91], v[152:155]
v_mfma_f32_16x16x32_bf16 v[156:159], v[52:55], v[92:95], v[156:159]
ds_read_b64_tr_b16 v[34:35], v16 offset:2400
s_waitcnt lgkmcnt(4)
v_mfma_f32_16x16x32_bf16 v[160:163], v[56:59], v[80:83], v[160:163]
v_mfma_f32_16x16x32_bf16 v[164:167], v[56:59], v[84:87], v[164:167]
ds_read_b64_tr_b16 v[36:37], v16 offset:18528
v_mfma_f32_16x16x32_bf16 v[168:171], v[56:59], v[88:91], v[168:171]
v_mfma_f32_16x16x32_bf16 v[172:175], v[56:59], v[92:95], v[172:175]
ds_read_b64_tr_b16 v[38:39], v16 offset:20832
s_waitcnt lgkmcnt(4)
v_mfma_f32_16x16x32_bf16 v[176:179], v[60:63], v[80:83], v[176:179]
v_mfma_f32_16x16x32_bf16 v[180:183], v[60:63], v[84:87], v[180:183]
ds_read_b64_tr_b16 v[40:41], v13 offset:128
v_mfma_f32_16x16x32_bf16 v[184:187], v[60:63], v[88:91], v[184:187]
v_mfma_f32_16x16x32_bf16 v[188:191], v[60:63], v[92:95], v[188:191]
ds_read_b64_tr_b16 v[42:43], v13 offset:2432
s_waitcnt lgkmcnt(4)
v_mfma_f32_16x16x32_bf16 v[192:195], v[32:35], v[80:83], v[192:195]
v_mfma_f32_16x16x32_bf16 v[196:199], v[32:35], v[84:87], v[196:199]
ds_read_b64_tr_b16 v[44:45], v13 offset:18560
v_mfma_f32_16x16x32_bf16 v[200:203], v[32:35], v[88:91], v[200:203]
v_mfma_f32_16x16x32_bf16 v[204:207], v[32:35], v[92:95], v[204:207]
ds_read_b64_tr_b16 v[46:47], v13 offset:20864
s_waitcnt lgkmcnt(4)
v_mfma_f32_16x16x32_bf16 v[208:211], v[36:39], v[80:83], v[208:211]
v_mfma_f32_16x16x32_bf16 v[212:215], v[36:39], v[84:87], v[212:215]
v_mfma_f32_16x16x32_bf16 v[216:219], v[36:39], v[88:91], v[216:219]
v_mfma_f32_16x16x32_bf16 v[220:223], v[36:39], v[92:95], v[220:223]
s_waitcnt lgkmcnt(0)
s_waitcnt vmcnt(5)
s_barrier
ds_read_b128 v[64:67], v8 offset:0
ds_read_b128 v[68:71], v8 offset:1024
ds_read_b128 v[72:75], v8 offset:2048
ds_read_b128 v[76:79], v8 offset:3072
ds_read_b64_tr_b16 v[48:49], v11 offset:0
ds_read_b64_tr_b16 v[50:51], v11 offset:2304
ds_read_b64_tr_b16 v[52:53], v11 offset:18432
ds_read_b64_tr_b16 v[54:55], v11 offset:20736
ds_read_b64_tr_b16 v[56:57], v14 offset:32
ds_read_b64_tr_b16 v[58:59], v14 offset:2336
v_mfma_f32_16x16x32_bf16 v[224:227], v[40:43], v[80:83], v[224:227]
v_mfma_f32_16x16x32_bf16 v[228:231], v[40:43], v[84:87], v[228:231]
s_add_u32 m0, s84, 90112
s_add_u32 s94, s82, 8192
v_mfma_f32_16x16x32_bf16 v[232:235], v[40:43], v[88:91], v[232:235]
buffer_load_dwordx4 v1, s[20:23], s94 offen sc1 lds
v_mfma_f32_16x16x32_bf16 v[236:239], v[40:43], v[92:95], v[236:239]
v_mfma_f32_16x16x32_bf16 v[240:243], v[44:47], v[80:83], v[240:243]
s_add_u32 m0, s83, 90112
s_add_u32 s95, s81, 2359296
v_mfma_f32_16x16x32_bf16 v[244:247], v[44:47], v[84:87], v[244:247]
buffer_load_dwordx4 v2, s[8:11], s95 offen  lds
v_mfma_f32_16x16x32_bf16 v[248:251], v[44:47], v[88:91], v[248:251]
v_mfma_f32_16x16x32_bf16 v[252:255], v[44:47], v[92:95], v[252:255]
s_add_u32 m0, s83, 91136
s_waitcnt lgkmcnt(4)
v_mfma_f32_16x16x32_bf16 v[96:99], v[48:51], v[64:67], v[96:99]
buffer_load_dwordx4 v3, s[8:11], s95 offen  lds
v_mfma_f32_16x16x32_bf16 v[100:103], v[48:51], v[68:71], v[100:103]
ds_read_b64_tr_b16 v[60:61], v14 offset:18464
v_mfma_f32_16x16x32_bf16 v[104:107], v[48:51], v[72:75], v[104:107]
s_add_u32 m0, s83, 108544
v_mfma_f32_16x16x32_bf16 v[108:111], v[48:51], v[76:79], v[108:111]
buffer_load_dwordx4 v2, s[12:15], s95 offen  lds
ds_read_b64_tr_b16 v[62:63], v14 offset:20768
s_waitcnt lgkmcnt(4)
v_mfma_f32_16x16x32_bf16 v[112:115], v[52:55], v[64:67], v[112:115]
v_mfma_f32_16x16x32_bf16 v[116:119], v[52:55], v[68:71], v[116:119]
s_add_u32 m0, s83, 109568
ds_read_b64_tr_b16 v[32:33], v11 offset:64
v_mfma_f32_16x16x32_bf16 v[120:123], v[52:55], v[72:75], v[120:123]
buffer_load_dwordx4 v3, s[12:15], s95 offen  lds
v_mfma_f32_16x16x32_bf16 v[124:127], v[52:55], v[76:79], v[124:127]
ds_read_b64_tr_b16 v[34:35], v11 offset:2368
s_waitcnt lgkmcnt(4)
v_mfma_f32_16x16x32_bf16 v[128:131], v[56:59], v[64:67], v[128:131]
v_mfma_f32_16x16x32_bf16 v[132:135], v[56:59], v[68:71], v[132:135]
ds_read_b64_tr_b16 v[36:37], v11 offset:18496
v_mfma_f32_16x16x32_bf16 v[136:139], v[56:59], v[72:75], v[136:139]
v_mfma_f32_16x16x32_bf16 v[140:143], v[56:59], v[76:79], v[140:143]
ds_read_b64_tr_b16 v[38:39], v11 offset:20800
s_waitcnt lgkmcnt(4)
v_mfma_f32_16x16x32_bf16 v[144:147], v[60:63], v[64:67], v[144:147]
v_mfma_f32_16x16x32_bf16 v[148:151], v[60:63], v[68:71], v[148:151]
ds_read_b64_tr_b16 v[40:41], v14 offset:96
v_mfma_f32_16x16x32_bf16 v[152:155], v[60:63], v[72:75], v[152:155]
v_mfma_f32_16x16x32_bf16 v[156:159], v[60:63], v[76:79], v[156:159]
ds_read_b64_tr_b16 v[42:43], v14 offset:2400
s_waitcnt lgkmcnt(4)
v_mfma_f32_16x16x32_bf16 v[160:163], v[32:35], v[64:67], v[160:163]
v_mfma_f32_16x16x32_bf16 v[164:167], v[32:35], v[68:71], v[164:167]
ds_read_b64_tr_b16 v[44:45], v14 offset:18528
v_mfma_f32_16x16x32_bf16 v[168:171], v[32:35], v[72:75], v[168:171]
v_mfma_f32_16x16x32_bf16 v[172:175], v[32:35], v[76:79], v[172:175]
ds_read_b64_tr_b16 v[46:47], v14 offset:20832
s_waitcnt lgkmcnt(4)
v_mfma_f32_16x16x32_bf16 v[176:179], v[36:39], v[64:67], v[176:179]
v_mfma_f32_16x16x32_bf16 v[180:183], v[36:39], v[68:71], v[180:183]
ds_read_b64_tr_b16 v[48:49], v11 offset:128
v_mfma_f32_16x16x32_bf16 v[184:187], v[36:39], v[72:75], v[184:187]
v_mfma_f32_16x16x32_bf16 v[188:191], v[36:39], v[76:79], v[188:191]
ds_read_b64_tr_b16 v[50:51], v11 offset:2432
s_waitcnt lgkmcnt(4)
v_mfma_f32_16x16x32_bf16 v[192:195], v[40:43], v[64:67], v[192:195]
v_mfma_f32_16x16x32_bf16 v[196:199], v[40:43], v[68:71], v[196:199]
ds_read_b64_tr_b16 v[52:53], v11 offset:18560
v_mfma_f32_16x16x32_bf16 v[200:203], v[40:43], v[72:75], v[200:203]
v_mfma_f32_16x16x32_bf16 v[204:207], v[40:43], v[76:79], v[204:207]
ds_read_b64_tr_b16 v[54:55], v11 offset:20864
s_waitcnt lgkmcnt(4)
v_mfma_f32_16x16x32_bf16 v[208:211], v[44:47], v[64:67], v[208:211]
v_mfma_f32_16x16x32_bf16 v[212:215], v[44:47], v[68:71], v[212:215]
v_mfma_f32_16x16x32_bf16 v[216:219], v[44:47], v[72:75], v[216:219]
v_mfma_f32_16x16x32_bf16 v[220:223], v[44:47], v[76:79], v[220:223]
s_waitcnt lgkmcnt(0)
s_waitcnt vmcnt(5)
s_barrier
ds_read_b128 v[80:83], v9 offset:0
ds_read_b128 v[84:87], v9 offset:1024
ds_read_b128 v[88:91], v9 offset:2048
ds_read_b128 v[92:95], v9 offset:3072
ds_read_b64_tr_b16 v[56:57], v12 offset:0
ds_read_b64_tr_b16 v[58:59], v12 offset:2304
ds_read_b64_tr_b16 v[60:61], v12 offset:18432
ds_read_b64_tr_b16 v[62:63], v12 offset:20736
ds_read_b64_tr_b16 v[32:33], v15 offset:32
ds_read_b64_tr_b16 v[34:35], v15 offset:2336
v_mfma_f32_16x16x32_bf16 v[224:227], v[48:51], v[64:67], v[224:227]
v_mfma_f32_16x16x32_bf16 v[228:231], v[48:51], v[68:71], v[228:231]
s_add_u32 m0, s84, 0
s_add_u32 s94, s82, 9216
v_mfma_f32_16x16x32_bf16 v[232:235], v[48:51], v[72:75], v[232:235]
buffer_load_dwordx4 v1, s[20:23], s94 offen sc1 lds
v_mfma_f32_16x16x32_bf16 v[236:239], v[48:51], v[76:79], v[236:239]
v_mfma_f32_16x16x32_bf16 v[240:243], v[52:55], v[64:67], v[240:243]
s_add_u32 m0, s83, 0
s_add_u32 s95, s81, 2433024
v_mfma_f32_16x16x32_bf16 v[244:247], v[52:55], v[68:71], v[244:247]
buffer_load_dwordx4 v2, s[8:11], s95 offen  lds
v_mfma_f32_16x16x32_bf16 v[248:251], v[52:55], v[72:75], v[248:251]
v_mfma_f32_16x16x32_bf16 v[252:255], v[52:55], v[76:79], v[252:255]
s_add_u32 m0, s83, 1024
s_waitcnt lgkmcnt(4)
v_mfma_f32_16x16x32_bf16 v[96:99], v[56:59], v[80:83], v[96:99]
buffer_load_dwordx4 v3, s[8:11], s95 offen  lds
v_mfma_f32_16x16x32_bf16 v[100:103], v[56:59], v[84:87], v[100:103]
ds_read_b64_tr_b16 v[36:37], v15 offset:18464
v_mfma_f32_16x16x32_bf16 v[104:107], v[56:59], v[88:91], v[104:107]
s_add_u32 m0, s83, 18432
v_mfma_f32_16x16x32_bf16 v[108:111], v[56:59], v[92:95], v[108:111]
buffer_load_dwordx4 v2, s[12:15], s95 offen  lds
ds_read_b64_tr_b16 v[38:39], v15 offset:20768
s_waitcnt lgkmcnt(4)
v_mfma_f32_16x16x32_bf16 v[112:115], v[60:63], v[80:83], v[112:115]
v_mfma_f32_16x16x32_bf16 v[116:119], v[60:63], v[84:87], v[116:119]
s_add_u32 m0, s83, 19456
ds_read_b64_tr_b16 v[40:41], v12 offset:64
v_mfma_f32_16x16x32_bf16 v[120:123], v[60:63], v[88:91], v[120:123]
buffer_load_dwordx4 v3, s[12:15], s95 offen  lds
v_mfma_f32_16x16x32_bf16 v[124:127], v[60:63], v[92:95], v[124:127]
ds_read_b64_tr_b16 v[42:43], v12 offset:2368
s_waitcnt lgkmcnt(4)
v_mfma_f32_16x16x32_bf16 v[128:131], v[32:35], v[80:83], v[128:131]
v_mfma_f32_16x16x32_bf16 v[132:135], v[32:35], v[84:87], v[132:135]
ds_read_b64_tr_b16 v[44:45], v12 offset:18496
v_mfma_f32_16x16x32_bf16 v[136:139], v[32:35], v[88:91], v[136:139]
v_mfma_f32_16x16x32_bf16 v[140:143], v[32:35], v[92:95], v[140:143]
ds_read_b64_tr_b16 v[46:47], v12 offset:20800
s_waitcnt lgkmcnt(4)
v_mfma_f32_16x16x32_bf16 v[144:147], v[36:39], v[80:83], v[144:147]
v_mfma_f32_16x16x32_bf16 v[148:151], v[36:39], v[84:87], v[148:151]
ds_read_b64_tr_b16 v[48:49], v15 offset:96
v_mfma_f32_16x16x32_bf16 v[152:155], v[36:39], v[88:91], v[152:155]
v_mfma_f32_16x16x32_bf16 v[156:159], v[36:39], v[92:95], v[156:159]
ds_read_b64_tr_b16 v[50:51], v15 offset:2400
s_waitcnt lgkmcnt(4)
v_mfma_f32_16x16x32_bf16 v[160:163], v[40:43], v[80:83], v[160:163]
v_mfma_f32_16x16x32_bf16 v[164:167], v[40:43], v[84:87], v[164:167]
ds_read_b64_tr_b16 v[52:53], v15 offset:18528
v_mfma_f32_16x16x32_bf16 v[168:171], v[40:43], v[88:91], v[168:171]
v_mfma_f32_16x16x32_bf16 v[172:175], v[40:43], v[92:95], v[172:175]
ds_read_b64_tr_b16 v[54:55], v15 offset:20832
s_waitcnt lgkmcnt(4)
v_mfma_f32_16x16x32_bf16 v[176:179], v[44:47], v[80:83], v[176:179]
v_mfma_f32_16x16x32_bf16 v[180:183], v[44:47], v[84:87], v[180:183]
ds_read_b64_tr_b16 v[56:57], v12 offset:128
v_mfma_f32_16x16x32_bf16 v[184:187], v[44:47], v[88:91], v[184:187]
v_mfma_f32_16x16x32_bf16 v[188:191], v[44:47], v[92:95], v[188:191]
ds_read_b64_tr_b16 v[58:59], v12 offset:2432
s_waitcnt lgkmcnt(4)
v_mfma_f32_16x16x32_bf16 v[192:195], v[48:51], v[80:83], v[192:195]
v_mfma_f32_16x16x32_bf16 v[196:199], v[48:51], v[84:87], v[196:199]
ds_read_b64_tr_b16 v[60:61], v12 offset:18560
v_mfma_f32_16x16x32_bf16 v[200:203], v[48:51], v[88:91], v[200:203]
v_mfma_f32_16x16x32_bf16 v[204:207], v[48:51], v[92:95], v[204:207]
ds_read_b64_tr_b16 v[62:63], v12 offset:20864
s_waitcnt lgkmcnt(4)
v_mfma_f32_16x16x32_bf16 v[208:211], v[52:55], v[80:83], v[208:211]
v_mfma_f32_16x16x32_bf16 v[212:215], v[52:55], v[84:87], v[212:215]
v_mfma_f32_16x16x32_bf16 v[216:219], v[52:55], v[88:91], v[216:219]
v_mfma_f32_16x16x32_bf16 v[220:223], v[52:55], v[92:95], v[220:223]
s_waitcnt lgkmcnt(0)
s_waitcnt vmcnt(5)
s_barrier
ds_read_b128 v[64:67], v10 offset:0
ds_read_b128 v[68:71], v10 offset:1024
ds_read_b128 v[72:75], v10 offset:2048
ds_read_b128 v[76:79], v10 offset:3072
ds_read_b64_tr_b16 v[32:33], v13 offset:0
ds_read_b64_tr_b16 v[34:35], v13 offset:2304
ds_read_b64_tr_b16 v[36:37], v13 offset:18432
ds_read_b64_tr_b16 v[38:39], v13 offset:20736
ds_read_b64_tr_b16 v[40:41], v16 offset:32
ds_read_b64_tr_b16 v[42:43], v16 offset:2336
v_mfma_f32_16x16x32_bf16 v[224:227], v[56:59], v[80:83], v[224:227]
v_mfma_f32_16x16x32_bf16 v[228:231], v[56:59], v[84:87], v[228:231]
s_add_u32 m0, s84, 45056
s_add_u32 s94, s82, 10240
v_mfma_f32_16x16x32_bf16 v[232:235], v[56:59], v[88:91], v[232:235]
buffer_load_dwordx4 v1, s[20:23], s94 offen sc1 lds
v_mfma_f32_16x16x32_bf16 v[236:239], v[56:59], v[92:95], v[236:239]
v_mfma_f32_16x16x32_bf16 v[240:243], v[60:63], v[80:83], v[240:243]
s_add_u32 m0, s83, 45056
s_add_u32 s95, s81, 2949120
v_mfma_f32_16x16x32_bf16 v[244:247], v[60:63], v[84:87], v[244:247]
buffer_load_dwordx4 v2, s[8:11], s95 offen  lds
v_mfma_f32_16x16x32_bf16 v[248:251], v[60:63], v[88:91], v[248:251]
v_mfma_f32_16x16x32_bf16 v[252:255], v[60:63], v[92:95], v[252:255]
s_add_u32 m0, s83, 46080
s_waitcnt lgkmcnt(4)
v_mfma_f32_16x16x32_bf16 v[96:99], v[32:35], v[64:67], v[96:99]
buffer_load_dwordx4 v3, s[8:11], s95 offen  lds
v_mfma_f32_16x16x32_bf16 v[100:103], v[32:35], v[68:71], v[100:103]
ds_read_b64_tr_b16 v[44:45], v16 offset:18464
v_mfma_f32_16x16x32_bf16 v[104:107], v[32:35], v[72:75], v[104:107]
s_add_u32 m0, s83, 63488
v_mfma_f32_16x16x32_bf16 v[108:111], v[32:35], v[76:79], v[108:111]
buffer_load_dwordx4 v2, s[12:15], s95 offen  lds
ds_read_b64_tr_b16 v[46:47], v16 offset:20768
s_waitcnt lgkmcnt(4)
v_mfma_f32_16x16x32_bf16 v[112:115], v[36:39], v[64:67], v[112:115]
v_mfma_f32_16x16x32_bf16 v[116:119], v[36:39], v[68:71], v[116:119]
s_add_u32 m0, s83, 64512
ds_read_b64_tr_b16 v[48:49], v13 offset:64
v_mfma_f32_16x16x32_bf16 v[120:123], v[36:39], v[72:75], v[120:123]
buffer_load_dwordx4 v3, s[12:15], s95 offen  lds
v_mfma_f32_16x16x32_bf16 v[124:127], v[36:39], v[76:79], v[124:127]
ds_read_b64_tr_b16 v[50:51], v13 offset:2368
s_waitcnt lgkmcnt(4)
v_mfma_f32_16x16x32_bf16 v[128:131], v[40:43], v[64:67], v[128:131]
v_mfma_f32_16x16x32_bf16 v[132:135], v[40:43], v[68:71], v[132:135]
ds_read_b64_tr_b16 v[52:53], v13 offset:18496
v_mfma_f32_16x16x32_bf16 v[136:139], v[40:43], v[72:75], v[136:139]
v_mfma_f32_16x16x32_bf16 v[140:143], v[40:43], v[76:79], v[140:143]
ds_read_b64_tr_b16 v[54:55], v13 offset:20800
s_waitcnt lgkmcnt(4)
v_mfma_f32_16x16x32_bf16 v[144:147], v[44:47], v[64:67], v[144:147]
v_mfma_f32_16x16x32_bf16 v[148:151], v[44:47], v[68:71], v[148:151]
ds_read_b64_tr_b16 v[56:57], v16 offset:96
v_mfma_f32_16x16x32_bf16 v[152:155], v[44:47], v[72:75], v[152:155]
v_mfma_f32_16x16x32_bf16 v[156:159], v[44:47], v[76:79], v[156:159]
ds_read_b64_tr_b16 v[58:59], v16 offset:2400
s_waitcnt lgkmcnt(4)
v_mfma_f32_16x16x32_bf16 v[160:163], v[48:51], v[64:67], v[160:163]
v_mfma_f32_16x16x32_bf16 v[164:167], v[48:51], v[68:71], v[164:167]
ds_read_b64_tr_b16 v[60:61], v16 offset:18528
v_mfma_f32_16x16x32_bf16 v[168:171], v[48:51], v[72:75], v[168:171]
v_mfma_f32_16x16x32_bf16 v[172:175], v[48:51], v[76:79], v[172:175]
ds_read_b64_tr_b16 v[62:63], v16 offset:20832
s_waitcnt lgkmcnt(4)
v_mfma_f32_16x16x32_bf16 v[176:179], v[52:55], v[64:67], v[176:179]
v_mfma_f32_16x16x32_bf16 v[180:183], v[52:55], v[68:71], v[180:183]
ds_read_b64_tr_b16 v[32:33], v13 offset:128
v_mfma_f32_16x16x32_bf16 v[184:187], v[52:55], v[72:75], v[184:187]
v_mfma_f32_16x16x32_bf16 v[188:191], v[52:55], v[76:79], v[188:191]
ds_read_b64_tr_b16 v[34:35], v13 offset:2432
s_waitcnt lgkmcnt(4)
v_mfma_f32_16x16x32_bf16 v[192:195], v[56:59], v[64:67], v[192:195]
v_mfma_f32_16x16x32_bf16 v[196:199], v[56:59], v[68:71], v[196:199]
ds_read_b64_tr_b16 v[36:37], v13 offset:18560
v_mfma_f32_16x16x32_bf16 v[200:203], v[56:59], v[72:75], v[200:203]
v_mfma_f32_16x16x32_bf16 v[204:207], v[56:59], v[76:79], v[204:207]
ds_read_b64_tr_b16 v[38:39], v13 offset:20864
s_waitcnt lgkmcnt(4)
v_mfma_f32_16x16x32_bf16 v[208:211], v[60:63], v[64:67], v[208:211]
v_mfma_f32_16x16x32_bf16 v[212:215], v[60:63], v[68:71], v[212:215]
v_mfma_f32_16x16x32_bf16 v[216:219], v[60:63], v[72:75], v[216:219]
v_mfma_f32_16x16x32_bf16 v[220:223], v[60:63], v[76:79], v[220:223]
s_waitcnt lgkmcnt(0)
s_waitcnt vmcnt(5)
s_barrier
ds_read_b128 v[80:83], v8 offset:0
ds_read_b128 v[84:87], v8 offset:1024
ds_read_b128 v[88:91], v8 offset:2048
ds_read_b128 v[92:95], v8 offset:3072
ds_read_b64_tr_b16 v[40:41], v11 offset:0
ds_read_b64_tr_b16 v[42:43], v11 offset:2304
ds_read_b64_tr_b16 v[44:45], v11 offset:18432
ds_read_b64_tr_b16 v[46:47], v11 offset:20736
ds_read_b64_tr_b16 v[48:49], v14 offset:32
ds_read_b64_tr_b16 v[50:51], v14 offset:2336
v_mfma_f32_16x16x32_bf16 v[224:227], v[32:35], v[64:67], v[224:227]
v_mfma_f32_16x16x32_bf16 v[228:231], v[32:35], v[68:71], v[228:231]
s_add_u32 m0, s84, 90112
s_add_u32 s94, s82, 11264
v_mfma_f32_16x16x32_bf16 v[232:235], v[32:35], v[72:75], v[232:235]
buffer_load_dwordx4 v1, s[20:23], s94 offen sc1 lds
v_mfma_f32_16x16x32_bf16 v[236:239], v[32:35], v[76:79], v[236:239]
v_mfma_f32_16x16x32_bf16 v[240:243], v[36:39], v[64:67], v[240:243]
s_add_u32 m0, s83, 90112
s_add_u32 s95, s81, 3022848
v_mfma_f32_16x16x32_bf16 v[244:247], v[36:39], v[68:71], v[244:247]
buffer_load_dwordx4 v2, s[8:11], s95 offen  lds
v_mfma_f32_16x16x32_bf16 v[248:251], v[36:39], v[72:75], v[248:251]
v_mfma_f32_16x16x32_bf16 v[252:255], v[36:39], v[76:79], v[252:255]
s_add_u32 m0, s83, 91136
s_waitcnt lgkmcnt(4)
v_mfma_f32_16x16x32_bf16 v[96:99], v[40:43], v[80:83], v[96:99]
buffer_load_dwordx4 v3, s[8:11], s95 offen  lds
v_mfma_f32_16x16x32_bf16 v[100:103], v[40:43], v[84:87], v[100:103]
ds_read_b64_tr_b16 v[52:53], v14 offset:18464
v_mfma_f32_16x16x32_bf16 v[104:107], v[40:43], v[88:91], v[104:107]
s_add_u32 m0, s83, 108544
v_mfma_f32_16x16x32_bf16 v[108:111], v[40:43], v[92:95], v[108:111]
buffer_load_dwordx4 v2, s[12:15], s95 offen  lds
ds_read_b64_tr_b16 v[54:55], v14 offset:20768
s_waitcnt lgkmcnt(4)
v_mfma_f32_16x16x32_bf16 v[112:115], v[44:47], v[80:83], v[112:115]
v_mfma_f32_16x16x32_bf16 v[116:119], v[44:47], v[84:87], v[116:119]
s_add_u32 m0, s83, 109568
ds_read_b64_tr_b16 v[56:57], v11 offset:64
v_mfma_f32_16x16x32_bf16 v[120:123], v[44:47], v[88:91], v[120:123]
buffer_load_dwordx4 v3, s[12:15], s95 offen  lds
v_mfma_f32_16x16x32_bf16 v[124:127], v[44:47], v[92:95], v[124:127]
ds_read_b64_tr_b16 v[58:59], v11 offset:2368
s_waitcnt lgkmcnt(4)
v_mfma_f32_16x16x32_bf16 v[128:131], v[48:51], v[80:83], v[128:131]
v_mfma_f32_16x16x32_bf16 v[132:135], v[48:51], v[84:87], v[132:135]
ds_read_b64_tr_b16 v[60:61], v11 offset:18496
v_mfma_f32_16x16x32_bf16 v[136:139], v[48:51], v[88:91], v[136:139]
v_mfma_f32_16x16x32_bf16 v[140:143], v[48:51], v[92:95], v[140:143]
ds_read_b64_tr_b16 v[62:63], v11 offset:20800
s_waitcnt lgkmcnt(4)
v_mfma_f32_16x16x32_bf16 v[144:147], v[52:55], v[80:83], v[144:147]
v_mfma_f32_16x16x32_bf16 v[148:151], v[52:55], v[84:87], v[148:151]
ds_read_b64_tr_b16 v[32:33], v14 offset:96
v_mfma_f32_16x16x32_bf16 v[152:155], v[52:55], v[88:91], v[152:155]
v_mfma_f32_16x16x32_bf16 v[156:159], v[52:55], v[92:95], v[156:159]
ds_read_b64_tr_b16 v[34:35], v14 offset:2400
s_waitcnt lgkmcnt(4)
v_mfma_f32_16x16x32_bf16 v[160:163], v[56:59], v[80:83], v[160:163]
v_mfma_f32_16x16x32_bf16 v[164:167], v[56:59], v[84:87], v[164:167]
ds_read_b64_tr_b16 v[36:37], v14 offset:18528
v_mfma_f32_16x16x32_bf16 v[168:171], v[56:59], v[88:91], v[168:171]
v_mfma_f32_16x16x32_bf16 v[172:175], v[56:59], v[92:95], v[172:175]
ds_read_b64_tr_b16 v[38:39], v14 offset:20832
s_waitcnt lgkmcnt(4)
v_mfma_f32_16x16x32_bf16 v[176:179], v[60:63], v[80:83], v[176:179]
v_mfma_f32_16x16x32_bf16 v[180:183], v[60:63], v[84:87], v[180:183]
ds_read_b64_tr_b16 v[40:41], v11 offset:128
v_mfma_f32_16x16x32_bf16 v[184:187], v[60:63], v[88:91], v[184:187]
v_mfma_f32_16x16x32_bf16 v[188:191], v[60:63], v[92:95], v[188:191]
ds_read_b64_tr_b16 v[42:43], v11 offset:2432
s_waitcnt lgkmcnt(4)
v_mfma_f32_16x16x32_bf16 v[192:195], v[32:35], v[80:83], v[192:195]
v_mfma_f32_16x16x32_bf16 v[196:199], v[32:35], v[84:87], v[196:199]
ds_read_b64_tr_b16 v[44:45], v11 offset:18560
v_mfma_f32_16x16x32_bf16 v[200:203], v[32:35], v[88:91], v[200:203]
v_mfma_f32_16x16x32_bf16 v[204:207], v[32:35], v[92:95], v[204:207]
ds_read_b64_tr_b16 v[46:47], v11 offset:20864
s_waitcnt lgkmcnt(4)
v_mfma_f32_16x16x32_bf16 v[208:211], v[36:39], v[80:83], v[208:211]
v_mfma_f32_16x16x32_bf16 v[212:215], v[36:39], v[84:87], v[212:215]
v_mfma_f32_16x16x32_bf16 v[216:219], v[36:39], v[88:91], v[216:219]
v_mfma_f32_16x16x32_bf16 v[220:223], v[36:39], v[92:95], v[220:223]
s_waitcnt lgkmcnt(0)
s_waitcnt vmcnt(5)
s_barrier
ds_read_b128 v[64:67], v9 offset:0
ds_read_b128 v[68:71], v9 offset:1024
ds_read_b128 v[72:75], v9 offset:2048
ds_read_b128 v[76:79], v9 offset:3072
ds_read_b64_tr_b16 v[48:49], v12 offset:0
ds_read_b64_tr_b16 v[50:51], v12 offset:2304
ds_read_b64_tr_b16 v[52:53], v12 offset:18432
ds_read_b64_tr_b16 v[54:55], v12 offset:20736
ds_read_b64_tr_b16 v[56:57], v15 offset:32
ds_read_b64_tr_b16 v[58:59], v15 offset:2336
v_mfma_f32_16x16x32_bf16 v[224:227], v[40:43], v[80:83], v[224:227]
v_mfma_f32_16x16x32_bf16 v[228:231], v[40:43], v[84:87], v[228:231]
s_add_u32 m0, s84, 0
s_add_u32 s94, s82, 12288
v_mfma_f32_16x16x32_bf16 v[232:235], v[40:43], v[88:91], v[232:235]
buffer_load_dwordx4 v1, s[20:23], s94 offen sc1 lds
v_mfma_f32_16x16x32_bf16 v[236:239], v[40:43], v[92:95], v[236:239]
v_mfma_f32_16x16x32_bf16 v[240:243], v[44:47], v[80:83], v[240:243]
s_add_u32 m0, s83, 0
s_add_u32 s95, s81, 3538944
v_mfma_f32_16x16x32_bf16 v[244:247], v[44:47], v[84:87], v[244:247]
buffer_load_dwordx4 v2, s[8:11], s95 offen  lds
v_mfma_f32_16x16x32_bf16 v[248:251], v[44:47], v[88:91], v[248:251]
v_mfma_f32_16x16x32_bf16 v[252:255], v[44:47], v[92:95], v[252:255]
s_add_u32 m0, s83, 1024
s_waitcnt lgkmcnt(4)
v_mfma_f32_16x16x32_bf16 v[96:99], v[48:51], v[64:67], v[96:99]
buffer_load_dwordx4 v3, s[8:11], s95 offen  lds
v_mfma_f32_16x16x32_bf16 v[100:103], v[48:51], v[68:71], v[100:103]
ds_read_b64_tr_b16 v[60:61], v15 offset:18464
v_mfma_f32_16x16x32_bf16 v[104:107], v[48:51], v[72:75], v[104:107]
s_add_u32 m0, s83, 18432
v_mfma_f32_16x16x32_bf16 v[108:111], v[48:51], v[76:79], v[108:111]
buffer_load_dwordx4 v2, s[12:15], s95 offen  lds
ds_read_b64_tr_b16 v[62:63], v15 offset:20768
s_waitcnt lgkmcnt(4)
v_mfma_f32_16x16x32_bf16 v[112:115], v[52:55], v[64:67], v[112:115]
v_mfma_f32_16x16x32_bf16 v[116:119], v[52:55], v[68:71], v[116:119]
s_add_u32 m0, s83, 19456
ds_read_b64_tr_b16 v[32:33], v12 offset:64
v_mfma_f32_16x16x32_bf16 v[120:123], v[52:55], v[72:75], v[120:123]
buffer_load_dwordx4 v3, s[12:15], s95 offen  lds
v_mfma_f32_16x16x32_bf16 v[124:127], v[52:55], v[76:79], v[124:127]
ds_read_b64_tr_b16 v[34:35], v12 offset:2368
s_waitcnt lgkmcnt(4)
v_mfma_f32_16x16x32_bf16 v[128:131], v[56:59], v[64:67], v[128:131]
v_mfma_f32_16x16x32_bf16 v[132:135], v[56:59], v[68:71], v[132:135]
ds_read_b64_tr_b16 v[36:37], v12 offset:18496
v_mfma_f32_16x16x32_bf16 v[136:139], v[56:59], v[72:75], v[136:139]
v_mfma_f32_16x16x32_bf16 v[140:143], v[56:59], v[76:79], v[140:143]
ds_read_b64_tr_b16 v[38:39], v12 offset:20800
s_waitcnt lgkmcnt(4)
v_mfma_f32_16x16x32_bf16 v[144:147], v[60:63], v[64:67], v[144:147]
v_mfma_f32_16x16x32_bf16 v[148:151], v[60:63], v[68:71], v[148:151]
ds_read_b64_tr_b16 v[40:41], v15 offset:96
v_mfma_f32_16x16x32_bf16 v[152:155], v[60:63], v[72:75], v[152:155]
v_mfma_f32_16x16x32_bf16 v[156:159], v[60:63], v[76:79], v[156:159]
ds_read_b64_tr_b16 v[42:43], v15 offset:2400
s_waitcnt lgkmcnt(4)
v_mfma_f32_16x16x32_bf16 v[160:163], v[32:35], v[64:67], v[160:163]
v_mfma_f32_16x16x32_bf16 v[164:167], v[32:35], v[68:71], v[164:167]
ds_read_b64_tr_b16 v[44:45], v15 offset:18528
v_mfma_f32_16x16x32_bf16 v[168:171], v[32:35], v[72:75], v[168:171]
v_mfma_f32_16x16x32_bf16 v[172:175], v[32:35], v[76:79], v[172:175]
ds_read_b64_tr_b16 v[46:47], v15 offset:20832
s_waitcnt lgkmcnt(4)
v_mfma_f32_16x16x32_bf16 v[176:179], v[36:39], v[64:67], v[176:179]
v_mfma_f32_16x16x32_bf16 v[180:183], v[36:39], v[68:71], v[180:183]
ds_read_b64_tr_b16 v[48:49], v12 offset:128
v_mfma_f32_16x16x32_bf16 v[184:187], v[36:39], v[72:75], v[184:187]
v_mfma_f32_16x16x32_bf16 v[188:191], v[36:39], v[76:79], v[188:191]
ds_read_b64_tr_b16 v[50:51], v12 offset:2432
s_waitcnt lgkmcnt(4)
v_mfma_f32_16x16x32_bf16 v[192:195], v[40:43], v[64:67], v[192:195]
v_mfma_f32_16x16x32_bf16 v[196:199], v[40:43], v[68:71], v[196:199]
ds_read_b64_tr_b16 v[52:53], v12 offset:18560
v_mfma_f32_16x16x32_bf16 v[200:203], v[40:43], v[72:75], v[200:203]
v_mfma_f32_16x16x32_bf16 v[204:207], v[40:43], v[76:79], v[204:207]
ds_read_b64_tr_b16 v[54:55], v12 offset:20864
s_waitcnt lgkmcnt(4)
v_mfma_f32_16x16x32_bf16 v[208:211], v[44:47], v[64:67], v[208:211]
v_mfma_f32_16x16x32_bf16 v[212:215], v[44:47], v[68:71], v[212:215]
v_mfma_f32_16x16x32_bf16 v[216:219], v[44:47], v[72:75], v[216:219]
v_mfma_f32_16x16x32_bf16 v[220:223], v[44:47], v[76:79], v[220:223]
s_waitcnt lgkmcnt(0)
s_waitcnt vmcnt(5)
s_barrier
ds_read_b128 v[80:83], v10 offset:0
ds_read_b128 v[84:87], v10 offset:1024
ds_read_b128 v[88:91], v10 offset:2048
ds_read_b128 v[92:95], v10 offset:3072
ds_read_b64_tr_b16 v[56:57], v13 offset:0
ds_read_b64_tr_b16 v[58:59], v13 offset:2304
ds_read_b64_tr_b16 v[60:61], v13 offset:18432
ds_read_b64_tr_b16 v[62:63], v13 offset:20736
ds_read_b64_tr_b16 v[32:33], v16 offset:32
ds_read_b64_tr_b16 v[34:35], v16 offset:2336
v_mfma_f32_16x16x32_bf16 v[224:227], v[48:51], v[64:67], v[224:227]
v_mfma_f32_16x16x32_bf16 v[228:231], v[48:51], v[68:71], v[228:231]
s_add_u32 m0, s84, 45056
s_add_u32 s94, s82, 13312
v_mfma_f32_16x16x32_bf16 v[232:235], v[48:51], v[72:75], v[232:235]
buffer_load_dwordx4 v1, s[20:23], s94 offen sc1 lds
v_mfma_f32_16x16x32_bf16 v[236:239], v[48:51], v[76:79], v[236:239]
v_mfma_f32_16x16x32_bf16 v[240:243], v[52:55], v[64:67], v[240:243]
s_add_u32 m0, s83, 45056
s_add_u32 s95, s81, 3612672
v_mfma_f32_16x16x32_bf16 v[244:247], v[52:55], v[68:71], v[244:247]
buffer_load_dwordx4 v2, s[8:11], s95 offen  lds
v_mfma_f32_16x16x32_bf16 v[248:251], v[52:55], v[72:75], v[248:251]
v_mfma_f32_16x16x32_bf16 v[252:255], v[52:55], v[76:79], v[252:255]
s_add_u32 m0, s83, 46080
s_waitcnt lgkmcnt(4)
v_mfma_f32_16x16x32_bf16 v[96:99], v[56:59], v[80:83], v[96:99]
buffer_load_dwordx4 v3, s[8:11], s95 offen  lds
v_mfma_f32_16x16x32_bf16 v[100:103], v[56:59], v[84:87], v[100:103]
ds_read_b64_tr_b16 v[36:37], v16 offset:18464
v_mfma_f32_16x16x32_bf16 v[104:107], v[56:59], v[88:91], v[104:107]
s_add_u32 m0, s83, 63488
v_mfma_f32_16x16x32_bf16 v[108:111], v[56:59], v[92:95], v[108:111]
buffer_load_dwordx4 v2, s[12:15], s95 offen  lds
ds_read_b64_tr_b16 v[38:39], v16 offset:20768
s_waitcnt lgkmcnt(4)
v_mfma_f32_16x16x32_bf16 v[112:115], v[60:63], v[80:83], v[112:115]
v_mfma_f32_16x16x32_bf16 v[116:119], v[60:63], v[84:87], v[116:119]
s_add_u32 m0, s83, 64512
ds_read_b64_tr_b16 v[40:41], v13 offset:64
v_mfma_f32_16x16x32_bf16 v[120:123], v[60:63], v[88:91], v[120:123]
buffer_load_dwordx4 v3, s[12:15], s95 offen  lds
v_mfma_f32_16x16x32_bf16 v[124:127], v[60:63], v[92:95], v[124:127]
ds_read_b64_tr_b16 v[42:43], v13 offset:2368
s_waitcnt lgkmcnt(4)
v_mfma_f32_16x16x32_bf16 v[128:131], v[32:35], v[80:83], v[128:131]
v_mfma_f32_16x16x32_bf16 v[132:135], v[32:35], v[84:87], v[132:135]
ds_read_b64_tr_b16 v[44:45], v13 offset:18496
v_mfma_f32_16x16x32_bf16 v[136:139], v[32:35], v[88:91], v[136:139]
v_mfma_f32_16x16x32_bf16 v[140:143], v[32:35], v[92:95], v[140:143]
ds_read_b64_tr_b16 v[46:47], v13 offset:20800
s_waitcnt lgkmcnt(4)
v_mfma_f32_16x16x32_bf16 v[144:147], v[36:39], v[80:83], v[144:147]
v_mfma_f32_16x16x32_bf16 v[148:151], v[36:39], v[84:87], v[148:151]
ds_read_b64_tr_b16 v[48:49], v16 offset:96
v_mfma_f32_16x16x32_bf16 v[152:155], v[36:39], v[88:91], v[152:155]
v_mfma_f32_16x16x32_bf16 v[156:159], v[36:39], v[92:95], v[156:159]
ds_read_b64_tr_b16 v[50:51], v16 offset:2400
s_waitcnt lgkmcnt(4)
v_mfma_f32_16x16x32_bf16 v[160:163], v[40:43], v[80:83], v[160:163]
v_mfma_f32_16x16x32_bf16 v[164:167], v[40:43], v[84:87], v[164:167]
ds_read_b64_tr_b16 v[52:53], v16 offset:18528
v_mfma_f32_16x16x32_bf16 v[168:171], v[40:43], v[88:91], v[168:171]
v_mfma_f32_16x16x32_bf16 v[172:175], v[40:43], v[92:95], v[172:175]
ds_read_b64_tr_b16 v[54:55], v16 offset:20832
s_waitcnt lgkmcnt(4)
v_mfma_f32_16x16x32_bf16 v[176:179], v[44:47], v[80:83], v[176:179]
v_mfma_f32_16x16x32_bf16 v[180:183], v[44:47], v[84:87], v[180:183]
ds_read_b64_tr_b16 v[56:57], v13 offset:128
v_mfma_f32_16x16x32_bf16 v[184:187], v[44:47], v[88:91], v[184:187]
v_mfma_f32_16x16x32_bf16 v[188:191], v[44:47], v[92:95], v[188:191]
ds_read_b64_tr_b16 v[58:59], v13 offset:2432
s_waitcnt lgkmcnt(4)
v_mfma_f32_16x16x32_bf16 v[192:195], v[48:51], v[80:83], v[192:195]
v_mfma_f32_16x16x32_bf16 v[196:199], v[48:51], v[84:87], v[196:199]
ds_read_b64_tr_b16 v[60:61], v13 offset:18560
v_mfma_f32_16x16x32_bf16 v[200:203], v[48:51], v[88:91], v[200:203]
v_mfma_f32_16x16x32_bf16 v[204:207], v[48:51], v[92:95], v[204:207]
ds_read_b64_tr_b16 v[62:63], v13 offset:20864
s_waitcnt lgkmcnt(4)
v_mfma_f32_16x16x32_bf16 v[208:211], v[52:55], v[80:83], v[208:211]
v_mfma_f32_16x16x32_bf16 v[212:215], v[52:55], v[84:87], v[212:215]
v_mfma_f32_16x16x32_bf16 v[216:219], v[52:55], v[88:91], v[216:219]
v_mfma_f32_16x16x32_bf16 v[220:223], v[52:55], v[92:95], v[220:223]
s_waitcnt lgkmcnt(0)
s_waitcnt vmcnt(5)
s_barrier
ds_read_b128 v[64:67], v8 offset:0
ds_read_b128 v[68:71], v8 offset:1024
ds_read_b128 v[72:75], v8 offset:2048
ds_read_b128 v[76:79], v8 offset:3072
ds_read_b64_tr_b16 v[32:33], v11 offset:0
ds_read_b64_tr_b16 v[34:35], v11 offset:2304
ds_read_b64_tr_b16 v[36:37], v11 offset:18432
ds_read_b64_tr_b16 v[38:39], v11 offset:20736
ds_read_b64_tr_b16 v[40:41], v14 offset:32
ds_read_b64_tr_b16 v[42:43], v14 offset:2336
v_mfma_f32_16x16x32_bf16 v[224:227], v[56:59], v[80:83], v[224:227]
v_mfma_f32_16x16x32_bf16 v[228:231], v[56:59], v[84:87], v[228:231]
s_add_u32 m0, s84, 90112
s_add_u32 s94, s82, 14336
v_mfma_f32_16x16x32_bf16 v[232:235], v[56:59], v[88:91], v[232:235]
buffer_load_dwordx4 v1, s[20:23], s94 offen sc1 lds
v_mfma_f32_16x16x32_bf16 v[236:239], v[56:59], v[92:95], v[236:239]
v_mfma_f32_16x16x32_bf16 v[240:243], v[60:63], v[80:83], v[240:243]
s_add_u32 m0, s83, 90112
s_add_u32 s95, s81, 4128768
v_mfma_f32_16x16x32_bf16 v[244:247], v[60:63], v[84:87], v[244:247]
buffer_load_dwordx4 v2, s[8:11], s95 offen  lds
v_mfma_f32_16x16x32_bf16 v[248:251], v[60:63], v[88:91], v[248:251]
v_mfma_f32_16x16x32_bf16 v[252:255], v[60:63], v[92:95], v[252:255]
s_add_u32 m0, s83, 91136
s_waitcnt lgkmcnt(4)
v_mfma_f32_16x16x32_bf16 v[96:99], v[32:35], v[64:67], v[96:99]
buffer_load_dwordx4 v3, s[8:11], s95 offen  lds
v_mfma_f32_16x16x32_bf16 v[100:103], v[32:35], v[68:71], v[100:103]
ds_read_b64_tr_b16 v[44:45], v14 offset:18464
v_mfma_f32_16x16x32_bf16 v[104:107], v[32:35], v[72:75], v[104:107]
s_add_u32 m0, s83, 108544
v_mfma_f32_16x16x32_bf16 v[108:111], v[32:35], v[76:79], v[108:111]
buffer_load_dwordx4 v2, s[12:15], s95 offen  lds
ds_read_b64_tr_b16 v[46:47], v14 offset:20768
s_waitcnt lgkmcnt(4)
v_mfma_f32_16x16x32_bf16 v[112:115], v[36:39], v[64:67], v[112:115]
v_mfma_f32_16x16x32_bf16 v[116:119], v[36:39], v[68:71], v[116:119]
s_add_u32 m0, s83, 109568
ds_read_b64_tr_b16 v[48:49], v11 offset:64
v_mfma_f32_16x16x32_bf16 v[120:123], v[36:39], v[72:75], v[120:123]
buffer_load_dwordx4 v3, s[12:15], s95 offen  lds
v_mfma_f32_16x16x32_bf16 v[124:127], v[36:39], v[76:79], v[124:127]
ds_read_b64_tr_b16 v[50:51], v11 offset:2368
s_waitcnt lgkmcnt(4)
v_mfma_f32_16x16x32_bf16 v[128:131], v[40:43], v[64:67], v[128:131]
v_mfma_f32_16x16x32_bf16 v[132:135], v[40:43], v[68:71], v[132:135]
ds_read_b64_tr_b16 v[52:53], v11 offset:18496
v_mfma_f32_16x16x32_bf16 v[136:139], v[40:43], v[72:75], v[136:139]
v_mfma_f32_16x16x32_bf16 v[140:143], v[40:43], v[76:79], v[140:143]
ds_read_b64_tr_b16 v[54:55], v11 offset:20800
s_waitcnt lgkmcnt(4)
v_mfma_f32_16x16x32_bf16 v[144:147], v[44:47], v[64:67], v[144:147]
v_mfma_f32_16x16x32_bf16 v[148:151], v[44:47], v[68:71], v[148:151]
ds_read_b64_tr_b16 v[56:57], v14 offset:96
v_mfma_f32_16x16x32_bf16 v[152:155], v[44:47], v[72:75], v[152:155]
v_mfma_f32_16x16x32_bf16 v[156:159], v[44:47], v[76:79], v[156:159]
ds_read_b64_tr_b16 v[58:59], v14 offset:2400
s_waitcnt lgkmcnt(4)
v_mfma_f32_16x16x32_bf16 v[160:163], v[48:51], v[64:67], v[160:163]
v_mfma_f32_16x16x32_bf16 v[164:167], v[48:51], v[68:71], v[164:167]
ds_read_b64_tr_b16 v[60:61], v14 offset:18528
v_mfma_f32_16x16x32_bf16 v[168:171], v[48:51], v[72:75], v[168:171]
v_mfma_f32_16x16x32_bf16 v[172:175], v[48:51], v[76:79], v[172:175]
ds_read_b64_tr_b16 v[62:63], v14 offset:20832
s_waitcnt lgkmcnt(4)
v_mfma_f32_16x16x32_bf16 v[176:179], v[52:55], v[64:67], v[176:179]
v_mfma_f32_16x16x32_bf16 v[180:183], v[52:55], v[68:71], v[180:183]
ds_read_b64_tr_b16 v[32:33], v11 offset:128
v_mfma_f32_16x16x32_bf16 v[184:187], v[52:55], v[72:75], v[184:187]
v_mfma_f32_16x16x32_bf16 v[188:191], v[52:55], v[76:79], v[188:191]
ds_read_b64_tr_b16 v[34:35], v11 offset:2432
s_waitcnt lgkmcnt(4)
v_mfma_f32_16x16x32_bf16 v[192:195], v[56:59], v[64:67], v[192:195]
v_mfma_f32_16x16x32_bf16 v[196:199], v[56:59], v[68:71], v[196:199]
ds_read_b64_tr_b16 v[36:37], v11 offset:18560
v_mfma_f32_16x16x32_bf16 v[200:203], v[56:59], v[72:75], v[200:203]
v_mfma_f32_16x16x32_bf16 v[204:207], v[56:59], v[76:79], v[204:207]
ds_read_b64_tr_b16 v[38:39], v11 offset:20864
s_waitcnt lgkmcnt(4)
v_mfma_f32_16x16x32_bf16 v[208:211], v[60:63], v[64:67], v[208:211]
v_mfma_f32_16x16x32_bf16 v[212:215], v[60:63], v[68:71], v[212:215]
v_mfma_f32_16x16x32_bf16 v[216:219], v[60:63], v[72:75], v[216:219]
v_mfma_f32_16x16x32_bf16 v[220:223], v[60:63], v[76:79], v[220:223]
s_waitcnt lgkmcnt(0)
s_waitcnt vmcnt(5)
s_barrier
ds_read_b128 v[80:83], v9 offset:0
ds_read_b128 v[84:87], v9 offset:1024
ds_read_b128 v[88:91], v9 offset:2048
ds_read_b128 v[92:95], v9 offset:3072
ds_read_b64_tr_b16 v[40:41], v12 offset:0
ds_read_b64_tr_b16 v[42:43], v12 offset:2304
ds_read_b64_tr_b16 v[44:45], v12 offset:18432
ds_read_b64_tr_b16 v[46:47], v12 offset:20736
ds_read_b64_tr_b16 v[48:49], v15 offset:32
ds_read_b64_tr_b16 v[50:51], v15 offset:2336
v_mfma_f32_16x16x32_bf16 v[224:227], v[32:35], v[64:67], v[224:227]
v_mfma_f32_16x16x32_bf16 v[228:231], v[32:35], v[68:71], v[228:231]
s_add_u32 m0, s84, 0
s_add_u32 s94, s82, 15360
v_mfma_f32_16x16x32_bf16 v[232:235], v[32:35], v[72:75], v[232:235]
buffer_load_dwordx4 v1, s[20:23], s94 offen sc1 lds
v_mfma_f32_16x16x32_bf16 v[236:239], v[32:35], v[76:79], v[236:239]
v_mfma_f32_16x16x32_bf16 v[240:243], v[36:39], v[64:67], v[240:243]
s_add_u32 m0, s83, 0
s_add_u32 s95, s81, 4202496
v_mfma_f32_16x16x32_bf16 v[244:247], v[36:39], v[68:71], v[244:247]
buffer_load_dwordx4 v2, s[8:11], s95 offen  lds
v_mfma_f32_16x16x32_bf16 v[248:251], v[36:39], v[72:75], v[248:251]
v_mfma_f32_16x16x32_bf16 v[252:255], v[36:39], v[76:79], v[252:255]
s_add_u32 m0, s83, 1024
s_waitcnt lgkmcnt(4)
v_mfma_f32_16x16x32_bf16 v[96:99], v[40:43], v[80:83], v[96:99]
buffer_load_dwordx4 v3, s[8:11], s95 offen  lds
v_mfma_f32_16x16x32_bf16 v[100:103], v[40:43], v[84:87], v[100:103]
ds_read_b64_tr_b16 v[52:53], v15 offset:18464
v_mfma_f32_16x16x32_bf16 v[104:107], v[40:43], v[88:91], v[104:107]
s_add_u32 m0, s83, 18432
v_mfma_f32_16x16x32_bf16 v[108:111], v[40:43], v[92:95], v[108:111]
buffer_load_dwordx4 v2, s[12:15], s95 offen  lds
ds_read_b64_tr_b16 v[54:55], v15 offset:20768
s_waitcnt lgkmcnt(4)
v_mfma_f32_16x16x32_bf16 v[112:115], v[44:47], v[80:83], v[112:115]
v_mfma_f32_16x16x32_bf16 v[116:119], v[44:47], v[84:87], v[116:119]
s_add_u32 m0, s83, 19456
ds_read_b64_tr_b16 v[56:57], v12 offset:64
v_mfma_f32_16x16x32_bf16 v[120:123], v[44:47], v[88:91], v[120:123]
buffer_load_dwordx4 v3, s[12:15], s95 offen  lds
v_mfma_f32_16x16x32_bf16 v[124:127], v[44:47], v[92:95], v[124:127]
ds_read_b64_tr_b16 v[58:59], v12 offset:2368
s_waitcnt lgkmcnt(4)
v_mfma_f32_16x16x32_bf16 v[128:131], v[48:51], v[80:83], v[128:131]
v_mfma_f32_16x16x32_bf16 v[132:135], v[48:51], v[84:87], v[132:135]
ds_read_b64_tr_b16 v[60:61], v12 offset:18496
v_mfma_f32_16x16x32_bf16 v[136:139], v[48:51], v[88:91], v[136:139]
v_mfma_f32_16x16x32_bf16 v[140:143], v[48:51], v[92:95], v[140:143]
ds_read_b64_tr_b16 v[62:63], v12 offset:20800
s_waitcnt lgkmcnt(4)
v_mfma_f32_16x16x32_bf16 v[144:147], v[52:55], v[80:83], v[144:147]
v_mfma_f32_16x16x32_bf16 v[148:151], v[52:55], v[84:87], v[148:151]
ds_read_b64_tr_b16 v[32:33], v15 offset:96
v_mfma_f32_16x16x32_bf16 v[152:155], v[52:55], v[88:91], v[152:155]
v_mfma_f32_16x16x32_bf16 v[156:159], v[52:55], v[92:95], v[156:159]
ds_read_b64_tr_b16 v[34:35], v15 offset:2400
s_waitcnt lgkmcnt(4)
v_mfma_f32_16x16x32_bf16 v[160:163], v[56:59], v[80:83], v[160:163]
v_mfma_f32_16x16x32_bf16 v[164:167], v[56:59], v[84:87], v[164:167]
ds_read_b64_tr_b16 v[36:37], v15 offset:18528
v_mfma_f32_16x16x32_bf16 v[168:171], v[56:59], v[88:91], v[168:171]
v_mfma_f32_16x16x32_bf16 v[172:175], v[56:59], v[92:95], v[172:175]
ds_read_b64_tr_b16 v[38:39], v15 offset:20832
s_waitcnt lgkmcnt(4)
v_mfma_f32_16x16x32_bf16 v[176:179], v[60:63], v[80:83], v[176:179]
v_mfma_f32_16x16x32_bf16 v[180:183], v[60:63], v[84:87], v[180:183]
ds_read_b64_tr_b16 v[40:41], v12 offset:128
v_mfma_f32_16x16x32_bf16 v[184:187], v[60:63], v[88:91], v[184:187]
v_mfma_f32_16x16x32_bf16 v[188:191], v[60:63], v[92:95], v[188:191]
ds_read_b64_tr_b16 v[42:43], v12 offset:2432
s_waitcnt lgkmcnt(4)
v_mfma_f32_16x16x32_bf16 v[192:195], v[32:35], v[80:83], v[192:195]
v_mfma_f32_16x16x32_bf16 v[196:199], v[32:35], v[84:87], v[196:199]
ds_read_b64_tr_b16 v[44:45], v12 offset:18560
v_mfma_f32_16x16x32_bf16 v[200:203], v[32:35], v[88:91], v[200:203]
v_mfma_f32_16x16x32_bf16 v[204:207], v[32:35], v[92:95], v[204:207]
ds_read_b64_tr_b16 v[46:47], v12 offset:20864
s_waitcnt lgkmcnt(4)
v_mfma_f32_16x16x32_bf16 v[208:211], v[36:39], v[80:83], v[208:211]
v_mfma_f32_16x16x32_bf16 v[212:215], v[36:39], v[84:87], v[212:215]
v_mfma_f32_16x16x32_bf16 v[216:219], v[36:39], v[88:91], v[216:219]
v_mfma_f32_16x16x32_bf16 v[220:223], v[36:39], v[92:95], v[220:223]
s_waitcnt lgkmcnt(0)
s_waitcnt vmcnt(5)
s_barrier
ds_read_b128 v[64:67], v10 offset:0
ds_read_b128 v[68:71], v10 offset:1024
ds_read_b128 v[72:75], v10 offset:2048
ds_read_b128 v[76:79], v10 offset:3072
ds_read_b64_tr_b16 v[48:49], v13 offset:0
ds_read_b64_tr_b16 v[50:51], v13 offset:2304
ds_read_b64_tr_b16 v[52:53], v13 offset:18432
ds_read_b64_tr_b16 v[54:55], v13 offset:20736
ds_read_b64_tr_b16 v[56:57], v16 offset:32
ds_read_b64_tr_b16 v[58:59], v16 offset:2336
v_mfma_f32_16x16x32_bf16 v[224:227], v[40:43], v[80:83], v[224:227]
v_mfma_f32_16x16x32_bf16 v[228:231], v[40:43], v[84:87], v[228:231]
s_add_u32 m0, s84, 45056
s_add_u32 s94, s82, 16384
v_mfma_f32_16x16x32_bf16 v[232:235], v[40:43], v[88:91], v[232:235]
buffer_load_dwordx4 v1, s[20:23], s94 offen sc1 lds
v_mfma_f32_16x16x32_bf16 v[236:239], v[40:43], v[92:95], v[236:239]
v_mfma_f32_16x16x32_bf16 v[240:243], v[44:47], v[80:83], v[240:243]
s_add_u32 m0, s83, 45056
s_add_u32 s95, s81, 4718592
v_mfma_f32_16x16x32_bf16 v[244:247], v[44:47], v[84:87], v[244:247]
buffer_load_dwordx4 v2, s[8:11], s95 offen  lds
v_mfma_f32_16x16x32_bf16 v[248:251], v[44:47], v[88:91], v[248:251]
v_mfma_f32_16x16x32_bf16 v[252:255], v[44:47], v[92:95], v[252:255]
s_add_u32 m0, s83, 46080
s_waitcnt lgkmcnt(4)
v_mfma_f32_16x16x32_bf16 v[96:99], v[48:51], v[64:67], v[96:99]
buffer_load_dwordx4 v3, s[8:11], s95 offen  lds
v_mfma_f32_16x16x32_bf16 v[100:103], v[48:51], v[68:71], v[100:103]
ds_read_b64_tr_b16 v[60:61], v16 offset:18464
v_mfma_f32_16x16x32_bf16 v[104:107], v[48:51], v[72:75], v[104:107]
s_add_u32 m0, s83, 63488
v_mfma_f32_16x16x32_bf16 v[108:111], v[48:51], v[76:79], v[108:111]
buffer_load_dwordx4 v2, s[12:15], s95 offen  lds
ds_read_b64_tr_b16 v[62:63], v16 offset:20768
s_waitcnt lgkmcnt(4)
v_mfma_f32_16x16x32_bf16 v[112:115], v[52:55], v[64:67], v[112:115]
v_mfma_f32_16x16x32_bf16 v[116:119], v[52:55], v[68:71], v[116:119]
s_add_u32 m0, s83, 64512
ds_read_b64_tr_b16 v[32:33], v13 offset:64
v_mfma_f32_16x16x32_bf16 v[120:123], v[52:55], v[72:75], v[120:123]
buffer_load_dwordx4 v3, s[12:15], s95 offen  lds
v_mfma_f32_16x16x32_bf16 v[124:127], v[52:55], v[76:79], v[124:127]
ds_read_b64_tr_b16 v[34:35], v13 offset:2368
s_waitcnt lgkmcnt(4)
v_mfma_f32_16x16x32_bf16 v[128:131], v[56:59], v[64:67], v[128:131]
v_mfma_f32_16x16x32_bf16 v[132:135], v[56:59], v[68:71], v[132:135]
ds_read_b64_tr_b16 v[36:37], v13 offset:18496
v_mfma_f32_16x16x32_bf16 v[136:139], v[56:59], v[72:75], v[136:139]
v_mfma_f32_16x16x32_bf16 v[140:143], v[56:59], v[76:79], v[140:143]
ds_read_b64_tr_b16 v[38:39], v13 offset:20800
s_waitcnt lgkmcnt(4)
v_mfma_f32_16x16x32_bf16 v[144:147], v[60:63], v[64:67], v[144:147]
v_mfma_f32_16x16x32_bf16 v[148:151], v[60:63], v[68:71], v[148:151]
ds_read_b64_tr_b16 v[40:41], v16 offset:96
v_mfma_f32_16x16x32_bf16 v[152:155], v[60:63], v[72:75], v[152:155]
v_mfma_f32_16x16x32_bf16 v[156:159], v[60:63], v[76:79], v[156:159]
ds_read_b64_tr_b16 v[42:43], v16 offset:2400
s_waitcnt lgkmcnt(4)
v_mfma_f32_16x16x32_bf16 v[160:163], v[32:35], v[64:67], v[160:163]
v_mfma_f32_16x16x32_bf16 v[164:167], v[32:35], v[68:71], v[164:167]
ds_read_b64_tr_b16 v[44:45], v16 offset:18528
v_mfma_f32_16x16x32_bf16 v[168:171], v[32:35], v[72:75], v[168:171]
v_mfma_f32_16x16x32_bf16 v[172:175], v[32:35], v[76:79], v[172:175]
ds_read_b64_tr_b16 v[46:47], v16 offset:20832
s_waitcnt lgkmcnt(4)
v_mfma_f32_16x16x32_bf16 v[176:179], v[36:39], v[64:67], v[176:179]
v_mfma_f32_16x16x32_bf16 v[180:183], v[36:39], v[68:71], v[180:183]
ds_read_b64_tr_b16 v[48:49], v13 offset:128
v_mfma_f32_16x16x32_bf16 v[184:187], v[36:39], v[72:75], v[184:187]
v_mfma_f32_16x16x32_bf16 v[188:191], v[36:39], v[76:79], v[188:191]
ds_read_b64_tr_b16 v[50:51], v13 offset:2432
s_waitcnt lgkmcnt(4)
v_mfma_f32_16x16x32_bf16 v[192:195], v[40:43], v[64:67], v[192:195]
v_mfma_f32_16x16x32_bf16 v[196:199], v[40:43], v[68:71], v[196:199]
ds_read_b64_tr_b16 v[52:53], v13 offset:18560
v_mfma_f32_16x16x32_bf16 v[200:203], v[40:43], v[72:75], v[200:203]
v_mfma_f32_16x16x32_bf16 v[204:207], v[40:43], v[76:79], v[204:207]
ds_read_b64_tr_b16 v[54:55], v13 offset:20864
s_waitcnt lgkmcnt(4)
v_mfma_f32_16x16x32_bf16 v[208:211], v[44:47], v[64:67], v[208:211]
v_mfma_f32_16x16x32_bf16 v[212:215], v[44:47], v[68:71], v[212:215]
v_mfma_f32_16x16x32_bf16 v[216:219], v[44:47], v[72:75], v[216:219]
v_mfma_f32_16x16x32_bf16 v[220:223], v[44:47], v[76:79], v[220:223]
s_waitcnt lgkmcnt(0)
s_waitcnt vmcnt(5)
s_barrier
ds_read_b128 v[80:83], v8 offset:0
ds_read_b128 v[84:87], v8 offset:1024
ds_read_b128 v[88:91], v8 offset:2048
ds_read_b128 v[92:95], v8 offset:3072
ds_read_b64_tr_b16 v[56:57], v11 offset:0
ds_read_b64_tr_b16 v[58:59], v11 offset:2304
ds_read_b64_tr_b16 v[60:61], v11 offset:18432
ds_read_b64_tr_b16 v[62:63], v11 offset:20736
ds_read_b64_tr_b16 v[32:33], v14 offset:32
ds_read_b64_tr_b16 v[34:35], v14 offset:2336
v_mfma_f32_16x16x32_bf16 v[224:227], v[48:51], v[64:67], v[224:227]
v_mfma_f32_16x16x32_bf16 v[228:231], v[48:51], v[68:71], v[228:231]
s_add_u32 m0, s84, 90112
s_add_u32 s94, s82, 17408
v_mfma_f32_16x16x32_bf16 v[232:235], v[48:51], v[72:75], v[232:235]
buffer_load_dwordx4 v1, s[20:23], s94 offen sc1 lds
v_mfma_f32_16x16x32_bf16 v[236:239], v[48:51], v[76:79], v[236:239]
v_mfma_f32_16x16x32_bf16 v[240:243], v[52:55], v[64:67], v[240:243]
s_add_u32 m0, s83, 90112
s_add_u32 s95, s81, 4792320
v_mfma_f32_16x16x32_bf16 v[244:247], v[52:55], v[68:71], v[244:247]
buffer_load_dwordx4 v2, s[8:11], s95 offen  lds
v_mfma_f32_16x16x32_bf16 v[248:251], v[52:55], v[72:75], v[248:251]
v_mfma_f32_16x16x32_bf16 v[252:255], v[52:55], v[76:79], v[252:255]
s_add_u32 m0, s83, 91136
s_waitcnt lgkmcnt(4)
v_mfma_f32_16x16x32_bf16 v[96:99], v[56:59], v[80:83], v[96:99]
buffer_load_dwordx4 v3, s[8:11], s95 offen  lds
v_mfma_f32_16x16x32_bf16 v[100:103], v[56:59], v[84:87], v[100:103]
ds_read_b64_tr_b16 v[36:37], v14 offset:18464
v_mfma_f32_16x16x32_bf16 v[104:107], v[56:59], v[88:91], v[104:107]
s_add_u32 m0, s83, 108544
v_mfma_f32_16x16x32_bf16 v[108:111], v[56:59], v[92:95], v[108:111]
buffer_load_dwordx4 v2, s[12:15], s95 offen  lds
ds_read_b64_tr_b16 v[38:39], v14 offset:20768
s_waitcnt lgkmcnt(4)
v_mfma_f32_16x16x32_bf16 v[112:115], v[60:63], v[80:83], v[112:115]
v_mfma_f32_16x16x32_bf16 v[116:119], v[60:63], v[84:87], v[116:119]
s_add_u32 m0, s83, 109568
ds_read_b64_tr_b16 v[40:41], v11 offset:64
v_mfma_f32_16x16x32_bf16 v[120:123], v[60:63], v[88:91], v[120:123]
buffer_load_dwordx4 v3, s[12:15], s95 offen  lds
v_mfma_f32_16x16x32_bf16 v[124:127], v[60:63], v[92:95], v[124:127]
ds_read_b64_tr_b16 v[42:43], v11 offset:2368
s_waitcnt lgkmcnt(4)
v_mfma_f32_16x16x32_bf16 v[128:131], v[32:35], v[80:83], v[128:131]
v_mfma_f32_16x16x32_bf16 v[132:135], v[32:35], v[84:87], v[132:135]
ds_read_b64_tr_b16 v[44:45], v11 offset:18496
v_mfma_f32_16x16x32_bf16 v[136:139], v[32:35], v[88:91], v[136:139]
v_mfma_f32_16x16x32_bf16 v[140:143], v[32:35], v[92:95], v[140:143]
ds_read_b64_tr_b16 v[46:47], v11 offset:20800
s_waitcnt lgkmcnt(4)
v_mfma_f32_16x16x32_bf16 v[144:147], v[36:39], v[80:83], v[144:147]
v_mfma_f32_16x16x32_bf16 v[148:151], v[36:39], v[84:87], v[148:151]
ds_read_b64_tr_b16 v[48:49], v14 offset:96
v_mfma_f32_16x16x32_bf16 v[152:155], v[36:39], v[88:91], v[152:155]
v_mfma_f32_16x16x32_bf16 v[156:159], v[36:39], v[92:95], v[156:159]
ds_read_b64_tr_b16 v[50:51], v14 offset:2400
s_waitcnt lgkmcnt(4)
v_mfma_f32_16x16x32_bf16 v[160:163], v[40:43], v[80:83], v[160:163]
v_mfma_f32_16x16x32_bf16 v[164:167], v[40:43], v[84:87], v[164:167]
ds_read_b64_tr_b16 v[52:53], v14 offset:18528
v_mfma_f32_16x16x32_bf16 v[168:171], v[40:43], v[88:91], v[168:171]
v_mfma_f32_16x16x32_bf16 v[172:175], v[40:43], v[92:95], v[172:175]
ds_read_b64_tr_b16 v[54:55], v14 offset:20832
s_waitcnt lgkmcnt(4)
v_mfma_f32_16x16x32_bf16 v[176:179], v[44:47], v[80:83], v[176:179]
v_mfma_f32_16x16x32_bf16 v[180:183], v[44:47], v[84:87], v[180:183]
ds_read_b64_tr_b16 v[56:57], v11 offset:128
v_mfma_f32_16x16x32_bf16 v[184:187], v[44:47], v[88:91], v[184:187]
v_mfma_f32_16x16x32_bf16 v[188:191], v[44:47], v[92:95], v[188:191]
ds_read_b64_tr_b16 v[58:59], v11 offset:2432
s_waitcnt lgkmcnt(4)
v_mfma_f32_16x16x32_bf16 v[192:195], v[48:51], v[80:83], v[192:195]
v_mfma_f32_16x16x32_bf16 v[196:199], v[48:51], v[84:87], v[196:199]
ds_read_b64_tr_b16 v[60:61], v11 offset:18560
v_mfma_f32_16x16x32_bf16 v[200:203], v[48:51], v[88:91], v[200:203]
v_mfma_f32_16x16x32_bf16 v[204:207], v[48:51], v[92:95], v[204:207]
ds_read_b64_tr_b16 v[62:63], v11 offset:20864
s_waitcnt lgkmcnt(4)
v_mfma_f32_16x16x32_bf16 v[208:211], v[52:55], v[80:83], v[208:211]
v_mfma_f32_16x16x32_bf16 v[212:215], v[52:55], v[84:87], v[212:215]
v_mfma_f32_16x16x32_bf16 v[216:219], v[52:55], v[88:91], v[216:219]
v_mfma_f32_16x16x32_bf16 v[220:223], v[52:55], v[92:95], v[220:223]
s_waitcnt lgkmcnt(0)
s_waitcnt vmcnt(5)
s_barrier
ds_read_b128 v[64:67], v9 offset:0
ds_read_b128 v[68:71], v9 offset:1024
ds_read_b128 v[72:75], v9 offset:2048
ds_read_b128 v[76:79], v9 offset:3072
ds_read_b64_tr_b16 v[32:33], v12 offset:0
ds_read_b64_tr_b16 v[34:35], v12 offset:2304
ds_read_b64_tr_b16 v[36:37], v12 offset:18432
ds_read_b64_tr_b16 v[38:39], v12 offset:20736
ds_read_b64_tr_b16 v[40:41], v15 offset:32
ds_read_b64_tr_b16 v[42:43], v15 offset:2336
v_mfma_f32_16x16x32_bf16 v[224:227], v[56:59], v[80:83], v[224:227]
v_mfma_f32_16x16x32_bf16 v[228:231], v[56:59], v[84:87], v[228:231]
s_add_u32 m0, s87, 0
s_add_u32 s94, s86, 0
v_mfma_f32_16x16x32_bf16 v[232:235], v[56:59], v[88:91], v[232:235]
buffer_load_dwordx4 v17, s[16:19], s94 offen  lds
v_mfma_f32_16x16x32_bf16 v[236:239], v[56:59], v[92:95], v[236:239]
v_mfma_f32_16x16x32_bf16 v[240:243], v[60:63], v[80:83], v[240:243]
s_add_u32 m0, s87, 1024
s_add_u32 s94, s86, 9216
v_mfma_f32_16x16x32_bf16 v[244:247], v[60:63], v[84:87], v[244:247]
buffer_load_dwordx4 v17, s[16:19], s94 offen  lds
v_mfma_f32_16x16x32_bf16 v[248:251], v[60:63], v[88:91], v[248:251]
v_mfma_f32_16x16x32_bf16 v[252:255], v[60:63], v[92:95], v[252:255]
s_add_u32 m0, s87, 2048
s_add_u32 s94, s86, 18432
s_waitcnt lgkmcnt(4)
v_mfma_f32_16x16x32_bf16 v[96:99], v[32:35], v[64:67], v[96:99]
buffer_load_dwordx4 v17, s[16:19], s94 offen  lds
v_mfma_f32_16x16x32_bf16 v[100:103], v[32:35], v[68:71], v[100:103]
ds_read_b64_tr_b16 v[44:45], v15 offset:18464
v_mfma_f32_16x16x32_bf16 v[104:107], v[32:35], v[72:75], v[104:107]
s_add_u32 m0, s87, 3072
s_add_u32 s94, s86, 27648
v_mfma_f32_16x16x32_bf16 v[108:111], v[32:35], v[76:79], v[108:111]
buffer_load_dwordx4 v17, s[16:19], s94 offen  lds
ds_read_b64_tr_b16 v[46:47], v15 offset:20768
s_waitcnt lgkmcnt(4)
v_mfma_f32_16x16x32_bf16 v[112:115], v[36:39], v[64:67], v[112:115]
v_mfma_f32_16x16x32_bf16 v[116:119], v[36:39], v[68:71], v[116:119]
ds_read_b64_tr_b16 v[48:49], v12 offset:64
v_mfma_f32_16x16x32_bf16 v[120:123], v[36:39], v[72:75], v[120:123]
v_mfma_f32_16x16x32_bf16 v[124:127], v[36:39], v[76:79], v[124:127]
ds_read_b64_tr_b16 v[50:51], v12 offset:2368
s_waitcnt lgkmcnt(4)
v_mfma_f32_16x16x32_bf16 v[128:131], v[40:43], v[64:67], v[128:131]
v_mfma_f32_16x16x32_bf16 v[132:135], v[40:43], v[68:71], v[132:135]
ds_read_b64_tr_b16 v[52:53], v12 offset:18496
v_mfma_f32_16x16x32_bf16 v[136:139], v[40:43], v[72:75], v[136:139]
v_mfma_f32_16x16x32_bf16 v[140:143], v[40:43], v[76:79], v[140:143]
ds_read_b64_tr_b16 v[54:55], v12 offset:20800
s_waitcnt lgkmcnt(4)
v_mfma_f32_16x16x32_bf16 v[144:147], v[44:47], v[64:67], v[144:147]
v_mfma_f32_16x16x32_bf16 v[148:151], v[44:47], v[68:71], v[148:151]
ds_read_b64_tr_b16 v[56:57], v15 offset:96
v_mfma_f32_16x16x32_bf16 v[152:155], v[44:47], v[72:75], v[152:155]
v_mfma_f32_16x16x32_bf16 v[156:159], v[44:47], v[76:79], v[156:159]
ds_read_b64_tr_b16 v[58:59], v15 offset:2400
s_waitcnt lgkmcnt(4)
v_mfma_f32_16x16x32_bf16 v[160:163], v[48:51], v[64:67], v[160:163]
v_mfma_f32_16x16x32_bf16 v[164:167], v[48:51], v[68:71], v[164:167]
ds_read_b64_tr_b16 v[60:61], v15 offset:18528
v_mfma_f32_16x16x32_bf16 v[168:171], v[48:51], v[72:75], v[168:171]
v_mfma_f32_16x16x32_bf16 v[172:175], v[48:51], v[76:79], v[172:175]
ds_read_b64_tr_b16 v[62:63], v15 offset:20832
s_waitcnt lgkmcnt(4)
v_mfma_f32_16x16x32_bf16 v[176:179], v[52:55], v[64:67], v[176:179]
v_mfma_f32_16x16x32_bf16 v[180:183], v[52:55], v[68:71], v[180:183]
ds_read_b64_tr_b16 v[32:33], v12 offset:128
v_mfma_f32_16x16x32_bf16 v[184:187], v[52:55], v[72:75], v[184:187]
v_mfma_f32_16x16x32_bf16 v[188:191], v[52:55], v[76:79], v[188:191]
ds_read_b64_tr_b16 v[34:35], v12 offset:2432
s_waitcnt lgkmcnt(4)
v_mfma_f32_16x16x32_bf16 v[192:195], v[56:59], v[64:67], v[192:195]
v_mfma_f32_16x16x32_bf16 v[196:199], v[56:59], v[68:71], v[196:199]
ds_read_b64_tr_b16 v[36:37], v12 offset:18560
v_mfma_f32_16x16x32_bf16 v[200:203], v[56:59], v[72:75], v[200:203]
v_mfma_f32_16x16x32_bf16 v[204:207], v[56:59], v[76:79], v[204:207]
ds_read_b64_tr_b16 v[38:39], v12 offset:20864
s_waitcnt lgkmcnt(4)
v_mfma_f32_16x16x32_bf16 v[208:211], v[60:63], v[64:67], v[208:211]
v_mfma_f32_16x16x32_bf16 v[212:215], v[60:63], v[68:71], v[212:215]
v_mfma_f32_16x16x32_bf16 v[216:219], v[60:63], v[72:75], v[216:219]
v_mfma_f32_16x16x32_bf16 v[220:223], v[60:63], v[76:79], v[220:223]
s_waitcnt lgkmcnt(0)
s_waitcnt vmcnt(4)
s_barrier
ds_read_b128 v[80:83], v10 offset:0
ds_read_b128 v[84:87], v10 offset:1024
ds_read_b128 v[88:91], v10 offset:2048
ds_read_b128 v[92:95], v10 offset:3072
ds_read_b64_tr_b16 v[40:41], v13 offset:0
ds_read_b64_tr_b16 v[42:43], v13 offset:2304
ds_read_b64_tr_b16 v[44:45], v13 offset:18432
ds_read_b64_tr_b16 v[46:47], v13 offset:20736
ds_read_b64_tr_b16 v[48:49], v16 offset:32
ds_read_b64_tr_b16 v[50:51], v16 offset:2336
v_mfma_f32_16x16x32_bf16 v[224:227], v[32:35], v[64:67], v[224:227]
v_mfma_f32_16x16x32_bf16 v[228:231], v[32:35], v[68:71], v[228:231]
s_add_u32 m0, s87, 36864
s_add_u32 s94, s86, 128
v_mfma_f32_16x16x32_bf16 v[232:235], v[32:35], v[72:75], v[232:235]
buffer_load_dwordx4 v17, s[16:19], s94 offen  lds
v_mfma_f32_16x16x32_bf16 v[236:239], v[32:35], v[76:79], v[236:239]
v_mfma_f32_16x16x32_bf16 v[240:243], v[36:39], v[64:67], v[240:243]
s_add_u32 m0, s87, 37888
s_add_u32 s94, s86, 9344
v_mfma_f32_16x16x32_bf16 v[244:247], v[36:39], v[68:71], v[244:247]
buffer_load_dwordx4 v17, s[16:19], s94 offen  lds
v_mfma_f32_16x16x32_bf16 v[248:251], v[36:39], v[72:75], v[248:251]
v_mfma_f32_16x16x32_bf16 v[252:255], v[36:39], v[76:79], v[252:255]
s_add_u32 m0, s87, 38912
s_add_u32 s94, s86, 18560
s_waitcnt lgkmcnt(4)
v_mfma_f32_16x16x32_bf16 v[96:99], v[40:43], v[80:83], v[96:99]
buffer_load_dwordx4 v17, s[16:19], s94 offen  lds
ds_read_b64_tr_b16 v[52:53], v16 offset:18464
ds_read_b64_tr_b16 v[54:55], v16 offset:20768
v_mov_b32 v9, 1073741824
v_mfma_f32_16x16x32_bf16 v[100:103], v[40:43], v[84:87], v[100:103]
v_lshrrev_b32 v5, 4, v0
v_and_b32 v6, 3, v0
v_bfe_u32 v7, v0, 3, 1
v_mfma_f32_16x16x32_bf16 v[104:107], v[40:43], v[88:91], v[104:107]
s_add_u32 m0, s87, 39936
s_add_u32 s94, s86, 27776
s_and_b32 s4, s58, 3
v_xor_b32 v14, s4, v5
v_mul_u32_u24 v2, 147456, v14
v_mfma_f32_16x16x32_bf16 v[108:111], v[40:43], v[92:95], v[108:111]
buffer_load_dwordx4 v17, s[16:19], s94 offen  lds
v_lshlrev_b32 v11, 8, v7
v_and_b32 v14, 7, v0
v_lshl_add_u32 v11, v14, 4, v11
v_add_u32 v2, v2, v11
s_waitcnt lgkmcnt(4)
v_mfma_f32_16x16x32_bf16 v[112:115], v[44:47], v[80:83], v[112:115]
ds_read_b64_tr_b16 v[56:57], v13 offset:64
ds_read_b64_tr_b16 v[58:59], v13 offset:2368
s_lshl_b32 s4, s59, 1
v_mfma_f32_16x16x32_bf16 v[116:119], v[44:47], v[84:87], v[116:119]
v_add_u32 v7, s4, v7
s_lshl_b32 s4, s80, 7
s_lshl_b32 s5, s59, 9
v_mfma_f32_16x16x32_bf16 v[120:123], v[44:47], v[88:91], v[120:123]
s_add_u32 s4, s4, s5
s_add_u32 s5, s4, 73728
v_add_u32 v11, s5, v11
v_mfma_f32_16x16x32_bf16 v[124:127], v[44:47], v[92:95], v[124:127]
s_add_u32 s90, s90, s4
s_lshl_b32 s4, s58, 10
s_add_u32 s90, s90, s4
s_and_b32 s4, s58, 12
s_waitcnt lgkmcnt(4)
v_mfma_f32_16x16x32_bf16 v[128:131], v[48:51], v[80:83], v[128:131]
ds_read_b64_tr_b16 v[60:61], v13 offset:18496
ds_read_b64_tr_b16 v[62:63], v13 offset:20800
s_mul_i32 s44, s4, 147456
v_mfma_f32_16x16x32_bf16 v[132:135], v[48:51], v[84:87], v[132:135]
s_add_u32 s44, s44, s90
s_xor_b32 s5, s4, 4
s_mul_i32 s45, s5, 147456
v_mfma_f32_16x16x32_bf16 v[136:139], v[48:51], v[88:91], v[136:139]
s_add_u32 s45, s45, s90
s_xor_b32 s5, s4, 8
s_mul_i32 s46, s5, 147456
v_mfma_f32_16x16x32_bf16 v[140:143], v[48:51], v[92:95], v[140:143]
s_add_u32 s46, s46, s90
s_xor_b32 s5, s4, 12
s_mul_i32 s47, s5, 147456
s_add_u32 s47, s47, s90
s_waitcnt lgkmcnt(4)
v_mfma_f32_16x16x32_bf16 v[144:147], v[52:55], v[80:83], v[144:147]
ds_read_b64_tr_b16 v[32:33], v16 offset:96
ds_read_b64_tr_b16 v[34:35], v16 offset:2400
v_and_b32 v10, 1023, v18
v_mfma_f32_16x16x32_bf16 v[148:151], v[52:55], v[84:87], v[148:151]
s_lshl_b32 s4, s89, 8
s_add_u32 s4, s4, 73728
v_add_u32 v10, s4, v10
s_lshr_b32 s3, s58, 3
v_mfma_f32_16x16x32_bf16 v[152:155], v[52:55], v[88:91], v[152:155]
s_and_b32 s5, s58, 7
v_lshrrev_b32 v14, 10, v18
v_cmp_eq_u32 s[48:49], s5, v14
v_mfma_f32_16x16x32_bf16 v[156:159], v[52:55], v[92:95], v[156:159]
s_cmp_eq_u32 s3, s59
s_cselect_b64 s[48:49], s[48:49], 0
v_cndmask_b32 v18, v18, v9, s[48:49]
s_lshl_b32 s5, s5, 7
s_lshl_b32 s91, s57, 2
s_waitcnt lgkmcnt(4)
v_mfma_f32_16x16x32_bf16 v[160:163], v[56:59], v[80:83], v[160:163]
ds_read_b64_tr_b16 v[36:37], v16 offset:18528
ds_read_b64_tr_b16 v[38:39], v16 offset:20832
s_lshl_b32 s3, s3, 1
v_mfma_f32_16x16x32_bf16 v[164:167], v[56:59], v[84:87], v[164:167]
s_add_u32 s91, s91, s3
s_add_u32 s91, s91, s80
s_lshl_b32 s3, s91, 1
v_mfma_f32_16x16x32_bf16 v[168:171], v[56:59], v[88:91], v[168:171]
v_add_u32 v3, s3, v5
v_mul_u32_u24 v3, 18432, v3
v_lshrrev_b32 v14, 1, v6
v_mfma_f32_16x16x32_bf16 v[172:175], v[56:59], v[92:95], v[172:175]
v_lshl_add_u32 v3, v14, 10, v3
v_lshl_add_u32 v3, v7, 4, v3
v_and_b32 v14, 1, v6
v_lshl_add_u32 v3, v14, 3, v3
s_waitcnt lgkmcnt(4)
v_mfma_f32_16x16x32_bf16 v[176:179], v[60:63], v[80:83], v[176:179]
ds_read_b64_tr_b16 v[40:41], v13 offset:128
ds_read_b64_tr_b16 v[42:43], v13 offset:2432
v_add_u32 v3, s5, v3
v_mfma_f32_16x16x32_bf16 v[180:183], v[60:63], v[84:87], v[180:183]
v_bfe_u32 v14, v0, 2, 1
v_lshl_add_u32 v3, v14, 6, v3
s_lshr_b32 s4, s5, 6
v_mfma_f32_16x16x32_bf16 v[184:187], v[60:63], v[88:91], v[184:187]
v_lshl_add_u32 v4, v5, 4, s4
v_add_u32 v4, v4, v14
v_lshl_add_u32 v4, v4, 6, s91
v_mfma_f32_16x16x32_bf16 v[188:191], v[60:63], v[92:95], v[188:191]
v_mul_u32_u24 v4, 1152, v4
v_lshl_add_u32 v4, v7, 5, v4
v_lshl_add_u32 v4, v6, 3, v4
v_cmp_gt_u32 vcc, 32, v0
s_waitcnt lgkmcnt(4)
v_mfma_f32_16x16x32_bf16 v[192:195], v[32:35], v[80:83], v[192:195]
ds_read_b64_tr_b16 v[44:45], v13 offset:18560
ds_read_b64_tr_b16 v[46:47], v13 offset:20864
v_cndmask_b32 v3, v9, v3, vcc
v_mfma_f32_16x16x32_bf16 v[196:199], v[32:35], v[84:87], v[196:199]
v_cndmask_b32 v4, v9, v4, vcc
v_lshlrev_b32 v14, 4, v14
v_lshl_add_u32 v14, v5, 2, v14
v_mfma_f32_16x16x32_bf16 v[200:203], v[32:35], v[88:91], v[200:203]
s_lshl_b32 s4, s58, 5
s_lshl_b32 s5, s80, 3
s_add_u32 s4, s4, s5
v_mfma_f32_16x16x32_bf16 v[204:207], v[32:35], v[92:95], v[204:207]
s_lshl_b32 s5, s57, 9
s_add_u32 s4, s4, s5
s_add_u32 s4, s4, 196608
v_add_u32 v27, s4, v14
s_waitcnt lgkmcnt(4)
v_mfma_f32_16x16x32_bf16 v[208:211], v[36:39], v[80:83], v[208:211]
s_lshl_b32 s4, s57, 11
s_add_u32 s4, s4, 32768
s_lshl_b32 s5, s58, 2
v_mfma_f32_16x16x32_bf16 v[212:215], v[36:39], v[84:87], v[212:215]
s_add_u32 s5, s5, s4
v_lshl_add_u32 v5, v0, 7, s5
v_cmp_gt_u32 vcc, 16, v0
v_mfma_f32_16x16x32_bf16 v[216:219], v[36:39], v[88:91], v[216:219]
s_nop 0
v_cndmask_b32 v9, v9, v5, vcc
s_lshl_b32 s5, s58, 7
s_add_u32 s5, s5, s4
v_mfma_f32_16x16x32_bf16 v[220:223], v[36:39], v[92:95], v[220:223]
v_and_b32 v5, 15, v0
v_lshl_add_u32 v8, v5, 2, s5
s_mov_b32 s91, 0.6931471805599453
s_lshr_b32 s3, s2, 3
s_mul_i32 s3, s3, 18
s_mul_i32 s4, s98, 576
s_add_u32 s3, s3, s4
v_add_u32 v28, s3, v0
v_mul_u32_u24 v28, 1152, v28
v_mov_b32 v29, 1073741824
v_cmp_gt_u32 vcc, 18, v0
s_nop 1
v_cndmask_b32 v28, v29, v28, vcc
s_lshl_b32 s3, s56, 7
s_add_u32 s3, s3, 256
s_cmp_eq_u32 s56, 7
s_cselect_b32 s3, 1073741824, s3
buffer_load_dword v26, v28, s[16:19], s3 offen
s_getpc_b64 s[4:5]
pf_ct17:
s_sub_u32 s4, s4, pf_ct17-pf_kernel
s_subb_u32 s5, s5, 0
s_bfe_u32 s3, s2, 0x30003
s_lshl_b32 s3, s3, 2
s_add_u32 s3, s3, s56
s_lshl_b32 s3, s3, 11
v_and_b32 v27, 15, v0
v_lshl_add_u32 v27, v27, 7, s3
v_min_u32 v27, pf_code_end-pf_kernel-4, v27
global_load_dword v26, v27, s[4:5]
s_waitcnt lgkmcnt(0)
s_barrier
v_mfma_f32_16x16x32_bf16 v[224:227], v[40:43], v[80:83], v[224:227]
v_mfma_f32_16x16x32_bf16 v[228:231], v[40:43], v[84:87], v[228:231]
v_mfma_f32_16x16x32_bf16 v[232:235], v[40:43], v[88:91], v[232:235]
v_mfma_f32_16x16x32_bf16 v[236:239], v[40:43], v[92:95], v[236:239]
v_mfma_f32_16x16x32_bf16 v[240:243], v[44:47], v[80:83], v[240:243]
v_mfma_f32_16x16x32_bf16 v[244:247], v[44:47], v[84:87], v[244:247]
v_mfma_f32_16x16x32_bf16 v[248:251], v[44:47], v[88:91], v[248:251]
v_mfma_f32_16x16x32_bf16 v[252:255], v[44:47], v[92:95], v[252:255]
s_mov_b32 s4, 1.0
s_mov_b32 s5, 1.0
v_exp_f32 v96, -v96
v_exp_f32 v97, -v97
v_exp_f32 v98, -v98
v_exp_f32 v99, -v99
v_exp_f32 v100, -v100
v_exp_f32 v101, -v101
v_exp_f32 v102, -v102
v_exp_f32 v103, -v103
v_pk_add_f32 v[96:97], v[96:97], s[4:5]
v_pk_add_f32 v[98:99], v[98:99], s[4:5]
v_pk_add_f32 v[100:101], v[100:101], s[4:5]
v_pk_add_f32 v[102:103], v[102:103], s[4:5]
v_rcp_f32 v96, v96
v_rcp_f32 v97, v97
v_rcp_f32 v98, v98
v_rcp_f32 v99, v99
v_rcp_f32 v100, v100
v_rcp_f32 v101, v101
v_rcp_f32 v102, v102
v_rcp_f32 v103, v103
v_pk_mul_f32 v[96:97], v[96:97], v[112:113]
v_pk_mul_f32 v[98:99], v[98:99], v[114:115]
v_pk_mul_f32 v[100:101], v[100:101], v[116:117]
v_pk_mul_f32 v[102:103], v[102:103], v[118:119]
v_cvt_pk_bf16_f32 v112, v96, v97
v_cvt_pk_bf16_f32 v113, v98, v99
v_cvt_pk_bf16_f32 v116, v100, v101
v_cvt_pk_bf16_f32 v117, v102, v103
v_exp_f32 v104, -v104
v_exp_f32 v105, -v105
v_exp_f32 v106, -v106
v_exp_f32 v107, -v107
v_exp_f32 v108, -v108
v_exp_f32 v109, -v109
v_exp_f32 v110, -v110
v_exp_f32 v111, -v111
v_pk_add_f32 v[104:105], v[104:105], s[4:5]
v_pk_add_f32 v[106:107], v[106:107], s[4:5]
v_pk_add_f32 v[108:109], v[108:109], s[4:5]
v_pk_add_f32 v[110:111], v[110:111], s[4:5]
v_rcp_f32 v104, v104
v_rcp_f32 v105, v105
v_rcp_f32 v106, v106
v_rcp_f32 v107, v107
v_rcp_f32 v108, v108
v_rcp_f32 v109, v109
v_rcp_f32 v110, v110
v_rcp_f32 v111, v111
v_pk_mul_f32 v[104:105], v[104:105], v[120:121]
v_pk_mul_f32 v[106:107], v[106:107], v[122:123]
v_pk_mul_f32 v[108:109], v[108:109], v[124:125]
v_pk_mul_f32 v[110:111], v[110:111], v[126:127]
v_cvt_pk_bf16_f32 v120, v104, v105
v_cvt_pk_bf16_f32 v121, v106, v107
v_cvt_pk_bf16_f32 v124, v108, v109
v_cvt_pk_bf16_f32 v125, v110, v111
ds_write_b64 v19, v[112:113] offset:0
ds_write_b64 v19, v[116:117] offset:9216
ds_write_b64 v19, v[120:121] offset:18432
ds_write_b64 v19, v[124:125] offset:27648
v_exp_f32 v128, -v128
v_exp_f32 v129, -v129
v_exp_f32 v130, -v130
v_exp_f32 v131, -v131
v_exp_f32 v132, -v132
v_exp_f32 v133, -v133
v_exp_f32 v134, -v134
v_exp_f32 v135, -v135
v_pk_add_f32 v[128:129], v[128:129], s[4:5]
v_pk_add_f32 v[130:131], v[130:131], s[4:5]
v_pk_add_f32 v[132:133], v[132:133], s[4:5]
v_pk_add_f32 v[134:135], v[134:135], s[4:5]
v_rcp_f32 v128, v128
v_rcp_f32 v129, v129
v_rcp_f32 v130, v130
v_rcp_f32 v131, v131
v_rcp_f32 v132, v132
v_rcp_f32 v133, v133
v_rcp_f32 v134, v134
v_rcp_f32 v135, v135
v_pk_mul_f32 v[128:129], v[128:129], v[144:145]
v_pk_mul_f32 v[130:131], v[130:131], v[146:147]
v_pk_mul_f32 v[132:133], v[132:133], v[148:149]
v_pk_mul_f32 v[134:135], v[134:135], v[150:151]
v_cvt_pk_bf16_f32 v144, v128, v129
v_cvt_pk_bf16_f32 v145, v130, v131
v_cvt_pk_bf16_f32 v148, v132, v133
v_cvt_pk_bf16_f32 v149, v134, v135
v_exp_f32 v136, -v136
v_exp_f32 v137, -v137
v_exp_f32 v138, -v138
v_exp_f32 v139, -v139
v_exp_f32 v140, -v140
v_exp_f32 v141, -v141
v_exp_f32 v142, -v142
v_exp_f32 v143, -v143
v_pk_add_f32 v[136:137], v[136:137], s[4:5]
v_pk_add_f32 v[138:139], v[138:139], s[4:5]
v_pk_add_f32 v[140:141], v[140:141], s[4:5]
v_pk_add_f32 v[142:143], v[142:143], s[4:5]
v_rcp_f32 v136, v136
v_rcp_f32 v137, v137
v_rcp_f32 v138, v138
v_rcp_f32 v139, v139
v_rcp_f32 v140, v140
v_rcp_f32 v141, v141
v_rcp_f32 v142, v142
v_rcp_f32 v143, v143
v_pk_mul_f32 v[136:137], v[136:137], v[152:153]
v_pk_mul_f32 v[138:139], v[138:139], v[154:155]
v_pk_mul_f32 v[140:141], v[140:141], v[156:157]
v_pk_mul_f32 v[142:143], v[142:143], v[158:159]
v_cvt_pk_bf16_f32 v152, v136, v137
v_cvt_pk_bf16_f32 v153, v138, v139
v_cvt_pk_bf16_f32 v156, v140, v141
v_cvt_pk_bf16_f32 v157, v142, v143
ds_write_b64 v25, v[144:145] offset:0
ds_write_b64 v25, v[148:149] offset:9216
ds_write_b64 v25, v[152:153] offset:18432
ds_write_b64 v25, v[156:157] offset:27648
v_exp_f32 v160, -v160
v_exp_f32 v161, -v161
v_exp_f32 v162, -v162
v_exp_f32 v163, -v163
v_exp_f32 v164, -v164
v_exp_f32 v165, -v165
v_exp_f32 v166, -v166
v_exp_f32 v167, -v167
v_pk_add_f32 v[160:161], v[160:161], s[4:5]
v_pk_add_f32 v[162:163], v[162:163], s[4:5]
v_pk_add_f32 v[164:165], v[164:165], s[4:5]
v_pk_add_f32 v[166:167], v[166:167], s[4:5]
v_rcp_f32 v160, v160
v_rcp_f32 v161, v161
v_rcp_f32 v162, v162
v_rcp_f32 v163, v163
v_rcp_f32 v164, v164
v_rcp_f32 v165, v165
v_rcp_f32 v166, v166
v_rcp_f32 v167, v167
v_pk_mul_f32 v[160:161], v[160:161], v[176:177]
v_pk_mul_f32 v[162:163], v[162:163], v[178:179]
v_pk_mul_f32 v[164:165], v[164:165], v[180:181]
v_pk_mul_f32 v[166:167], v[166:167], v[182:183]
v_cvt_pk_bf16_f32 v176, v160, v161
v_cvt_pk_bf16_f32 v177, v162, v163
v_cvt_pk_bf16_f32 v180, v164, v165
v_cvt_pk_bf16_f32 v181, v166, v167
v_exp_f32 v168, -v168
v_exp_f32 v169, -v169
v_exp_f32 v170, -v170
v_exp_f32 v171, -v171
v_exp_f32 v172, -v172
v_exp_f32 v173, -v173
v_exp_f32 v174, -v174
v_exp_f32 v175, -v175
v_pk_add_f32 v[168:169], v[168:169], s[4:5]
v_pk_add_f32 v[170:171], v[170:171], s[4:5]
v_pk_add_f32 v[172:173], v[172:173], s[4:5]
v_pk_add_f32 v[174:175], v[174:175], s[4:5]
v_rcp_f32 v168, v168
v_rcp_f32 v169, v169
v_rcp_f32 v170, v170
v_rcp_f32 v171, v171
v_rcp_f32 v172, v172
v_rcp_f32 v173, v173
v_rcp_f32 v174, v174
v_rcp_f32 v175, v175
v_pk_mul_f32 v[168:169], v[168:169], v[184:185]
v_pk_mul_f32 v[170:171], v[170:171], v[186:187]
v_pk_mul_f32 v[172:173], v[172:173], v[188:189]
v_pk_mul_f32 v[174:175], v[174:175], v[190:191]
v_cvt_pk_bf16_f32 v184, v168, v169
v_cvt_pk_bf16_f32 v185, v170, v171
v_cvt_pk_bf16_f32 v188, v172, v173
v_cvt_pk_bf16_f32 v189, v174, v175
ds_write_b64 v19, v[176:177] offset:1024
ds_write_b64 v19, v[180:181] offset:10240
ds_write_b64 v19, v[184:185] offset:19456
ds_write_b64 v19, v[188:189] offset:28672
v_exp_f32 v192, -v192
v_exp_f32 v193, -v193
v_exp_f32 v194, -v194
v_exp_f32 v195, -v195
v_exp_f32 v196, -v196
v_exp_f32 v197, -v197
v_exp_f32 v198, -v198
v_exp_f32 v199, -v199
v_pk_add_f32 v[192:193], v[192:193], s[4:5]
v_pk_add_f32 v[194:195], v[194:195], s[4:5]
v_pk_add_f32 v[196:197], v[196:197], s[4:5]
v_pk_add_f32 v[198:199], v[198:199], s[4:5]
v_rcp_f32 v192, v192
v_rcp_f32 v193, v193
v_rcp_f32 v194, v194
v_rcp_f32 v195, v195
v_rcp_f32 v196, v196
v_rcp_f32 v197, v197
v_rcp_f32 v198, v198
v_rcp_f32 v199, v199
v_pk_mul_f32 v[192:193], v[192:193], v[208:209]
v_pk_mul_f32 v[194:195], v[194:195], v[210:211]
v_pk_mul_f32 v[196:197], v[196:197], v[212:213]
v_pk_mul_f32 v[198:199], v[198:199], v[214:215]
v_cvt_pk_bf16_f32 v208, v192, v193
v_cvt_pk_bf16_f32 v209, v194, v195
v_cvt_pk_bf16_f32 v212, v196, v197
v_cvt_pk_bf16_f32 v213, v198, v199
v_exp_f32 v200, -v200
v_exp_f32 v201, -v201
v_exp_f32 v202, -v202
v_exp_f32 v203, -v203
v_exp_f32 v204, -v204
v_exp_f32 v205, -v205
v_exp_f32 v206, -v206
v_exp_f32 v207, -v207
v_pk_add_f32 v[200:201], v[200:201], s[4:5]
v_pk_add_f32 v[202:203], v[202:203], s[4:5]
v_pk_add_f32 v[204:205], v[204:205], s[4:5]
v_pk_add_f32 v[206:207], v[206:207], s[4:5]
v_rcp_f32 v200, v200
v_rcp_f32 v201, v201
v_rcp_f32 v202, v202
v_rcp_f32 v203, v203
v_rcp_f32 v204, v204
v_rcp_f32 v205, v205
v_rcp_f32 v206, v206
v_rcp_f32 v207, v207
v_pk_mul_f32 v[200:201], v[200:201], v[216:217]
v_pk_mul_f32 v[202:203], v[202:203], v[218:219]
v_pk_mul_f32 v[204:205], v[204:205], v[220:221]
v_pk_mul_f32 v[206:207], v[206:207], v[222:223]
v_cvt_pk_bf16_f32 v216, v200, v201
v_cvt_pk_bf16_f32 v217, v202, v203
v_cvt_pk_bf16_f32 v220, v204, v205
v_cvt_pk_bf16_f32 v221, v206, v207
ds_write_b64 v25, v[208:209] offset:1024
ds_write_b64 v25, v[212:213] offset:10240
ds_write_b64 v25, v[216:217] offset:19456
ds_write_b64 v25, v[220:221] offset:28672
v_exp_f32 v224, -v224
v_exp_f32 v225, -v225
v_exp_f32 v226, -v226
v_exp_f32 v227, -v227
v_exp_f32 v228, -v228
v_exp_f32 v229, -v229
v_exp_f32 v230, -v230
v_exp_f32 v231, -v231
v_pk_add_f32 v[224:225], v[224:225], s[4:5]
v_pk_add_f32 v[226:227], v[226:227], s[4:5]
v_pk_add_f32 v[228:229], v[228:229], s[4:5]
v_pk_add_f32 v[230:231], v[230:231], s[4:5]
v_rcp_f32 v224, v224
v_rcp_f32 v225, v225
v_rcp_f32 v226, v226
v_rcp_f32 v227, v227
v_rcp_f32 v228, v228
v_rcp_f32 v229, v229
v_rcp_f32 v230, v230
v_rcp_f32 v231, v231
v_pk_mul_f32 v[224:225], v[224:225], v[240:241]
v_pk_mul_f32 v[226:227], v[226:227], v[242:243]
v_pk_mul_f32 v[228:229], v[228:229], v[244:245]
v_pk_mul_f32 v[230:231], v[230:231], v[246:247]
v_cvt_pk_bf16_f32 v240, v224, v225
v_cvt_pk_bf16_f32 v241, v226, v227
v_cvt_pk_bf16_f32 v244, v228, v229
v_cvt_pk_bf16_f32 v245, v230, v231
v_exp_f32 v232, -v232
v_exp_f32 v233, -v233
v_exp_f32 v234, -v234
v_exp_f32 v235, -v235
v_exp_f32 v236, -v236
v_exp_f32 v237, -v237
v_exp_f32 v238, -v238
v_exp_f32 v239, -v239
v_pk_add_f32 v[232:233], v[232:233], s[4:5]
v_pk_add_f32 v[234:235], v[234:235], s[4:5]
v_pk_add_f32 v[236:237], v[236:237], s[4:5]
v_pk_add_f32 v[238:239], v[238:239], s[4:5]
v_rcp_f32 v232, v232
v_rcp_f32 v233, v233
v_rcp_f32 v234, v234
v_rcp_f32 v235, v235
v_rcp_f32 v236, v236
v_rcp_f32 v237, v237
v_rcp_f32 v238, v238
v_rcp_f32 v239, v239
v_pk_mul_f32 v[232:233], v[232:233], v[248:249]
v_pk_mul_f32 v[234:235], v[234:235], v[250:251]
v_pk_mul_f32 v[236:237], v[236:237], v[252:253]
v_pk_mul_f32 v[238:239], v[238:239], v[254:255]
v_cvt_pk_bf16_f32 v248, v232, v233
v_cvt_pk_bf16_f32 v249, v234, v235
v_cvt_pk_bf16_f32 v252, v236, v237
v_cvt_pk_bf16_f32 v253, v238, v239
ds_write_b64 v19, v[240:241] offset:2048
ds_write_b64 v19, v[244:245] offset:11264
ds_write_b64 v19, v[248:249] offset:20480
ds_write_b64 v19, v[252:253] offset:29696
v_and_b32 v5, 1, v0
v_lshlrev_b32 v5, 4, v5
s_movk_i32 s3, 0x3f80
v_lshlrev_b32 v5, v5, s3
v_bfe_u32 v6, v0, 1, 3
v_cmp_eq_u32 vcc, 0, v6
s_nop 1
v_cndmask_b32 v12, 0, v5, vcc
v_cmp_eq_u32 vcc, 1, v6
s_nop 1
v_cndmask_b32 v13, 0, v5, vcc
v_cmp_eq_u32 vcc, 2, v6
s_nop 1
v_cndmask_b32 v14, 0, v5, vcc
v_cmp_eq_u32 vcc, 3, v6
s_nop 1
v_cndmask_b32 v15, 0, v5, vcc
v_mov_b32 v5, 1
v_mov_b32 v16, 0x10001
s_waitcnt lgkmcnt(0)
s_waitcnt vmcnt(6)
s_barrier
ds_read_b64_tr_b16 v[28:29], v20 offset:0
ds_read_b64_tr_b16 v[30:31], v20 offset:2048
ds_read_b64_tr_b16 v[32:33], v20 offset:4096
ds_read_b64_tr_b16 v[34:35], v20 offset:6144
ds_read_b64_tr_b16 v[36:37], v20 offset:8192
ds_read_b64_tr_b16 v[38:39], v20 offset:10240
ds_read_b128 v[112:115], v24 offset:0
ds_read_b128 v[116:119], v24 offset:9216
ds_read_b128 v[120:123], v24 offset:18432
ds_read_b128 v[124:127], v24 offset:27648
ds_read_b128 v[128:131], v24 offset:1024
ds_read_b128 v[132:135], v24 offset:10240
ds_read_b128 v[136:139], v24 offset:19456
ds_read_b128 v[140:143], v24 offset:28672
ds_read_b128 v[144:147], v24 offset:2048
ds_read_b128 v[148:151], v24 offset:11264
ds_read_b128 v[152:155], v24 offset:20480
ds_read_b128 v[156:159], v24 offset:29696
s_waitcnt lgkmcnt(11)
v_mfma_f32_16x16x32_bf16 v[80:83], v[28:31], v[112:115], 0
ds_read_b64_tr_b16 v[40:41], v20 offset:12288
s_waitcnt lgkmcnt(8)
v_mfma_f32_16x16x32_bf16 v[80:83], v[32:35], v[128:131], v[80:83]
ds_read_b64_tr_b16 v[42:43], v20 offset:14336
ds_read_b64_tr_b16 v[44:45], v20 offset:16384
s_waitcnt lgkmcnt(6)
v_mfma_f32_16x16x32_bf16 v[80:83], v[36:39], v[144:147], v[80:83]
ds_read_b64_tr_b16 v[46:47], v20 offset:18432
v_mfma_f32_16x16x32_bf16 v[84:87], v[28:31], v[116:119], 0
ds_read_b64_tr_b16 v[48:49], v20 offset:20480
ds_read_b64_tr_b16 v[50:51], v20 offset:22528
v_mfma_f32_16x16x32_bf16 v[84:87], v[32:35], v[132:135], v[84:87]
ds_read_b128 v[160:163], v24 offset:3072
s_waitcnt lgkmcnt(9)
v_mfma_f32_16x16x32_bf16 v[84:87], v[36:39], v[148:151], v[84:87]
ds_read_b128 v[164:167], v24 offset:12288
ds_read_b128 v[168:171], v24 offset:21504
v_mfma_f32_16x16x32_bf16 v[88:91], v[28:31], v[120:123], 0
ds_read_b128 v[172:175], v24 offset:30720
v_mfma_f32_16x16x32_bf16 v[88:91], v[32:35], v[136:139], v[88:91]
ds_read_b128 v[176:179], v24 offset:4096
ds_read_b128 v[180:183], v24 offset:13312
s_waitcnt lgkmcnt(13)
v_mfma_f32_16x16x32_bf16 v[88:91], v[36:39], v[152:155], v[88:91]
ds_read_b128 v[184:187], v24 offset:22528
v_mfma_f32_16x16x32_bf16 v[92:95], v[28:31], v[124:127], 0
ds_read_b128 v[188:191], v24 offset:31744
ds_read_b128 v[192:195], v24 offset:5120
v_mfma_f32_16x16x32_bf16 v[92:95], v[32:35], v[140:143], v[92:95]
ds_read_b128 v[196:199], v24 offset:14336
s_waitcnt lgkmcnt(15)
v_mfma_f32_16x16x32_bf16 v[92:95], v[36:39], v[156:159], v[92:95]
ds_read_b128 v[200:203], v24 offset:23552
ds_read_b128 v[204:207], v24 offset:32768
s_waitcnt lgkmcnt(11)
v_mfma_f32_16x16x32_bf16 v[80:83], v[40:43], v[160:163], v[80:83]
ds_read_b64_tr_b16 v[52:53], v20 offset:24576
s_waitcnt lgkmcnt(8)
v_mfma_f32_16x16x32_bf16 v[80:83], v[44:47], v[176:179], v[80:83]
ds_read_b64_tr_b16 v[54:55], v20 offset:26624
ds_read_b64_tr_b16 v[56:57], v20 offset:28672
s_waitcnt lgkmcnt(6)
v_mfma_f32_16x16x32_bf16 v[80:83], v[48:51], v[192:195], v[80:83]
ds_read_b64_tr_b16 v[58:59], v20 offset:30720
v_mfma_f32_16x16x32_bf16 v[84:87], v[40:43], v[164:167], v[84:87]
ds_read_b64_tr_b16 v[60:61], v20 offset:32768
ds_read_b64_tr_b16 v[62:63], v20 offset:34816
v_mfma_f32_16x16x32_bf16 v[84:87], v[44:47], v[180:183], v[84:87]
ds_read_b128 v[208:211], v24 offset:6144
s_waitcnt lgkmcnt(9)
v_mfma_f32_16x16x32_bf16 v[84:87], v[48:51], v[196:199], v[84:87]
ds_read_b128 v[212:215], v24 offset:15360
ds_read_b128 v[216:219], v24 offset:24576
v_mfma_f32_16x16x32_bf16 v[88:91], v[40:43], v[168:171], v[88:91]
ds_read_b128 v[220:223], v24 offset:33792
v_mfma_f32_16x16x32_bf16 v[88:91], v[44:47], v[184:187], v[88:91]
ds_read_b128 v[224:227], v24 offset:7168
ds_read_b128 v[228:231], v24 offset:16384
s_waitcnt lgkmcnt(13)
v_mfma_f32_16x16x32_bf16 v[88:91], v[48:51], v[200:203], v[88:91]
ds_read_b128 v[232:235], v24 offset:25600
v_mfma_f32_16x16x32_bf16 v[92:95], v[40:43], v[172:175], v[92:95]
ds_read_b128 v[236:239], v24 offset:34816
ds_read_b128 v[240:243], v24 offset:8192
v_mfma_f32_16x16x32_bf16 v[92:95], v[44:47], v[188:191], v[92:95]
ds_read_b128 v[244:247], v24 offset:17408
s_waitcnt lgkmcnt(15)
v_mfma_f32_16x16x32_bf16 v[92:95], v[48:51], v[204:207], v[92:95]
ds_read_b128 v[248:251], v24 offset:26624
ds_read_b128 v[252:255], v24 offset:35840
s_waitcnt lgkmcnt(0)
s_waitcnt vmcnt(2)
s_barrier
ds_read_b64_tr_b16 v[28:29], v21 offset:0
ds_read_b64_tr_b16 v[30:31], v21 offset:2048
ds_read_b64_tr_b16 v[32:33], v21 offset:4096
ds_read_b64_tr_b16 v[34:35], v21 offset:6144
ds_read_b64_tr_b16 v[36:37], v21 offset:8192
ds_read_b64_tr_b16 v[38:39], v21 offset:10240
v_mfma_f32_16x16x32_bf16 v[80:83], v[52:55], v[208:211], v[80:83]
s_add_u32 m0, s87, 90112
s_add_u32 s94, s86, 256
v_mfma_f32_16x16x32_bf16 v[80:83], v[56:59], v[224:227], v[80:83]
buffer_load_dwordx4 v17, s[16:19], s94 offen  lds
v_mfma_f32_16x16x32_bf16 v[80:83], v[60:63], v[240:243], v[80:83]
s_add_u32 m0, s87, 91136
s_add_u32 s94, s86, 9472
v_mfma_f32_16x16x32_bf16 v[84:87], v[52:55], v[212:215], v[84:87]
buffer_load_dwordx4 v17, s[16:19], s94 offen  lds
v_mfma_f32_16x16x32_bf16 v[84:87], v[56:59], v[228:231], v[84:87]
s_add_u32 m0, s87, 92160
s_add_u32 s94, s86, 18688
v_mfma_f32_16x16x32_bf16 v[84:87], v[60:63], v[244:247], v[84:87]
buffer_load_dwordx4 v17, s[16:19], s94 offen  lds
v_mfma_f32_16x16x32_bf16 v[88:91], v[52:55], v[216:219], v[88:91]
s_add_u32 m0, s87, 93184
s_add_u32 s94, s86, 27904
v_mfma_f32_16x16x32_bf16 v[88:91], v[56:59], v[232:235], v[88:91]
buffer_load_dwordx4 v17, s[16:19], s94 offen  lds
v_mfma_f32_16x16x32_bf16 v[88:91], v[60:63], v[248:251], v[88:91]
s_add_u32 m0, s87, 126976
s_add_u32 s94, s86, 384
v_mfma_f32_16x16x32_bf16 v[92:95], v[52:55], v[220:223], v[92:95]
buffer_load_dwordx4 v17, s[16:19], s94 offen  lds
v_mfma_f32_16x16x32_bf16 v[92:95], v[56:59], v[236:239], v[92:95]
s_add_u32 m0, s87, 128000
s_add_u32 s94, s86, 9600
v_mfma_f32_16x16x32_bf16 v[92:95], v[60:63], v[252:255], v[92:95]
buffer_load_dwordx4 v17, s[16:19], s94 offen  lds
s_add_u32 m0, s87, 129024
s_add_u32 s94, s86, 18816
buffer_load_dwordx4 v17, s[16:19], s94 offen  lds
s_add_u32 m0, s87, 130048
s_add_u32 s94, s86, 28032
buffer_load_dwordx4 v17, s[16:19], s94 offen  lds
s_waitcnt lgkmcnt(4)
v_mfma_f32_16x16x32_bf16 v[96:99], v[28:31], v[112:115], 0
ds_read_b64_tr_b16 v[40:41], v21 offset:12288
s_waitcnt lgkmcnt(3)
v_mfma_f32_16x16x32_bf16 v[96:99], v[32:35], v[128:131], v[96:99]
ds_read_b64_tr_b16 v[42:43], v21 offset:14336
s_waitcnt lgkmcnt(2)
v_mfma_f32_16x16x32_bf16 v[96:99], v[36:39], v[144:147], v[96:99]
ds_read_b64_tr_b16 v[44:45], v21 offset:16384
ds_read_b64_tr_b16 v[46:47], v21 offset:18432
v_mfma_f32_16x16x32_bf16 v[100:103], v[28:31], v[116:119], 0
ds_read_b64_tr_b16 v[48:49], v21 offset:20480
v_mfma_f32_16x16x32_bf16 v[100:103], v[32:35], v[132:135], v[100:103]
ds_read_b64_tr_b16 v[50:51], v21 offset:22528
v_cvt_pk_bf16_f32 v80, v80, v81
v_mfma_f32_16x16x32_bf16 v[100:103], v[36:39], v[148:151], v[100:103]
v_cvt_pk_bf16_f32 v81, v82, v83
v_mfma_f32_16x16x32_bf16 v[104:107], v[28:31], v[120:123], 0
v_cvt_pk_bf16_f32 v82, v84, v85
v_mfma_f32_16x16x32_bf16 v[104:107], v[32:35], v[136:139], v[104:107]
v_cvt_pk_bf16_f32 v83, v86, v87
s_add_u32 s3, s88, 0
buffer_store_dwordx4 v[80:83], v18, s[24:27], s3 offen offset:0 sc1
v_mfma_f32_16x16x32_bf16 v[104:107], v[36:39], v[152:155], v[104:107]
v_cvt_pk_bf16_f32 v88, v88, v89
v_mfma_f32_16x16x32_bf16 v[108:111], v[28:31], v[124:127], 0
v_cvt_pk_bf16_f32 v89, v90, v91
v_cvt_pk_bf16_f32 v90, v92, v93
v_mfma_f32_16x16x32_bf16 v[108:111], v[32:35], v[140:143], v[108:111]
v_cvt_pk_bf16_f32 v91, v94, v95
v_mfma_f32_16x16x32_bf16 v[108:111], v[36:39], v[156:159], v[108:111]
s_add_u32 s3, s88, 0
buffer_store_dwordx4 v[88:91], v18, s[24:27], s3 offen offset:128 sc1
s_mov_b64 exec, s[48:49]
ds_write_b128 v10, v[80:83] offset:0
ds_write_b128 v10, v[88:91] offset:128
s_mov_b64 exec, -1
s_waitcnt lgkmcnt(6)
v_mfma_f32_16x16x32_bf16 v[96:99], v[40:43], v[160:163], v[96:99]
ds_read_b64_tr_b16 v[52:53], v21 offset:24576
s_waitcnt lgkmcnt(5)
v_mfma_f32_16x16x32_bf16 v[96:99], v[44:47], v[176:179], v[96:99]
ds_read_b64_tr_b16 v[54:55], v21 offset:26624
s_waitcnt lgkmcnt(4)
v_mfma_f32_16x16x32_bf16 v[96:99], v[48:51], v[192:195], v[96:99]
ds_read_b64_tr_b16 v[56:57], v21 offset:28672
v_mfma_f32_16x16x32_bf16 v[100:103], v[40:43], v[164:167], v[100:103]
ds_read_b64_tr_b16 v[58:59], v21 offset:30720
v_mfma_f32_16x16x32_bf16 v[100:103], v[44:47], v[180:183], v[100:103]
ds_read_b64_tr_b16 v[60:61], v21 offset:32768
v_mfma_f32_16x16x32_bf16 v[100:103], v[48:51], v[196:199], v[100:103]
ds_read_b64_tr_b16 v[62:63], v21 offset:34816
v_mfma_f32_16x16x32_bf16 v[104:107], v[40:43], v[168:171], v[104:107]
v_mfma_f32_16x16x32_bf16 v[104:107], v[44:47], v[184:187], v[104:107]
v_mfma_f32_16x16x32_bf16 v[104:107], v[48:51], v[200:203], v[104:107]
v_mfma_f32_16x16x32_bf16 v[108:111], v[40:43], v[172:175], v[108:111]
v_mfma_f32_16x16x32_bf16 v[108:111], v[44:47], v[188:191], v[108:111]
v_mfma_f32_16x16x32_bf16 v[108:111], v[48:51], v[204:207], v[108:111]
s_waitcnt lgkmcnt(0)
s_waitcnt vmcnt(6)
s_barrier
ds_read_b64_tr_b16 v[28:29], v22 offset:0
ds_read_b64_tr_b16 v[30:31], v22 offset:2048
ds_read_b64_tr_b16 v[32:33], v22 offset:4096
ds_read_b64_tr_b16 v[34:35], v22 offset:6144
ds_read_b64_tr_b16 v[36:37], v22 offset:8192
ds_read_b64_tr_b16 v[38:39], v22 offset:10240
v_mfma_f32_16x16x32_bf16 v[96:99], v[52:55], v[208:211], v[96:99]
s_add_u32 m0, s87, 0
s_add_u32 s94, s86, 512
v_mfma_f32_16x16x32_bf16 v[96:99], v[56:59], v[224:227], v[96:99]
buffer_load_dwordx4 v17, s[16:19], s94 offen  lds
v_mfma_f32_16x16x32_bf16 v[96:99], v[60:63], v[240:243], v[96:99]
s_add_u32 m0, s87, 1024
s_add_u32 s94, s86, 9728
v_mfma_f32_16x16x32_bf16 v[100:103], v[52:55], v[212:215], v[100:103]
buffer_load_dwordx4 v17, s[16:19], s94 offen  lds
v_mfma_f32_16x16x32_bf16 v[100:103], v[56:59], v[228:231], v[100:103]
s_add_u32 m0, s87, 2048
s_add_u32 s94, s86, 18944
v_mfma_f32_16x16x32_bf16 v[100:103], v[60:63], v[244:247], v[100:103]
buffer_load_dwordx4 v17, s[16:19], s94 offen  lds
v_mfma_f32_16x16x32_bf16 v[104:107], v[52:55], v[216:219], v[104:107]
s_add_u32 m0, s87, 3072
s_add_u32 s94, s86, 28160
v_mfma_f32_16x16x32_bf16 v[104:107], v[56:59], v[232:235], v[104:107]
buffer_load_dwordx4 v17, s[16:19], s94 offen  lds
v_mfma_f32_16x16x32_bf16 v[104:107], v[60:63], v[248:251], v[104:107]
v_mfma_f32_16x16x32_bf16 v[108:111], v[52:55], v[220:223], v[108:111]
v_mfma_f32_16x16x32_bf16 v[108:111], v[56:59], v[236:239], v[108:111]
v_mfma_f32_16x16x32_bf16 v[108:111], v[60:63], v[252:255], v[108:111]
s_waitcnt lgkmcnt(4)
v_mfma_f32_16x16x32_bf16 v[80:83], v[28:31], v[112:115], 0
ds_read_b64_tr_b16 v[40:41], v22 offset:12288
s_waitcnt lgkmcnt(3)
v_mfma_f32_16x16x32_bf16 v[80:83], v[32:35], v[128:131], v[80:83]
ds_read_b64_tr_b16 v[42:43], v22 offset:14336
s_waitcnt lgkmcnt(2)
v_mfma_f32_16x16x32_bf16 v[80:83], v[36:39], v[144:147], v[80:83]
ds_read_b64_tr_b16 v[44:45], v22 offset:16384
ds_read_b64_tr_b16 v[46:47], v22 offset:18432
v_mfma_f32_16x16x32_bf16 v[84:87], v[28:31], v[116:119], 0
ds_read_b64_tr_b16 v[48:49], v22 offset:20480
v_mfma_f32_16x16x32_bf16 v[84:87], v[32:35], v[132:135], v[84:87]
ds_read_b64_tr_b16 v[50:51], v22 offset:22528
v_cvt_pk_bf16_f32 v96, v96, v97
v_mfma_f32_16x16x32_bf16 v[84:87], v[36:39], v[148:151], v[84:87]
v_cvt_pk_bf16_f32 v97, v98, v99
v_mfma_f32_16x16x32_bf16 v[88:91], v[28:31], v[120:123], 0
v_cvt_pk_bf16_f32 v98, v100, v101
v_mfma_f32_16x16x32_bf16 v[88:91], v[32:35], v[136:139], v[88:91]
v_cvt_pk_bf16_f32 v99, v102, v103
s_add_u32 s3, s88, 16384
buffer_store_dwordx4 v[96:99], v18, s[24:27], s3 offen offset:0 sc1
v_mfma_f32_16x16x32_bf16 v[88:91], v[36:39], v[152:155], v[88:91]
v_cvt_pk_bf16_f32 v104, v104, v105
v_mfma_f32_16x16x32_bf16 v[92:95], v[28:31], v[124:127], 0
v_cvt_pk_bf16_f32 v105, v106, v107
v_cvt_pk_bf16_f32 v106, v108, v109
v_mfma_f32_16x16x32_bf16 v[92:95], v[32:35], v[140:143], v[92:95]
v_cvt_pk_bf16_f32 v107, v110, v111
v_mfma_f32_16x16x32_bf16 v[92:95], v[36:39], v[156:159], v[92:95]
s_add_u32 s3, s88, 16384
buffer_store_dwordx4 v[104:107], v18, s[24:27], s3 offen offset:128 sc1
s_mov_b64 exec, s[48:49]
ds_write_b128 v10, v[96:99] offset:1024
ds_write_b128 v10, v[104:107] offset:1152
s_mov_b64 exec, -1
s_waitcnt lgkmcnt(6)
v_mfma_f32_16x16x32_bf16 v[80:83], v[40:43], v[160:163], v[80:83]
ds_read_b64_tr_b16 v[52:53], v22 offset:24576
s_waitcnt lgkmcnt(5)
v_mfma_f32_16x16x32_bf16 v[80:83], v[44:47], v[176:179], v[80:83]
ds_read_b64_tr_b16 v[54:55], v22 offset:26624
s_waitcnt lgkmcnt(4)
v_mfma_f32_16x16x32_bf16 v[80:83], v[48:51], v[192:195], v[80:83]
ds_read_b64_tr_b16 v[56:57], v22 offset:28672
v_mfma_f32_16x16x32_bf16 v[84:87], v[40:43], v[164:167], v[84:87]
ds_read_b64_tr_b16 v[58:59], v22 offset:30720
v_mfma_f32_16x16x32_bf16 v[84:87], v[44:47], v[180:183], v[84:87]
ds_read_b64_tr_b16 v[60:61], v22 offset:32768
v_mfma_f32_16x16x32_bf16 v[84:87], v[48:51], v[196:199], v[84:87]
ds_read_b64_tr_b16 v[62:63], v22 offset:34816
v_mfma_f32_16x16x32_bf16 v[88:91], v[40:43], v[168:171], v[88:91]
v_mfma_f32_16x16x32_bf16 v[88:91], v[44:47], v[184:187], v[88:91]
v_mfma_f32_16x16x32_bf16 v[88:91], v[48:51], v[200:203], v[88:91]
v_mfma_f32_16x16x32_bf16 v[92:95], v[40:43], v[172:175], v[92:95]
v_mfma_f32_16x16x32_bf16 v[92:95], v[44:47], v[188:191], v[92:95]
v_mfma_f32_16x16x32_bf16 v[92:95], v[48:51], v[204:207], v[92:95]
s_waitcnt lgkmcnt(0)
s_waitcnt vmcnt(8)
s_barrier
ds_read_b64_tr_b16 v[28:29], v23 offset:0
ds_read_b64_tr_b16 v[30:31], v23 offset:2048
ds_read_b64_tr_b16 v[32:33], v23 offset:4096
ds_read_b64_tr_b16 v[34:35], v23 offset:6144
ds_read_b64_tr_b16 v[36:37], v23 offset:8192
ds_read_b64_tr_b16 v[38:39], v23 offset:10240
v_mfma_f32_16x16x32_bf16 v[80:83], v[52:55], v[208:211], v[80:83]
s_add_u32 m0, s87, 36864
s_add_u32 s94, s86, 640
v_mfma_f32_16x16x32_bf16 v[80:83], v[56:59], v[224:227], v[80:83]
buffer_load_dwordx4 v17, s[16:19], s94 offen  lds
v_mfma_f32_16x16x32_bf16 v[80:83], v[60:63], v[240:243], v[80:83]
s_add_u32 m0, s87, 37888
s_add_u32 s94, s86, 9856
v_mfma_f32_16x16x32_bf16 v[84:87], v[52:55], v[212:215], v[84:87]
buffer_load_dwordx4 v17, s[16:19], s94 offen  lds
v_mfma_f32_16x16x32_bf16 v[84:87], v[56:59], v[228:231], v[84:87]
s_add_u32 m0, s87, 38912
s_add_u32 s94, s86, 19072
v_mfma_f32_16x16x32_bf16 v[84:87], v[60:63], v[244:247], v[84:87]
buffer_load_dwordx4 v17, s[16:19], s94 offen  lds
v_mfma_f32_16x16x32_bf16 v[88:91], v[52:55], v[216:219], v[88:91]
s_add_u32 m0, s87, 39936
s_add_u32 s94, s86, 28288
v_mfma_f32_16x16x32_bf16 v[88:91], v[56:59], v[232:235], v[88:91]
buffer_load_dwordx4 v17, s[16:19], s94 offen  lds
v_mfma_f32_16x16x32_bf16 v[88:91], v[60:63], v[248:251], v[88:91]
v_mfma_f32_16x16x32_bf16 v[92:95], v[52:55], v[220:223], v[92:95]
v_mfma_f32_16x16x32_bf16 v[92:95], v[56:59], v[236:239], v[92:95]
v_mfma_f32_16x16x32_bf16 v[92:95], v[60:63], v[252:255], v[92:95]
s_waitcnt lgkmcnt(4)
v_mfma_f32_16x16x32_bf16 v[96:99], v[28:31], v[112:115], 0
ds_read_b64_tr_b16 v[40:41], v23 offset:12288
s_waitcnt lgkmcnt(3)
v_mfma_f32_16x16x32_bf16 v[96:99], v[32:35], v[128:131], v[96:99]
ds_read_b64_tr_b16 v[42:43], v23 offset:14336
s_waitcnt lgkmcnt(2)
v_mfma_f32_16x16x32_bf16 v[96:99], v[36:39], v[144:147], v[96:99]
ds_read_b64_tr_b16 v[44:45], v23 offset:16384
ds_read_b64_tr_b16 v[46:47], v23 offset:18432
v_mfma_f32_16x16x32_bf16 v[100:103], v[28:31], v[116:119], 0
ds_read_b64_tr_b16 v[48:49], v23 offset:20480
v_mfma_f32_16x16x32_bf16 v[100:103], v[32:35], v[132:135], v[100:103]
ds_read_b64_tr_b16 v[50:51], v23 offset:22528
v_cvt_pk_bf16_f32 v80, v80, v81
v_mfma_f32_16x16x32_bf16 v[100:103], v[36:39], v[148:151], v[100:103]
v_cvt_pk_bf16_f32 v81, v82, v83
v_mfma_f32_16x16x32_bf16 v[104:107], v[28:31], v[120:123], 0
v_cvt_pk_bf16_f32 v82, v84, v85
v_mfma_f32_16x16x32_bf16 v[104:107], v[32:35], v[136:139], v[104:107]
v_cvt_pk_bf16_f32 v83, v86, v87
s_add_u32 s3, s88, 32768
buffer_store_dwordx4 v[80:83], v18, s[24:27], s3 offen offset:0 sc1
v_mfma_f32_16x16x32_bf16 v[104:107], v[36:39], v[152:155], v[104:107]
v_cvt_pk_bf16_f32 v88, v88, v89
v_mfma_f32_16x16x32_bf16 v[108:111], v[28:31], v[124:127], 0
v_cvt_pk_bf16_f32 v89, v90, v91
v_cvt_pk_bf16_f32 v90, v92, v93
v_mfma_f32_16x16x32_bf16 v[108:111], v[32:35], v[140:143], v[108:111]
v_cvt_pk_bf16_f32 v91, v94, v95
v_mfma_f32_16x16x32_bf16 v[108:111], v[36:39], v[156:159], v[108:111]
s_add_u32 s3, s88, 32768
buffer_store_dwordx4 v[88:91], v18, s[24:27], s3 offen offset:128 sc1
s_mov_b64 exec, s[48:49]
ds_write_b128 v10, v[80:83] offset:2048
ds_write_b128 v10, v[88:91] offset:2176
s_mov_b64 exec, -1
s_waitcnt lgkmcnt(6)
v_mfma_f32_16x16x32_bf16 v[96:99], v[40:43], v[160:163], v[96:99]
ds_read_b64_tr_b16 v[52:53], v23 offset:24576
s_waitcnt lgkmcnt(5)
v_mfma_f32_16x16x32_bf16 v[96:99], v[44:47], v[176:179], v[96:99]
ds_read_b64_tr_b16 v[54:55], v23 offset:26624
s_waitcnt lgkmcnt(4)
v_mfma_f32_16x16x32_bf16 v[96:99], v[48:51], v[192:195], v[96:99]
ds_read_b64_tr_b16 v[56:57], v23 offset:28672
v_mfma_f32_16x16x32_bf16 v[100:103], v[40:43], v[164:167], v[100:103]
ds_read_b64_tr_b16 v[58:59], v23 offset:30720
v_mfma_f32_16x16x32_bf16 v[100:103], v[44:47], v[180:183], v[100:103]
ds_read_b64_tr_b16 v[60:61], v23 offset:32768
v_mfma_f32_16x16x32_bf16 v[100:103], v[48:51], v[196:199], v[100:103]
ds_read_b64_tr_b16 v[62:63], v23 offset:34816
v_mfma_f32_16x16x32_bf16 v[104:107], v[40:43], v[168:171], v[104:107]
v_mfma_f32_16x16x32_bf16 v[104:107], v[44:47], v[184:187], v[104:107]
v_mfma_f32_16x16x32_bf16 v[104:107], v[48:51], v[200:203], v[104:107]
v_mfma_f32_16x16x32_bf16 v[108:111], v[40:43], v[172:175], v[108:111]
v_mfma_f32_16x16x32_bf16 v[108:111], v[44:47], v[188:191], v[108:111]
v_mfma_f32_16x16x32_bf16 v[108:111], v[48:51], v[204:207], v[108:111]
s_waitcnt lgkmcnt(0)
s_waitcnt vmcnt(6)
s_barrier
ds_read_b64_tr_b16 v[28:29], v20 offset:0
ds_read_b64_tr_b16 v[30:31], v20 offset:2048
ds_read_b64_tr_b16 v[32:33], v20 offset:4096
ds_read_b64_tr_b16 v[34:35], v20 offset:6144
ds_read_b64_tr_b16 v[36:37], v20 offset:8192
ds_read_b64_tr_b16 v[38:39], v20 offset:10240
s_cmp_lg_u32 s56, 0
s_cbranch_scc1 pf_sig0
s_mov_b32 s3, 0
buffer_store_dword v5, v9, s[28:31], s3 offen sc1
pf_sig0:
v_mfma_f32_16x16x32_bf16 v[96:99], v[52:55], v[208:211], v[96:99]
s_add_u32 m0, s87, 90112
s_add_u32 s94, s86, 768
v_mfma_f32_16x16x32_bf16 v[96:99], v[56:59], v[224:227], v[96:99]
buffer_load_dwordx4 v17, s[16:19], s94 offen  lds
v_mfma_f32_16x16x32_bf16 v[96:99], v[60:63], v[240:243], v[96:99]
s_add_u32 m0, s87, 91136
s_add_u32 s94, s86, 9984
v_mfma_f32_16x16x32_bf16 v[100:103], v[52:55], v[212:215], v[100:103]
buffer_load_dwordx4 v17, s[16:19], s94 offen  lds
v_mfma_f32_16x16x32_bf16 v[100:103], v[56:59], v[228:231], v[100:103]
s_add_u32 m0, s87, 92160
s_add_u32 s94, s86, 19200
v_mfma_f32_16x16x32_bf16 v[100:103], v[60:63], v[244:247], v[100:103]
buffer_load_dwordx4 v17, s[16:19], s94 offen  lds
v_mfma_f32_16x16x32_bf16 v[104:107], v[52:55], v[216:219], v[104:107]
s_add_u32 m0, s87, 93184
s_add_u32 s94, s86, 28416
v_mfma_f32_16x16x32_bf16 v[104:107], v[56:59], v[232:235], v[104:107]
buffer_load_dwordx4 v17, s[16:19], s94 offen  lds
v_mfma_f32_16x16x32_bf16 v[104:107], v[60:63], v[248:251], v[104:107]
v_mfma_f32_16x16x32_bf16 v[108:111], v[52:55], v[220:223], v[108:111]
v_mfma_f32_16x16x32_bf16 v[108:111], v[56:59], v[236:239], v[108:111]
v_mfma_f32_16x16x32_bf16 v[108:111], v[60:63], v[252:255], v[108:111]
s_waitcnt lgkmcnt(4)
v_mfma_f32_16x16x32_bf16 v[80:83], v[28:31], v[112:115], 0
ds_read_b64_tr_b16 v[40:41], v20 offset:12288
s_waitcnt lgkmcnt(3)
v_mfma_f32_16x16x32_bf16 v[80:83], v[32:35], v[128:131], v[80:83]
ds_read_b64_tr_b16 v[42:43], v20 offset:14336
s_waitcnt lgkmcnt(2)
v_mfma_f32_16x16x32_bf16 v[80:83], v[36:39], v[144:147], v[80:83]
ds_read_b64_tr_b16 v[44:45], v20 offset:16384
ds_read_b64_tr_b16 v[46:47], v20 offset:18432
v_mfma_f32_16x16x32_bf16 v[84:87], v[28:31], v[116:119], 0
ds_read_b64_tr_b16 v[48:49], v20 offset:20480
v_mfma_f32_16x16x32_bf16 v[84:87], v[32:35], v[132:135], v[84:87]
ds_read_b64_tr_b16 v[50:51], v20 offset:22528
v_cvt_pk_bf16_f32 v96, v96, v97
v_mfma_f32_16x16x32_bf16 v[84:87], v[36:39], v[148:151], v[84:87]
v_cvt_pk_bf16_f32 v97, v98, v99
v_mfma_f32_16x16x32_bf16 v[88:91], v[28:31], v[120:123], 0
v_cvt_pk_bf16_f32 v98, v100, v101
v_mfma_f32_16x16x32_bf16 v[88:91], v[32:35], v[136:139], v[88:91]
v_cvt_pk_bf16_f32 v99, v102, v103
s_add_u32 s3, s88, 49152
buffer_store_dwordx4 v[96:99], v18, s[24:27], s3 offen offset:0 sc1
v_mfma_f32_16x16x32_bf16 v[88:91], v[36:39], v[152:155], v[88:91]
v_cvt_pk_bf16_f32 v104, v104, v105
v_mfma_f32_16x16x32_bf16 v[92:95], v[28:31], v[124:127], 0
v_cvt_pk_bf16_f32 v105, v106, v107
v_cvt_pk_bf16_f32 v106, v108, v109
v_mfma_f32_16x16x32_bf16 v[92:95], v[32:35], v[140:143], v[92:95]
v_cvt_pk_bf16_f32 v107, v110, v111
v_mfma_f32_16x16x32_bf16 v[92:95], v[36:39], v[156:159], v[92:95]
s_add_u32 s3, s88, 49152
buffer_store_dwordx4 v[104:107], v18, s[24:27], s3 offen offset:128 sc1
s_mov_b64 exec, s[48:49]
ds_write_b128 v10, v[96:99] offset:3072
ds_write_b128 v10, v[104:107] offset:3200
s_mov_b64 exec, -1
s_waitcnt lgkmcnt(6)
v_mfma_f32_16x16x32_bf16 v[80:83], v[40:43], v[160:163], v[80:83]
ds_read_b64_tr_b16 v[52:53], v20 offset:24576
s_waitcnt lgkmcnt(5)
v_mfma_f32_16x16x32_bf16 v[80:83], v[44:47], v[176:179], v[80:83]
ds_read_b64_tr_b16 v[54:55], v20 offset:26624
s_waitcnt lgkmcnt(4)
v_mfma_f32_16x16x32_bf16 v[80:83], v[48:51], v[192:195], v[80:83]
ds_read_b64_tr_b16 v[56:57], v20 offset:28672
v_mfma_f32_16x16x32_bf16 v[84:87], v[40:43], v[164:167], v[84:87]
ds_read_b64_tr_b16 v[58:59], v20 offset:30720
v_mfma_f32_16x16x32_bf16 v[84:87], v[44:47], v[180:183], v[84:87]
ds_read_b64_tr_b16 v[60:61], v20 offset:32768
v_mfma_f32_16x16x32_bf16 v[84:87], v[48:51], v[196:199], v[84:87]
ds_read_b64_tr_b16 v[62:63], v20 offset:34816
v_mfma_f32_16x16x32_bf16 v[88:91], v[40:43], v[168:171], v[88:91]
v_mfma_f32_16x16x32_bf16 v[88:91], v[44:47], v[184:187], v[88:91]
v_mfma_f32_16x16x32_bf16 v[88:91], v[48:51], v[200:203], v[88:91]
v_mfma_f32_16x16x32_bf16 v[92:95], v[40:43], v[172:175], v[92:95]
v_mfma_f32_16x16x32_bf16 v[92:95], v[44:47], v[188:191], v[92:95]
v_mfma_f32_16x16x32_bf16 v[92:95], v[48:51], v[204:207], v[92:95]
s_waitcnt lgkmcnt(0)
s_waitcnt vmcnt(8)
s_barrier
s_mov_b32 s3, 0
buffer_load_dword v19, v8, s[28:31], s3 offen sc1
ds_read_b64_tr_b16 v[28:29], v21 offset:0
ds_read_b64_tr_b16 v[30:31], v21 offset:2048
ds_read_b64_tr_b16 v[32:33], v21 offset:4096
ds_read_b64_tr_b16 v[34:35], v21 offset:6144
ds_read_b64_tr_b16 v[36:37], v21 offset:8192
ds_read_b64_tr_b16 v[38:39], v21 offset:10240
v_mfma_f32_16x16x32_bf16 v[80:83], v[52:55], v[208:211], v[80:83]
s_add_u32 m0, s87, 126976
s_add_u32 s94, s86, 896
v_mfma_f32_16x16x32_bf16 v[80:83], v[56:59], v[224:227], v[80:83]
buffer_load_dwordx4 v17, s[16:19], s94 offen  lds
v_mfma_f32_16x16x32_bf16 v[80:83], v[60:63], v[240:243], v[80:83]
s_add_u32 m0, s87, 128000
s_add_u32 s94, s86, 10112
v_mfma_f32_16x16x32_bf16 v[84:87], v[52:55], v[212:215], v[84:87]
buffer_load_dwordx4 v17, s[16:19], s94 offen  lds
v_mfma_f32_16x16x32_bf16 v[84:87], v[56:59], v[228:231], v[84:87]
s_add_u32 m0, s87, 129024
s_add_u32 s94, s86, 19328
v_mfma_f32_16x16x32_bf16 v[84:87], v[60:63], v[244:247], v[84:87]
buffer_load_dwordx4 v17, s[16:19], s94 offen  lds
v_mfma_f32_16x16x32_bf16 v[88:91], v[52:55], v[216:219], v[88:91]
s_add_u32 m0, s87, 130048
s_add_u32 s94, s86, 28544
v_mfma_f32_16x16x32_bf16 v[88:91], v[56:59], v[232:235], v[88:91]
buffer_load_dwordx4 v17, s[16:19], s94 offen  lds
v_mfma_f32_16x16x32_bf16 v[88:91], v[60:63], v[248:251], v[88:91]
v_mfma_f32_16x16x32_bf16 v[92:95], v[52:55], v[220:223], v[92:95]
v_mfma_f32_16x16x32_bf16 v[92:95], v[56:59], v[236:239], v[92:95]
v_mfma_f32_16x16x32_bf16 v[92:95], v[60:63], v[252:255], v[92:95]
s_waitcnt lgkmcnt(4)
v_mfma_f32_16x16x32_bf16 v[96:99], v[28:31], v[112:115], 0
ds_read_b64_tr_b16 v[40:41], v21 offset:12288
s_waitcnt lgkmcnt(3)
v_mfma_f32_16x16x32_bf16 v[96:99], v[32:35], v[128:131], v[96:99]
ds_read_b64_tr_b16 v[42:43], v21 offset:14336
s_waitcnt lgkmcnt(2)
v_mfma_f32_16x16x32_bf16 v[96:99], v[36:39], v[144:147], v[96:99]
ds_read_b64_tr_b16 v[44:45], v21 offset:16384
ds_read_b64_tr_b16 v[46:47], v21 offset:18432
v_mfma_f32_16x16x32_bf16 v[100:103], v[28:31], v[116:119], 0
ds_read_b64_tr_b16 v[48:49], v21 offset:20480
v_mfma_f32_16x16x32_bf16 v[100:103], v[32:35], v[132:135], v[100:103]
ds_read_b64_tr_b16 v[50:51], v21 offset:22528
v_cvt_pk_bf16_f32 v80, v80, v81
v_mfma_f32_16x16x32_bf16 v[100:103], v[36:39], v[148:151], v[100:103]
v_cvt_pk_bf16_f32 v81, v82, v83
v_mfma_f32_16x16x32_bf16 v[104:107], v[28:31], v[120:123], 0
v_cvt_pk_bf16_f32 v82, v84, v85
v_mfma_f32_16x16x32_bf16 v[104:107], v[32:35], v[136:139], v[104:107]
v_cvt_pk_bf16_f32 v83, v86, v87
s_add_u32 s3, s88, 65536
buffer_store_dwordx4 v[80:83], v18, s[24:27], s3 offen offset:0 sc1
v_mfma_f32_16x16x32_bf16 v[104:107], v[36:39], v[152:155], v[104:107]
v_cvt_pk_bf16_f32 v88, v88, v89
v_mfma_f32_16x16x32_bf16 v[108:111], v[28:31], v[124:127], 0
v_cvt_pk_bf16_f32 v89, v90, v91
v_cvt_pk_bf16_f32 v90, v92, v93
v_mfma_f32_16x16x32_bf16 v[108:111], v[32:35], v[140:143], v[108:111]
v_cvt_pk_bf16_f32 v91, v94, v95
v_mfma_f32_16x16x32_bf16 v[108:111], v[36:39], v[156:159], v[108:111]
s_add_u32 s3, s88, 65536
buffer_store_dwordx4 v[88:91], v18, s[24:27], s3 offen offset:128 sc1
s_mov_b64 exec, s[48:49]
ds_write_b128 v10, v[80:83] offset:4096
ds_write_b128 v10, v[88:91] offset:4224
s_mov_b64 exec, -1
s_mov_b32 s3, 0
s_waitcnt vmcnt(6)
v_cmp_eq_u32 vcc, 0, v19
s_cbranch_vccnz pf_ac0_slow
pf_ac0_ok:
s_waitcnt lgkmcnt(6)
v_mfma_f32_16x16x32_bf16 v[96:99], v[40:43], v[160:163], v[96:99]
ds_read_b64_tr_b16 v[52:53], v21 offset:24576
s_waitcnt lgkmcnt(5)
v_mfma_f32_16x16x32_bf16 v[96:99], v[44:47], v[176:179], v[96:99]
ds_read_b64_tr_b16 v[54:55], v21 offset:26624
s_waitcnt lgkmcnt(4)
v_mfma_f32_16x16x32_bf16 v[96:99], v[48:51], v[192:195], v[96:99]
ds_read_b64_tr_b16 v[56:57], v21 offset:28672
v_mfma_f32_16x16x32_bf16 v[100:103], v[40:43], v[164:167], v[100:103]
ds_read_b64_tr_b16 v[58:59], v21 offset:30720
v_mfma_f32_16x16x32_bf16 v[100:103], v[44:47], v[180:183], v[100:103]
ds_read_b64_tr_b16 v[60:61], v21 offset:32768
v_mfma_f32_16x16x32_bf16 v[100:103], v[48:51], v[196:199], v[100:103]
ds_read_b64_tr_b16 v[62:63], v21 offset:34816
v_mfma_f32_16x16x32_bf16 v[104:107], v[40:43], v[168:171], v[104:107]
v_mfma_f32_16x16x32_bf16 v[104:107], v[44:47], v[184:187], v[104:107]
v_mfma_f32_16x16x32_bf16 v[104:107], v[48:51], v[200:203], v[104:107]
v_mfma_f32_16x16x32_bf16 v[108:111], v[40:43], v[172:175], v[108:111]
v_mfma_f32_16x16x32_bf16 v[108:111], v[44:47], v[188:191], v[108:111]
s_add_u32 s3, s44, 0
s_mov_b64 exec, 0xffff
ds_read_b128 v[64:67], v11 offset:0
s_mov_b32 exec_hi, -1
s_mov_b32 exec_lo, 0xffff0000
s_waitcnt lgkmcnt(0)
buffer_load_dwordx4 v[64:67], v2, s[24:27], s3 offen sc1
s_mov_b64 exec, -1
v_mfma_f32_16x16x32_bf16 v[108:111], v[48:51], v[204:207], v[108:111]
s_add_u32 s3, s45, 0
buffer_load_dwordx4 v[68:71], v2, s[24:27], s3 offen sc1
s_barrier
ds_read_b64_tr_b16 v[28:29], v22 offset:0
ds_read_b64_tr_b16 v[30:31], v22 offset:2048
ds_read_b64_tr_b16 v[32:33], v22 offset:4096
ds_read_b64_tr_b16 v[34:35], v22 offset:6144
ds_read_b64_tr_b16 v[36:37], v22 offset:8192
ds_read_b64_tr_b16 v[38:39], v22 offset:10240
v_mfma_f32_16x16x32_bf16 v[96:99], v[52:55], v[208:211], v[96:99]
s_add_u32 m0, s87, 0
s_add_u32 s94, s86, 1024
v_mfma_f32_16x16x32_bf16 v[96:99], v[56:59], v[224:227], v[96:99]
buffer_load_dwordx4 v17, s[16:19], s94 offen  lds
v_mfma_f32_16x16x32_bf16 v[96:99], v[60:63], v[240:243], v[96:99]
s_add_u32 m0, s87, 1024
s_add_u32 s94, s86, 10240
v_mfma_f32_16x16x32_bf16 v[100:103], v[52:55], v[212:215], v[100:103]
buffer_load_dwordx4 v17, s[16:19], s94 offen  lds
v_mfma_f32_16x16x32_bf16 v[100:103], v[56:59], v[228:231], v[100:103]
s_add_u32 m0, s87, 2048
s_add_u32 s94, s86, 19456
v_mfma_f32_16x16x32_bf16 v[100:103], v[60:63], v[244:247], v[100:103]
buffer_load_dwordx4 v17, s[16:19], s94 offen  lds
v_mfma_f32_16x16x32_bf16 v[104:107], v[52:55], v[216:219], v[104:107]
s_add_u32 m0, s87, 3072
s_add_u32 s94, s86, 28672
v_mfma_f32_16x16x32_bf16 v[104:107], v[56:59], v[232:235], v[104:107]
buffer_load_dwordx4 v17, s[16:19], s94 offen  lds
v_mfma_f32_16x16x32_bf16 v[104:107], v[60:63], v[248:251], v[104:107]
v_mfma_f32_16x16x32_bf16 v[108:111], v[52:55], v[220:223], v[108:111]
v_mfma_f32_16x16x32_bf16 v[108:111], v[56:59], v[236:239], v[108:111]
v_mfma_f32_16x16x32_bf16 v[108:111], v[60:63], v[252:255], v[108:111]
s_waitcnt lgkmcnt(4)
v_mfma_f32_16x16x32_bf16 v[80:83], v[28:31], v[112:115], 0
ds_read_b64_tr_b16 v[40:41], v22 offset:12288
s_waitcnt lgkmcnt(3)
v_mfma_f32_16x16x32_bf16 v[80:83], v[32:35], v[128:131], v[80:83]
ds_read_b64_tr_b16 v[42:43], v22 offset:14336
s_waitcnt lgkmcnt(2)
v_mfma_f32_16x16x32_bf16 v[80:83], v[36:39], v[144:147], v[80:83]
ds_read_b64_tr_b16 v[44:45], v22 offset:16384
ds_read_b64_tr_b16 v[46:47], v22 offset:18432
v_mfma_f32_16x16x32_bf16 v[84:87], v[28:31], v[116:119], 0
ds_read_b64_tr_b16 v[48:49], v22 offset:20480
v_mfma_f32_16x16x32_bf16 v[84:87], v[32:35], v[132:135], v[84:87]
ds_read_b64_tr_b16 v[50:51], v22 offset:22528
v_cvt_pk_bf16_f32 v96, v96, v97
v_mfma_f32_16x16x32_bf16 v[84:87], v[36:39], v[148:151], v[84:87]
v_cvt_pk_bf16_f32 v97, v98, v99
v_mfma_f32_16x16x32_bf16 v[88:91], v[28:31], v[120:123], 0
v_cvt_pk_bf16_f32 v98, v100, v101
v_mfma_f32_16x16x32_bf16 v[88:91], v[32:35], v[136:139], v[88:91]
v_cvt_pk_bf16_f32 v99, v102, v103
s_add_u32 s3, s88, 81920
buffer_store_dwordx4 v[96:99], v18, s[24:27], s3 offen offset:0 sc1
v_mfma_f32_16x16x32_bf16 v[88:91], v[36:39], v[152:155], v[88:91]
v_cvt_pk_bf16_f32 v104, v104, v105
v_mfma_f32_16x16x32_bf16 v[92:95], v[28:31], v[124:127], 0
v_cvt_pk_bf16_f32 v105, v106, v107
v_cvt_pk_bf16_f32 v106, v108, v109
v_mfma_f32_16x16x32_bf16 v[92:95], v[32:35], v[140:143], v[92:95]
v_cvt_pk_bf16_f32 v107, v110, v111
v_mfma_f32_16x16x32_bf16 v[92:95], v[36:39], v[156:159], v[92:95]
s_add_u32 s3, s88, 81920
buffer_store_dwordx4 v[104:107], v18, s[24:27], s3 offen offset:128 sc1
s_mov_b64 exec, s[48:49]
ds_write_b128 v10, v[96:99] offset:5120
ds_write_b128 v10, v[104:107] offset:5248
s_mov_b64 exec, -1
s_waitcnt lgkmcnt(6)
v_mfma_f32_16x16x32_bf16 v[80:83], v[40:43], v[160:163], v[80:83]
ds_read_b64_tr_b16 v[52:53], v22 offset:24576
s_waitcnt lgkmcnt(5)
v_mfma_f32_16x16x32_bf16 v[80:83], v[44:47], v[176:179], v[80:83]
ds_read_b64_tr_b16 v[54:55], v22 offset:26624
s_waitcnt lgkmcnt(4)
v_mfma_f32_16x16x32_bf16 v[80:83], v[48:51], v[192:195], v[80:83]
ds_read_b64_tr_b16 v[56:57], v22 offset:28672
v_mfma_f32_16x16x32_bf16 v[84:87], v[40:43], v[164:167], v[84:87]
ds_read_b64_tr_b16 v[58:59], v22 offset:30720
v_mfma_f32_16x16x32_bf16 v[84:87], v[44:47], v[180:183], v[84:87]
ds_read_b64_tr_b16 v[60:61], v22 offset:32768
v_mfma_f32_16x16x32_bf16 v[84:87], v[48:51], v[196:199], v[84:87]
ds_read_b64_tr_b16 v[62:63], v22 offset:34816
v_mfma_f32_16x16x32_bf16 v[88:91], v[40:43], v[168:171], v[88:91]
v_mfma_f32_16x16x32_bf16 v[88:91], v[44:47], v[184:187], v[88:91]
v_mfma_f32_16x16x32_bf16 v[88:91], v[48:51], v[200:203], v[88:91]
v_mfma_f32_16x16x32_bf16 v[92:95], v[40:43], v[172:175], v[92:95]
v_mfma_f32_16x16x32_bf16 v[92:95], v[44:47], v[188:191], v[92:95]
v_mfma_f32_16x16x32_bf16 v[92:95], v[48:51], v[204:207], v[92:95]
s_add_u32 s3, s46, 0
buffer_load_dwordx4 v[72:75], v2, s[24:27], s3 offen sc1
s_waitcnt lgkmcnt(0)
s_waitcnt vmcnt(9)
s_barrier
ds_read_b64_tr_b16 v[28:29], v23 offset:0
ds_read_b64_tr_b16 v[30:31], v23 offset:2048
ds_read_b64_tr_b16 v[32:33], v23 offset:4096
ds_read_b64_tr_b16 v[34:35], v23 offset:6144
ds_read_b64_tr_b16 v[36:37], v23 offset:8192
ds_read_b64_tr_b16 v[38:39], v23 offset:10240
s_cmp_lg_u32 s56, 0
s_cbranch_scc1 pf_sig1
s_mov_b32 s3, 32768
buffer_store_dword v5, v9, s[28:31], s3 offen sc1
pf_sig1:
v_mfma_f32_16x16x32_bf16 v[80:83], v[52:55], v[208:211], v[80:83]
v_mfma_f32_16x16x32_bf16 v[80:83], v[56:59], v[224:227], v[80:83]
v_mfma_f32_16x16x32_bf16 v[80:83], v[60:63], v[240:243], v[80:83]
v_mfma_f32_16x16x32_bf16 v[84:87], v[52:55], v[212:215], v[84:87]
v_mfma_f32_16x16x32_bf16 v[84:87], v[56:59], v[228:231], v[84:87]
v_mfma_f32_16x16x32_bf16 v[84:87], v[60:63], v[244:247], v[84:87]
v_mfma_f32_16x16x32_bf16 v[88:91], v[52:55], v[216:219], v[88:91]
v_mfma_f32_16x16x32_bf16 v[88:91], v[56:59], v[232:235], v[88:91]
v_mfma_f32_16x16x32_bf16 v[88:91], v[60:63], v[248:251], v[88:91]
v_mfma_f32_16x16x32_bf16 v[92:95], v[52:55], v[220:223], v[92:95]
v_mfma_f32_16x16x32_bf16 v[92:95], v[56:59], v[236:239], v[92:95]
v_mfma_f32_16x16x32_bf16 v[92:95], v[60:63], v[252:255], v[92:95]
s_waitcnt lgkmcnt(4)
v_mfma_f32_16x16x32_bf16 v[96:99], v[28:31], v[112:115], 0
ds_read_b64_tr_b16 v[40:41], v23 offset:12288
s_waitcnt lgkmcnt(3)
v_mfma_f32_16x16x32_bf16 v[96:99], v[32:35], v[128:131], v[96:99]
ds_read_b64_tr_b16 v[42:43], v23 offset:14336
s_waitcnt lgkmcnt(2)
v_mfma_f32_16x16x32_bf16 v[96:99], v[36:39], v[144:147], v[96:99]
ds_read_b64_tr_b16 v[44:45], v23 offset:16384
ds_read_b64_tr_b16 v[46:47], v23 offset:18432
v_mfma_f32_16x16x32_bf16 v[100:103], v[28:31], v[116:119], 0
ds_read_b64_tr_b16 v[48:49], v23 offset:20480
v_mfma_f32_16x16x32_bf16 v[100:103], v[32:35], v[132:135], v[100:103]
ds_read_b64_tr_b16 v[50:51], v23 offset:22528
v_cvt_pk_bf16_f32 v80, v80, v81
v_mfma_f32_16x16x32_bf16 v[100:103], v[36:39], v[148:151], v[100:103]
v_cvt_pk_bf16_f32 v81, v82, v83
v_mfma_f32_16x16x32_bf16 v[104:107], v[28:31], v[120:123], 0
v_cvt_pk_bf16_f32 v82, v84, v85
v_mfma_f32_16x16x32_bf16 v[104:107], v[32:35], v[136:139], v[104:107]
v_cvt_pk_bf16_f32 v83, v86, v87
s_add_u32 s3, s88, 98304
buffer_store_dwordx4 v[80:83], v18, s[24:27], s3 offen offset:0 sc1
v_mfma_f32_16x16x32_bf16 v[104:107], v[36:39], v[152:155], v[104:107]
v_cvt_pk_bf16_f32 v88, v88, v89
v_mfma_f32_16x16x32_bf16 v[108:111], v[28:31], v[124:127], 0
v_cvt_pk_bf16_f32 v89, v90, v91
v_cvt_pk_bf16_f32 v90, v92, v93
v_mfma_f32_16x16x32_bf16 v[108:111], v[32:35], v[140:143], v[108:111]
v_cvt_pk_bf16_f32 v91, v94, v95
v_mfma_f32_16x16x32_bf16 v[108:111], v[36:39], v[156:159], v[108:111]
s_add_u32 s3, s88, 98304
buffer_store_dwordx4 v[88:91], v18, s[24:27], s3 offen offset:128 sc1
s_mov_b64 exec, s[48:49]
ds_write_b128 v10, v[80:83] offset:6144
ds_write_b128 v10, v[88:91] offset:6272
s_mov_b64 exec, -1
s_waitcnt lgkmcnt(6)
v_mfma_f32_16x16x32_bf16 v[96:99], v[40:43], v[160:163], v[96:99]
ds_read_b64_tr_b16 v[52:53], v23 offset:24576
s_waitcnt lgkmcnt(5)
v_mfma_f32_16x16x32_bf16 v[96:99], v[44:47], v[176:179], v[96:99]
ds_read_b64_tr_b16 v[54:55], v23 offset:26624
s_waitcnt lgkmcnt(4)
v_mfma_f32_16x16x32_bf16 v[96:99], v[48:51], v[192:195], v[96:99]
ds_read_b64_tr_b16 v[56:57], v23 offset:28672
v_mfma_f32_16x16x32_bf16 v[100:103], v[40:43], v[164:167], v[100:103]
ds_read_b64_tr_b16 v[58:59], v23 offset:30720
v_mfma_f32_16x16x32_bf16 v[100:103], v[44:47], v[180:183], v[100:103]
ds_read_b64_tr_b16 v[60:61], v23 offset:32768
v_mfma_f32_16x16x32_bf16 v[100:103], v[48:51], v[196:199], v[100:103]
ds_read_b64_tr_b16 v[62:63], v23 offset:34816
v_mfma_f32_16x16x32_bf16 v[104:107], v[40:43], v[168:171], v[104:107]
v_mfma_f32_16x16x32_bf16 v[104:107], v[44:47], v[184:187], v[104:107]
v_mfma_f32_16x16x32_bf16 v[104:107], v[48:51], v[200:203], v[104:107]
v_mfma_f32_16x16x32_bf16 v[108:111], v[40:43], v[172:175], v[108:111]
v_mfma_f32_16x16x32_bf16 v[108:111], v[44:47], v[188:191], v[108:111]
v_mfma_f32_16x16x32_bf16 v[108:111], v[48:51], v[204:207], v[108:111]
s_add_u32 s3, s47, 0
buffer_load_dwordx4 v[76:79], v2, s[24:27], s3 offen sc1
s_waitcnt lgkmcnt(0)
s_waitcnt vmcnt(6)
s_barrier
ds_read_b64_tr_b16 v[28:29], v20 offset:0
ds_read_b64_tr_b16 v[30:31], v20 offset:2048
ds_read_b64_tr_b16 v[32:33], v20 offset:4096
ds_read_b64_tr_b16 v[34:35], v20 offset:6144
ds_read_b64_tr_b16 v[36:37], v20 offset:8192
ds_read_b64_tr_b16 v[38:39], v20 offset:10240
v_mfma_f32_16x16x32_bf16 v[96:99], v[52:55], v[208:211], v[96:99]
v_mfma_f32_16x16x32_bf16 v[96:99], v[56:59], v[224:227], v[96:99]
v_mfma_f32_16x16x32_bf16 v[96:99], v[60:63], v[240:243], v[96:99]
v_mfma_f32_16x16x32_bf16 v[100:103], v[52:55], v[212:215], v[100:103]
v_mfma_f32_16x16x32_bf16 v[100:103], v[56:59], v[228:231], v[100:103]
v_mfma_f32_16x16x32_bf16 v[100:103], v[60:63], v[244:247], v[100:103]
v_mfma_f32_16x16x32_bf16 v[104:107], v[52:55], v[216:219], v[104:107]
v_mfma_f32_16x16x32_bf16 v[104:107], v[56:59], v[232:235], v[104:107]
v_mfma_f32_16x16x32_bf16 v[104:107], v[60:63], v[248:251], v[104:107]
v_mfma_f32_16x16x32_bf16 v[108:111], v[52:55], v[220:223], v[108:111]
v_mfma_f32_16x16x32_bf16 v[108:111], v[56:59], v[236:239], v[108:111]
v_mfma_f32_16x16x32_bf16 v[108:111], v[60:63], v[252:255], v[108:111]
s_waitcnt lgkmcnt(4)
v_mfma_f32_16x16x32_bf16 v[80:83], v[28:31], v[112:115], 0
ds_read_b64_tr_b16 v[40:41], v20 offset:12288
s_waitcnt lgkmcnt(3)
v_mfma_f32_16x16x32_bf16 v[80:83], v[32:35], v[128:131], v[80:83]
ds_read_b64_tr_b16 v[42:43], v20 offset:14336
s_waitcnt lgkmcnt(2)
v_mfma_f32_16x16x32_bf16 v[80:83], v[36:39], v[144:147], v[80:83]
ds_read_b64_tr_b16 v[44:45], v20 offset:16384
ds_read_b64_tr_b16 v[46:47], v20 offset:18432
v_mfma_f32_16x16x32_bf16 v[84:87], v[28:31], v[116:119], 0
ds_read_b64_tr_b16 v[48:49], v20 offset:20480
v_mfma_f32_16x16x32_bf16 v[84:87], v[32:35], v[132:135], v[84:87]
ds_read_b64_tr_b16 v[50:51], v20 offset:22528
v_cvt_pk_bf16_f32 v96, v96, v97
v_mfma_f32_16x16x32_bf16 v[84:87], v[36:39], v[148:151], v[84:87]
v_cvt_pk_bf16_f32 v97, v98, v99
v_mfma_f32_16x16x32_bf16 v[88:91], v[28:31], v[120:123], 0
v_cvt_pk_bf16_f32 v98, v100, v101
v_mfma_f32_16x16x32_bf16 v[88:91], v[32:35], v[136:139], v[88:91]
v_cvt_pk_bf16_f32 v99, v102, v103
s_add_u32 s3, s88, 114688
buffer_store_dwordx4 v[96:99], v18, s[24:27], s3 offen offset:0 sc1
v_mfma_f32_16x16x32_bf16 v[88:91], v[36:39], v[152:155], v[88:91]
v_cvt_pk_bf16_f32 v104, v104, v105
v_mfma_f32_16x16x32_bf16 v[92:95], v[28:31], v[124:127], 0
v_cvt_pk_bf16_f32 v105, v106, v107
v_cvt_pk_bf16_f32 v106, v108, v109
v_mfma_f32_16x16x32_bf16 v[92:95], v[32:35], v[140:143], v[92:95]
v_cvt_pk_bf16_f32 v107, v110, v111
v_mfma_f32_16x16x32_bf16 v[92:95], v[36:39], v[156:159], v[92:95]
s_add_u32 s3, s88, 114688
buffer_store_dwordx4 v[104:107], v18, s[24:27], s3 offen offset:128 sc1
s_mov_b64 exec, s[48:49]
ds_write_b128 v10, v[96:99] offset:7168
ds_write_b128 v10, v[104:107] offset:7296
s_mov_b64 exec, -1
s_waitcnt lgkmcnt(6)
v_mfma_f32_16x16x32_bf16 v[80:83], v[40:43], v[160:163], v[80:83]
ds_read_b64_tr_b16 v[52:53], v20 offset:24576
s_waitcnt lgkmcnt(5)
v_mfma_f32_16x16x32_bf16 v[80:83], v[44:47], v[176:179], v[80:83]
ds_read_b64_tr_b16 v[54:55], v20 offset:26624
s_waitcnt lgkmcnt(4)
v_mfma_f32_16x16x32_bf16 v[80:83], v[48:51], v[192:195], v[80:83]
ds_read_b64_tr_b16 v[56:57], v20 offset:28672
v_mfma_f32_16x16x32_bf16 v[84:87], v[40:43], v[164:167], v[84:87]
ds_read_b64_tr_b16 v[58:59], v20 offset:30720
v_mfma_f32_16x16x32_bf16 v[84:87], v[44:47], v[180:183], v[84:87]
ds_read_b64_tr_b16 v[60:61], v20 offset:32768
v_mfma_f32_16x16x32_bf16 v[84:87], v[48:51], v[196:199], v[84:87]
ds_read_b64_tr_b16 v[62:63], v20 offset:34816
v_mfma_f32_16x16x32_bf16 v[88:91], v[40:43], v[168:171], v[88:91]
v_mfma_f32_16x16x32_bf16 v[88:91], v[44:47], v[184:187], v[88:91]
v_mfma_f32_16x16x32_bf16 v[88:91], v[48:51], v[200:203], v[88:91]
v_mfma_f32_16x16x32_bf16 v[92:95], v[40:43], v[172:175], v[92:95]
v_mfma_f32_16x16x32_bf16 v[92:95], v[44:47], v[188:191], v[92:95]
v_mfma_f32_16x16x32_bf16 v[92:95], v[48:51], v[204:207], v[92:95]
s_movk_i32 s3, 0
buffer_load_dwordx2 v[6:7], v3, s[36:39], s3 offen sc1
s_mov_b32 s3, 32768
buffer_load_dword v29, v8, s[28:31], s3 offen sc1
s_waitcnt lgkmcnt(4)
v_mfma_f32_16x16x32_bf16 v[80:83], v[52:55], v[208:211], v[80:83]
s_waitcnt lgkmcnt(2)
v_mfma_f32_16x16x32_bf16 v[80:83], v[56:59], v[224:227], v[80:83]
s_waitcnt lgkmcnt(0)
v_mfma_f32_16x16x32_bf16 v[80:83], v[60:63], v[240:243], v[80:83]
v_mfma_f32_16x16x32_bf16 v[84:87], v[52:55], v[212:215], v[84:87]
v_mfma_f32_16x16x32_bf16 v[84:87], v[56:59], v[228:231], v[84:87]
v_mfma_f32_16x16x32_bf16 v[84:87], v[60:63], v[244:247], v[84:87]
v_mfma_f32_16x16x32_bf16 v[88:91], v[52:55], v[216:219], v[88:91]
v_mfma_f32_16x16x32_bf16 v[88:91], v[56:59], v[232:235], v[88:91]
v_mfma_f32_16x16x32_bf16 v[88:91], v[60:63], v[248:251], v[88:91]
v_mfma_f32_16x16x32_bf16 v[92:95], v[52:55], v[220:223], v[92:95]
v_mfma_f32_16x16x32_bf16 v[92:95], v[56:59], v[236:239], v[92:95]
v_mfma_f32_16x16x32_bf16 v[92:95], v[60:63], v[252:255], v[92:95]
v_cvt_pk_bf16_f32 v80, v80, v81
v_cvt_pk_bf16_f32 v81, v82, v83
v_cvt_pk_bf16_f32 v82, v84, v85
v_cvt_pk_bf16_f32 v83, v86, v87
s_add_u32 s3, s88, 131072
buffer_store_dwordx4 v[80:83], v18, s[24:27], s3 offen offset:0 sc1
v_cvt_pk_bf16_f32 v88, v88, v89
v_cvt_pk_bf16_f32 v89, v90, v91
v_cvt_pk_bf16_f32 v90, v92, v93
v_cvt_pk_bf16_f32 v91, v94, v95
s_add_u32 s3, s88, 131072
buffer_store_dwordx4 v[88:91], v18, s[24:27], s3 offen offset:128 sc1
s_mov_b64 exec, s[48:49]
ds_write_b128 v10, v[80:83] offset:8192
ds_write_b128 v10, v[88:91] offset:8320
s_mov_b64 exec, -1
s_waitcnt vmcnt(4)
s_barrier
s_cmp_lg_u32 s56, 0
s_cbranch_scc1 pf_sig2
s_mov_b32 s3, 65536
buffer_store_dword v5, v9, s[28:31], s3 offen sc1
pf_sig2:
s_mov_b32 s3, 32768
s_waitcnt vmcnt(2)
v_cmp_eq_u32 vcc, 0, v29
s_cbranch_vccnz pf_ac1_slow
pf_ac1_ok:
s_add_u32 s3, s44, 32768
s_mov_b64 exec, 0xffff
ds_read_b128 v[136:139], v11 offset:2048
s_mov_b32 exec_hi, -1
s_mov_b32 exec_lo, 0xffff0000
s_waitcnt lgkmcnt(0)
buffer_load_dwordx4 v[136:139], v2, s[24:27], s3 offen sc1
s_mov_b64 exec, -1
s_add_u32 s3, s45, 32768
buffer_load_dwordx4 v[140:143], v2, s[24:27], s3 offen sc1
s_add_u32 s3, s46, 32768
buffer_load_dwordx4 v[144:147], v2, s[24:27], s3 offen sc1
s_add_u32 s3, s47, 32768
buffer_load_dwordx4 v[148:151], v2, s[24:27], s3 offen sc1
s_movk_i32 s3, 4096
buffer_load_dwordx2 v[152:153], v3, s[36:39], s3 offen sc1
s_add_u32 s3, s44, 65536
s_mov_b64 exec, 0xffff
ds_read_b128 v[160:163], v11 offset:4096
s_mov_b32 exec_hi, -1
s_mov_b32 exec_lo, 0xffff0000
s_waitcnt lgkmcnt(0)
buffer_load_dwordx4 v[160:163], v2, s[24:27], s3 offen sc1
s_mov_b64 exec, -1
s_add_u32 s3, s45, 65536
buffer_load_dwordx4 v[164:167], v2, s[24:27], s3 offen sc1
s_add_u32 s3, s46, 65536
buffer_load_dwordx4 v[168:171], v2, s[24:27], s3 offen sc1
s_add_u32 s3, s47, 65536
buffer_load_dwordx4 v[172:175], v2, s[24:27], s3 offen sc1
s_movk_i32 s3, 8192
buffer_load_dwordx2 v[176:177], v3, s[36:39], s3 offen sc1
s_waitcnt vmcnt(10)
s_barrier
s_cmp_lg_u32 s56, 0
s_cbranch_scc1 pf_sig3
s_mov_b32 s3, 98304
buffer_store_dword v5, v9, s[28:31], s3 offen sc1
pf_sig3:
s_mov_b32 s3, 65536
buffer_load_dword v19, v8, s[28:31], s3 offen sc1
v_mfma_f32_16x16x32_bf16 v[24:27], v[12:15], v[76:79], 0
v_mfma_f32_16x16x32_bf16 v[24:27], v[12:15], v[72:75], v[24:27]
v_mfma_f32_16x16x32_bf16 v[24:27], v[12:15], v[68:71], v[24:27]
v_mfma_f32_16x16x32_bf16 v[24:27], v[12:15], v[64:67], v[24:27]
v_lshlrev_b32 v64, 16, v6
v_and_b32 v65, 0xffff0000, v6
v_lshlrev_b32 v66, 16, v7
v_and_b32 v67, 0xffff0000, v7
s_nop 3
v_fma_f32 v64, v24, s91, v64
v_fma_f32 v65, v25, s91, v65
v_fma_f32 v66, v26, s91, v66
v_fma_f32 v67, v27, s91, v67
v_cvt_pk_bf16_f32 v6, v64, v65
v_cvt_pk_bf16_f32 v7, v66, v67
s_mov_b32 s3, 65536
s_waitcnt vmcnt(0)
v_cmp_eq_u32 vcc, 0, v19
s_cbranch_vccnz pf_ac2_slow
pf_ac2_ok:
s_add_u32 s3, s44, 98304
s_mov_b64 exec, 0xffff
ds_read_b128 v[184:187], v11 offset:6144
s_mov_b32 exec_hi, -1
s_mov_b32 exec_lo, 0xffff0000
s_waitcnt lgkmcnt(0)
buffer_load_dwordx4 v[184:187], v2, s[24:27], s3 offen sc1
s_mov_b64 exec, -1
s_add_u32 s3, s45, 98304
buffer_load_dwordx4 v[188:191], v2, s[24:27], s3 offen sc1
s_add_u32 s3, s46, 98304
buffer_load_dwordx4 v[192:195], v2, s[24:27], s3 offen sc1
s_add_u32 s3, s47, 98304
buffer_load_dwordx4 v[196:199], v2, s[24:27], s3 offen sc1
s_movk_i32 s3, 12288
buffer_load_dwordx2 v[200:201], v3, s[36:39], s3 offen sc1
buffer_store_dwordx2 v[6:7], v4, s[40:43], 0 offen offset:0
s_mov_b32 s3, 98304
buffer_load_dword v19, v8, s[28:31], s3 offen sc1
v_mfma_f32_16x16x32_bf16 v[156:159], v[12:15], v[148:151], 0
v_mfma_f32_16x16x32_bf16 v[156:159], v[12:15], v[144:147], v[156:159]
v_mfma_f32_16x16x32_bf16 v[156:159], v[12:15], v[140:143], v[156:159]
v_mfma_f32_16x16x32_bf16 v[156:159], v[12:15], v[136:139], v[156:159]
v_lshlrev_b32 v136, 16, v152
v_and_b32 v137, 0xffff0000, v152
v_lshlrev_b32 v138, 16, v153
v_and_b32 v139, 0xffff0000, v153
s_nop 3
v_fma_f32 v136, v156, s91, v136
v_fma_f32 v137, v157, s91, v137
v_fma_f32 v138, v158, s91, v138
v_fma_f32 v139, v159, s91, v139
v_cvt_pk_bf16_f32 v152, v136, v137
v_cvt_pk_bf16_f32 v153, v138, v139
v_mfma_f32_16x16x32_bf16 v[180:183], v[12:15], v[172:175], 0
v_mfma_f32_16x16x32_bf16 v[180:183], v[12:15], v[168:171], v[180:183]
v_mfma_f32_16x16x32_bf16 v[180:183], v[12:15], v[164:167], v[180:183]
v_mfma_f32_16x16x32_bf16 v[180:183], v[12:15], v[160:163], v[180:183]
v_lshlrev_b32 v160, 16, v176
v_and_b32 v161, 0xffff0000, v176
v_lshlrev_b32 v162, 16, v177
v_and_b32 v163, 0xffff0000, v177
s_nop 3
v_fma_f32 v160, v180, s91, v160
v_fma_f32 v161, v181, s91, v161
v_fma_f32 v162, v182, s91, v162
v_fma_f32 v163, v183, s91, v163
v_cvt_pk_bf16_f32 v176, v160, v161
v_cvt_pk_bf16_f32 v177, v162, v163
s_waitcnt vmcnt(3)
v_mfma_f32_16x16x32_bf16 v[204:207], v[12:15], v[196:199], 0
v_mfma_f32_16x16x32_bf16 v[204:207], v[12:15], v[192:195], v[204:207]
v_mfma_f32_16x16x32_bf16 v[204:207], v[12:15], v[188:191], v[204:207]
v_mfma_f32_16x16x32_bf16 v[204:207], v[12:15], v[184:187], v[204:207]
s_waitcnt vmcnt(2)
v_lshlrev_b32 v184, 16, v200
v_and_b32 v185, 0xffff0000, v200
v_lshlrev_b32 v186, 16, v201
v_and_b32 v187, 0xffff0000, v201
s_nop 2
v_fma_f32 v184, v204, s91, v184
v_fma_f32 v185, v205, s91, v185
v_fma_f32 v186, v206, s91, v186
v_fma_f32 v187, v207, s91, v187
v_cvt_pk_bf16_f32 v200, v184, v185
v_cvt_pk_bf16_f32 v201, v186, v187
s_mov_b32 s3, 98304
s_waitcnt vmcnt(0)
v_cmp_eq_u32 vcc, 0, v19
s_cbranch_vccnz pf_ac3_slow
pf_ac3_ok:
s_add_u32 s3, s44, 131072
s_mov_b64 exec, 0xffff
ds_read_b128 v[208:211], v11 offset:8192
s_mov_b32 exec_hi, -1
s_mov_b32 exec_lo, 0xffff0000
s_waitcnt lgkmcnt(0)
buffer_load_dwordx4 v[208:211], v2, s[24:27], s3 offen sc1
s_mov_b64 exec, -1
s_add_u32 s3, s45, 131072
buffer_load_dwordx4 v[212:215], v2, s[24:27], s3 offen sc1
s_add_u32 s3, s46, 131072
buffer_load_dwordx4 v[216:219], v2, s[24:27], s3 offen sc1
s_add_u32 s3, s47, 131072
buffer_load_dwordx4 v[220:223], v2, s[24:27], s3 offen sc1
s_movk_i32 s3, 16384
buffer_load_dwordx2 v[224:225], v3, s[36:39], s3 offen sc1
buffer_store_dwordx2 v[152:153], v4, s[40:43], 0 offen offset:256
buffer_store_dwordx2 v[176:177], v4, s[40:43], 0 offen offset:512
buffer_store_dwordx2 v[200:201], v4, s[40:43], 0 offen offset:768
s_waitcnt vmcnt(4)
v_mfma_f32_16x16x32_bf16 v[228:231], v[12:15], v[220:223], 0
v_mfma_f32_16x16x32_bf16 v[228:231], v[12:15], v[216:219], v[228:231]
v_mfma_f32_16x16x32_bf16 v[228:231], v[12:15], v[212:215], v[228:231]
v_mfma_f32_16x16x32_bf16 v[228:231], v[12:15], v[208:211], v[228:231]
s_waitcnt vmcnt(3)
v_lshlrev_b32 v208, 16, v224
v_and_b32 v209, 0xffff0000, v224
v_lshlrev_b32 v210, 16, v225
v_and_b32 v211, 0xffff0000, v225
s_nop 2
v_fma_f32 v208, v228, s91, v208
v_fma_f32 v209, v229, s91, v209
v_fma_f32 v210, v230, s91, v210
v_fma_f32 v211, v231, s91, v211
v_cvt_pk_bf16_f32 v224, v208, v209
v_cvt_pk_bf16_f32 v225, v210, v211
buffer_store_dwordx2 v[224:225], v4, s[40:43], 0 offen offset:1024
s_endpgm
pf_p4:
s_lshl_b32 s3, s57, 4
s_add_u32 s3, s3, s58
s_lshl_b32 s3, s3, 7
s_lshl_b32 s4, s56, 2
s_add_u32 s91, s3, s4
s_add_u32 s93, s91, 0
buffer_load_dword v27, v26, s[28:31], s93 offen sc1
v_lshrrev_b32 v5, 4, v0
v_bfe_u32 v6, v0, 2, 2
v_lshl_add_u32 v7, v5, 3, v6
v_mul_u32_u24 v7, 576, v7
v_and_b32 v14, 3, v0
v_lshl_add_u32 v7, v14, 3, v7
s_mul_i32 s3, s80, 9
s_add_u32 s3, s3, 5
s_lshl_b32 s4, s3, 5
s_add_u32 s4, s4, 8192
v_add_u32 v7, s4, v7
s_and_b32 s3, s3, 1
s_cmp_eq_u32 s3, 0
s_cselect_b32 s3, 32, -32
v_and_b32 v14, 1, v5
v_mul_i32_i24 v14, s3, v14
v_add_u32 v11, v7, v14
v_sub_u32 v14, v7, v14
s_lshl_b32 s3, s59, 12
s_add_u32 s3, s3, 0
v_add_u32 v8, s3, v1
v_add_u32 v9, 45056, v8
v_add_u32 v12, 45056, v11
v_add_u32 v15, 45056, v14
v_add_u32 v10, 90112, v8
v_add_u32 v13, 90112, v11
v_add_u32 v16, 90112, v14
v_lshrrev_b32 v17, 3, v0
v_mul_u32_u24 v17, 1152, v17
v_bfe_u32 v7, v0, 1, 2
v_xor_b32 v7, v7, v5
v_lshl_add_u32 v17, v7, 5, v17
v_and_b32 v7, 1, v0
v_lshl_add_u32 v17, v7, 4, v17
s_mul_i32 s3, s56, 5
s_sub_u32 s3, s3, 4
s_lshl_b32 s87, s3, 10
s_mul_i32 s3, s3, 9216
s_mul_i32 s86, s58, 331776
s_add_u32 s86, s86, s3
v_lshl_add_u32 v20, v5, 2, v6
v_bfe_u32 v7, v20, 1, 2
v_xor_b32 v7, s89, v7
v_lshlrev_b32 v7, 5, v7
v_lshl_add_u32 v20, v20, 7, v7
v_and_b32 v7, 3, v0
v_lshl_add_u32 v20, v7, 3, v20
v_add_u32 v21, 36864, v20
v_add_u32 v22, 90112, v20
v_add_u32 v23, 126976, v20
v_add_u32 v20, 0, v20
s_xor_b32 s3, s59, 0
s_mul_i32 s3, s3, 36864
s_add_u32 s3, s3, 90112
v_add_u32 v24, s3, v1
s_mul_i32 s3, s59, 36864
s_add_u32 s3, s3, 90112
s_mul_i32 s4, s80, 9
s_add_u32 s4, s4, 5
s_lshr_b32 s5, s4, 1
s_lshl_b32 s5, s5, 10
s_add_u32 s3, s3, s5
s_and_b32 s4, s4, 1
s_lshl_b32 s5, s4, 3
s_add_u32 s5, s5, s3
v_add_u32 v19, s5, v1
s_mul_i32 s5, s4, 1024
s_add_u32 s5, s5, s3
s_xor_b32 s4, s4, 1
s_lshl_b32 s4, s4, 3
s_add_u32 s5, s5, s4
v_add_u32 v25, s5, v1
v_bfe_u32 v7, v0, 1, 3
v_lshlrev_b32 v18, 10, v7
v_and_b32 v7, 1, v0
v_lshl_add_u32 v18, v7, 6, v18
v_lshl_add_u32 v18, v5, 4, v18
s_mul_i32 s90, s57, 2359296
s_mul_i32 s3, s58, 147456
s_add_u32 s88, s90, s3
s_lshl_b32 s4, s59, 13
s_add_u32 s88, s88, s4
s_lshl_b32 s4, s89, 8
s_add_u32 s88, s88, s4
s_cmp_lg_u32 s92, 0
s_cbranch_scc1 pf_bip
s_mov_b32 s94, 589824
buffer_load_dword v28, v31, s[44:47], s94 offen
s_mov_b32 s94, 663552
buffer_load_dword v28, v31, s[44:47], s94 offen
pf_bip:
s_waitcnt vmcnt(0)
v_cmp_eq_u32 vcc, 0, v27
s_cbranch_vccnz pf_bx_slow
pf_bx_ok:
s_add_u32 m0, s84, 0
s_add_u32 s94, s82, 0
buffer_load_dwordx4 v1, s[20:23], s94 offen sc1 lds
s_add_u32 m0, s84, 45056
s_add_u32 s94, s82, 1024
buffer_load_dwordx4 v1, s[20:23], s94 offen sc1 lds
s_waitcnt vmcnt(1)
s_cmp_eq_u32 s92, 0
s_cbranch_scc1 pf_bhl
buffer_store_dwordx4 v[192:195], v37, s[36:39], s50 offen offset:0 sc1
buffer_store_dwordx4 v[196:199], v37, s[36:39], s50 offen offset:1024 sc1
s_cmp_lg_u32 s56, 1
s_cbranch_scc1 pf_bhl
buffer_store_dwordx4 v[200:203], v37, s[36:39], s100 offen offset:0 sc1
buffer_store_dwordx4 v[204:207], v37, s[36:39], s100 offen offset:1024 sc1
pf_bhl:
s_barrier
ds_read_b128 v[64:67], v8 offset:0
ds_read_b128 v[68:71], v8 offset:1024
ds_read_b128 v[72:75], v8 offset:2048
ds_read_b128 v[76:79], v8 offset:3072
ds_read_b64_tr_b16 v[32:33], v11 offset:0
ds_read_b64_tr_b16 v[34:35], v11 offset:2304
ds_read_b64_tr_b16 v[36:37], v11 offset:18432
ds_read_b64_tr_b16 v[38:39], v11 offset:20736
ds_read_b64_tr_b16 v[40:41], v14 offset:32
ds_read_b64_tr_b16 v[42:43], v14 offset:2336
s_waitcnt lgkmcnt(4)
v_mfma_f32_16x16x32_bf16 v[128:131], v[32:35], v[64:67], 0
v_mfma_f32_16x16x32_bf16 v[132:135], v[32:35], v[68:71], 0
s_add_u32 m0, s84, 90112
s_add_u32 s94, s82, 2048
ds_read_b64_tr_b16 v[44:45], v14 offset:18464
v_mfma_f32_16x16x32_bf16 v[136:139], v[32:35], v[72:75], 0
buffer_load_dwordx4 v1, s[20:23], s94 offen sc1 lds
v_mfma_f32_16x16x32_bf16 v[140:143], v[32:35], v[76:79], 0
ds_read_b64_tr_b16 v[46:47], v14 offset:20768
s_waitcnt lgkmcnt(4)
v_mfma_f32_16x16x32_bf16 v[144:147], v[36:39], v[64:67], 0
s_add_u32 m0, s83, 90112
s_add_u32 s95, s81, 589824
v_mfma_f32_16x16x32_bf16 v[148:151], v[36:39], v[68:71], 0
buffer_load_dwordx4 v2, s[8:11], s95 offen  lds
ds_read_b64_tr_b16 v[48:49], v11 offset:64
v_mfma_f32_16x16x32_bf16 v[152:155], v[36:39], v[72:75], 0
v_mfma_f32_16x16x32_bf16 v[156:159], v[36:39], v[76:79], 0
s_add_u32 m0, s83, 91136
ds_read_b64_tr_b16 v[50:51], v11 offset:2368
s_waitcnt lgkmcnt(4)
v_mfma_f32_16x16x32_bf16 v[160:163], v[40:43], v[64:67], 0
buffer_load_dwordx4 v3, s[8:11], s95 offen  lds
v_mfma_f32_16x16x32_bf16 v[164:167], v[40:43], v[68:71], 0
ds_read_b64_tr_b16 v[52:53], v11 offset:18496
v_mfma_f32_16x16x32_bf16 v[168:171], v[40:43], v[72:75], 0
s_add_u32 m0, s83, 108544
v_mfma_f32_16x16x32_bf16 v[172:175], v[40:43], v[76:79], 0
buffer_load_dwordx4 v2, s[12:15], s95 offen  lds
ds_read_b64_tr_b16 v[54:55], v11 offset:20800
s_waitcnt lgkmcnt(4)
v_mfma_f32_16x16x32_bf16 v[176:179], v[44:47], v[64:67], 0
v_mfma_f32_16x16x32_bf16 v[180:183], v[44:47], v[68:71], 0
s_add_u32 m0, s83, 109568
ds_read_b64_tr_b16 v[56:57], v14 offset:96
v_mfma_f32_16x16x32_bf16 v[184:187], v[44:47], v[72:75], 0
buffer_load_dwordx4 v3, s[12:15], s95 offen  lds
v_mfma_f32_16x16x32_bf16 v[188:191], v[44:47], v[76:79], 0
ds_read_b64_tr_b16 v[58:59], v14 offset:2400
s_waitcnt lgkmcnt(4)
v_mfma_f32_16x16x32_bf16 v[192:195], v[48:51], v[64:67], 0
s_add_u32 m0, s85, 90112
v_mfma_f32_16x16x32_bf16 v[196:199], v[48:51], v[68:71], 0
buffer_load_dwordx4 v4, s[32:35], s95 offen  lds
ds_read_b64_tr_b16 v[60:61], v14 offset:18528
v_mfma_f32_16x16x32_bf16 v[200:203], v[48:51], v[72:75], 0
v_mfma_f32_16x16x32_bf16 v[204:207], v[48:51], v[76:79], 0
s_mov_b32 s94, 1179648
ds_read_b64_tr_b16 v[62:63], v14 offset:20832
s_waitcnt lgkmcnt(4)
v_mfma_f32_16x16x32_bf16 v[208:211], v[52:55], v[64:67], 0
buffer_load_dword v28, v31, s[44:47], s94 offen
v_mfma_f32_16x16x32_bf16 v[212:215], v[52:55], v[68:71], 0
v_mfma_f32_16x16x32_bf16 v[216:219], v[52:55], v[72:75], 0
v_mfma_f32_16x16x32_bf16 v[220:223], v[52:55], v[76:79], 0
s_waitcnt lgkmcnt(0)
s_waitcnt vmcnt(7)
s_barrier
ds_read_b128 v[80:83], v9 offset:0
ds_read_b128 v[84:87], v9 offset:1024
ds_read_b128 v[88:91], v9 offset:2048
ds_read_b128 v[92:95], v9 offset:3072
ds_read_b64_tr_b16 v[32:33], v12 offset:0
ds_read_b64_tr_b16 v[34:35], v12 offset:2304
ds_read_b64_tr_b16 v[36:37], v12 offset:18432
ds_read_b64_tr_b16 v[38:39], v12 offset:20736
ds_read_b64_tr_b16 v[40:41], v15 offset:32
ds_read_b64_tr_b16 v[42:43], v15 offset:2336
v_mfma_f32_16x16x32_bf16 v[224:227], v[56:59], v[64:67], 0
v_mfma_f32_16x16x32_bf16 v[228:231], v[56:59], v[68:71], 0
s_add_u32 m0, s84, 0
s_add_u32 s94, s82, 3072
v_mfma_f32_16x16x32_bf16 v[232:235], v[56:59], v[72:75], 0
buffer_load_dwordx4 v1, s[20:23], s94 offen sc1 lds
v_mfma_f32_16x16x32_bf16 v[236:239], v[56:59], v[76:79], 0
v_mfma_f32_16x16x32_bf16 v[240:243], v[60:63], v[64:67], 0
s_add_u32 m0, s83, 0
s_add_u32 s95, s81, 663552
v_mfma_f32_16x16x32_bf16 v[244:247], v[60:63], v[68:71], 0
buffer_load_dwordx4 v2, s[8:11], s95 offen  lds
v_mfma_f32_16x16x32_bf16 v[248:251], v[60:63], v[72:75], 0
v_mfma_f32_16x16x32_bf16 v[252:255], v[60:63], v[76:79], 0
s_add_u32 m0, s83, 1024
s_waitcnt lgkmcnt(4)
v_mfma_f32_16x16x32_bf16 v[128:131], v[32:35], v[80:83], v[128:131]
buffer_load_dwordx4 v3, s[8:11], s95 offen  lds
v_mfma_f32_16x16x32_bf16 v[132:135], v[32:35], v[84:87], v[132:135]
ds_read_b64_tr_b16 v[44:45], v15 offset:18464
v_mfma_f32_16x16x32_bf16 v[136:139], v[32:35], v[88:91], v[136:139]
s_add_u32 m0, s83, 18432
v_mfma_f32_16x16x32_bf16 v[140:143], v[32:35], v[92:95], v[140:143]
buffer_load_dwordx4 v2, s[12:15], s95 offen  lds
ds_read_b64_tr_b16 v[46:47], v15 offset:20768
s_waitcnt lgkmcnt(4)
v_mfma_f32_16x16x32_bf16 v[144:147], v[36:39], v[80:83], v[144:147]
v_mfma_f32_16x16x32_bf16 v[148:151], v[36:39], v[84:87], v[148:151]
s_add_u32 m0, s83, 19456
ds_read_b64_tr_b16 v[48:49], v12 offset:64
v_mfma_f32_16x16x32_bf16 v[152:155], v[36:39], v[88:91], v[152:155]
buffer_load_dwordx4 v3, s[12:15], s95 offen  lds
v_mfma_f32_16x16x32_bf16 v[156:159], v[36:39], v[92:95], v[156:159]
ds_read_b64_tr_b16 v[50:51], v12 offset:2368
s_waitcnt lgkmcnt(4)
v_mfma_f32_16x16x32_bf16 v[160:163], v[40:43], v[80:83], v[160:163]
s_add_u32 m0, s85, 0
v_mfma_f32_16x16x32_bf16 v[164:167], v[40:43], v[84:87], v[164:167]
buffer_load_dwordx4 v4, s[32:35], s95 offen  lds
ds_read_b64_tr_b16 v[52:53], v12 offset:18496
v_mfma_f32_16x16x32_bf16 v[168:171], v[40:43], v[88:91], v[168:171]
v_mfma_f32_16x16x32_bf16 v[172:175], v[40:43], v[92:95], v[172:175]
s_mov_b32 s94, 1253376
ds_read_b64_tr_b16 v[54:55], v12 offset:20800
s_waitcnt lgkmcnt(4)
v_mfma_f32_16x16x32_bf16 v[176:179], v[44:47], v[80:83], v[176:179]
buffer_load_dword v28, v31, s[44:47], s94 offen
v_mfma_f32_16x16x32_bf16 v[180:183], v[44:47], v[84:87], v[180:183]
ds_read_b64_tr_b16 v[56:57], v15 offset:96
v_mfma_f32_16x16x32_bf16 v[184:187], v[44:47], v[88:91], v[184:187]
v_mfma_f32_16x16x32_bf16 v[188:191], v[44:47], v[92:95], v[188:191]
ds_read_b64_tr_b16 v[58:59], v15 offset:2400
s_waitcnt lgkmcnt(4)
v_mfma_f32_16x16x32_bf16 v[192:195], v[48:51], v[80:83], v[192:195]
v_mfma_f32_16x16x32_bf16 v[196:199], v[48:51], v[84:87], v[196:199]
ds_read_b64_tr_b16 v[60:61], v15 offset:18528
v_mfma_f32_16x16x32_bf16 v[200:203], v[48:51], v[88:91], v[200:203]
v_mfma_f32_16x16x32_bf16 v[204:207], v[48:51], v[92:95], v[204:207]
ds_read_b64_tr_b16 v[62:63], v15 offset:20832
s_waitcnt lgkmcnt(4)
v_mfma_f32_16x16x32_bf16 v[208:211], v[52:55], v[80:83], v[208:211]
v_mfma_f32_16x16x32_bf16 v[212:215], v[52:55], v[84:87], v[212:215]
v_mfma_f32_16x16x32_bf16 v[216:219], v[52:55], v[88:91], v[216:219]
v_mfma_f32_16x16x32_bf16 v[220:223], v[52:55], v[92:95], v[220:223]
s_waitcnt lgkmcnt(0)
s_waitcnt vmcnt(8)
s_barrier
ds_read_b128 v[64:67], v10 offset:0
ds_read_b128 v[68:71], v10 offset:1024
ds_read_b128 v[72:75], v10 offset:2048
ds_read_b128 v[76:79], v10 offset:3072
ds_read_b64_tr_b16 v[32:33], v13 offset:0
ds_read_b64_tr_b16 v[34:35], v13 offset:2304
ds_read_b64_tr_b16 v[36:37], v13 offset:18432
ds_read_b64_tr_b16 v[38:39], v13 offset:20736
ds_read_b64_tr_b16 v[40:41], v16 offset:32
ds_read_b64_tr_b16 v[42:43], v16 offset:2336
v_mfma_f32_16x16x32_bf16 v[224:227], v[56:59], v[80:83], v[224:227]
v_mfma_f32_16x16x32_bf16 v[228:231], v[56:59], v[84:87], v[228:231]
s_add_u32 m0, s84, 45056
s_add_u32 s94, s82, 4096
v_mfma_f32_16x16x32_bf16 v[232:235], v[56:59], v[88:91], v[232:235]
buffer_load_dwordx4 v1, s[20:23], s94 offen sc1 lds
v_mfma_f32_16x16x32_bf16 v[236:239], v[56:59], v[92:95], v[236:239]
v_mfma_f32_16x16x32_bf16 v[240:243], v[60:63], v[80:83], v[240:243]
s_add_u32 m0, s83, 45056
s_add_u32 s95, s81, 1179648
v_mfma_f32_16x16x32_bf16 v[244:247], v[60:63], v[84:87], v[244:247]
buffer_load_dwordx4 v2, s[8:11], s95 offen  lds
v_mfma_f32_16x16x32_bf16 v[248:251], v[60:63], v[88:91], v[248:251]
v_mfma_f32_16x16x32_bf16 v[252:255], v[60:63], v[92:95], v[252:255]
s_add_u32 m0, s83, 46080
s_waitcnt lgkmcnt(4)
v_mfma_f32_16x16x32_bf16 v[128:131], v[32:35], v[64:67], v[128:131]
buffer_load_dwordx4 v3, s[8:11], s95 offen  lds
v_mfma_f32_16x16x32_bf16 v[132:135], v[32:35], v[68:71], v[132:135]
ds_read_b64_tr_b16 v[44:45], v16 offset:18464
v_mfma_f32_16x16x32_bf16 v[136:139], v[32:35], v[72:75], v[136:139]
s_add_u32 m0, s83, 63488
v_mfma_f32_16x16x32_bf16 v[140:143], v[32:35], v[76:79], v[140:143]
buffer_load_dwordx4 v2, s[12:15], s95 offen  lds
ds_read_b64_tr_b16 v[46:47], v16 offset:20768
s_waitcnt lgkmcnt(4)
v_mfma_f32_16x16x32_bf16 v[144:147], v[36:39], v[64:67], v[144:147]
v_mfma_f32_16x16x32_bf16 v[148:151], v[36:39], v[68:71], v[148:151]
s_add_u32 m0, s83, 64512
ds_read_b64_tr_b16 v[48:49], v13 offset:64
v_mfma_f32_16x16x32_bf16 v[152:155], v[36:39], v[72:75], v[152:155]
buffer_load_dwordx4 v3, s[12:15], s95 offen  lds
v_mfma_f32_16x16x32_bf16 v[156:159], v[36:39], v[76:79], v[156:159]
ds_read_b64_tr_b16 v[50:51], v13 offset:2368
s_waitcnt lgkmcnt(4)
v_mfma_f32_16x16x32_bf16 v[160:163], v[40:43], v[64:67], v[160:163]
s_add_u32 m0, s85, 45056
v_mfma_f32_16x16x32_bf16 v[164:167], v[40:43], v[68:71], v[164:167]
buffer_load_dwordx4 v4, s[32:35], s95 offen  lds
ds_read_b64_tr_b16 v[52:53], v13 offset:18496
v_mfma_f32_16x16x32_bf16 v[168:171], v[40:43], v[72:75], v[168:171]
v_mfma_f32_16x16x32_bf16 v[172:175], v[40:43], v[76:79], v[172:175]
s_mov_b32 s94, 1769472
ds_read_b64_tr_b16 v[54:55], v13 offset:20800
s_waitcnt lgkmcnt(4)
v_mfma_f32_16x16x32_bf16 v[176:179], v[44:47], v[64:67], v[176:179]
buffer_load_dword v28, v31, s[44:47], s94 offen
v_mfma_f32_16x16x32_bf16 v[180:183], v[44:47], v[68:71], v[180:183]
ds_read_b64_tr_b16 v[56:57], v16 offset:96
v_mfma_f32_16x16x32_bf16 v[184:187], v[44:47], v[72:75], v[184:187]
v_mfma_f32_16x16x32_bf16 v[188:191], v[44:47], v[76:79], v[188:191]
ds_read_b64_tr_b16 v[58:59], v16 offset:2400
s_waitcnt lgkmcnt(4)
v_mfma_f32_16x16x32_bf16 v[192:195], v[48:51], v[64:67], v[192:195]
v_mfma_f32_16x16x32_bf16 v[196:199], v[48:51], v[68:71], v[196:199]
ds_read_b64_tr_b16 v[60:61], v16 offset:18528
v_mfma_f32_16x16x32_bf16 v[200:203], v[48:51], v[72:75], v[200:203]
v_mfma_f32_16x16x32_bf16 v[204:207], v[48:51], v[76:79], v[204:207]
ds_read_b64_tr_b16 v[62:63], v16 offset:20832
s_waitcnt lgkmcnt(4)
v_mfma_f32_16x16x32_bf16 v[208:211], v[52:55], v[64:67], v[208:211]
v_mfma_f32_16x16x32_bf16 v[212:215], v[52:55], v[68:71], v[212:215]
v_mfma_f32_16x16x32_bf16 v[216:219], v[52:55], v[72:75], v[216:219]
v_mfma_f32_16x16x32_bf16 v[220:223], v[52:55], v[76:79], v[220:223]
s_waitcnt lgkmcnt(0)
s_waitcnt vmcnt(8)
s_barrier
ds_read_b128 v[80:83], v8 offset:0
ds_read_b128 v[84:87], v8 offset:1024
ds_read_b128 v[88:91], v8 offset:2048
ds_read_b128 v[92:95], v8 offset:3072
ds_read_b64_tr_b16 v[32:33], v11 offset:0
ds_read_b64_tr_b16 v[34:35], v11 offset:2304
ds_read_b64_tr_b16 v[36:37], v11 offset:18432
ds_read_b64_tr_b16 v[38:39], v11 offset:20736
ds_read_b64_tr_b16 v[40:41], v14 offset:32
ds_read_b64_tr_b16 v[42:43], v14 offset:2336
v_mfma_f32_16x16x32_bf16 v[224:227], v[56:59], v[64:67], v[224:227]
v_mfma_f32_16x16x32_bf16 v[228:231], v[56:59], v[68:71], v[228:231]
s_add_u32 m0, s84, 90112
s_add_u32 s94, s82, 5120
v_mfma_f32_16x16x32_bf16 v[232:235], v[56:59], v[72:75], v[232:235]
buffer_load_dwordx4 v1, s[20:23], s94 offen sc1 lds
v_mfma_f32_16x16x32_bf16 v[236:239], v[56:59], v[76:79], v[236:239]
v_mfma_f32_16x16x32_bf16 v[240:243], v[60:63], v[64:67], v[240:243]
s_add_u32 m0, s83, 90112
s_add_u32 s95, s81, 1253376
v_mfma_f32_16x16x32_bf16 v[244:247], v[60:63], v[68:71], v[244:247]
buffer_load_dwordx4 v2, s[8:11], s95 offen  lds
v_mfma_f32_16x16x32_bf16 v[248:251], v[60:63], v[72:75], v[248:251]
v_mfma_f32_16x16x32_bf16 v[252:255], v[60:63], v[76:79], v[252:255]
s_add_u32 m0, s83, 91136
s_waitcnt lgkmcnt(4)
v_mfma_f32_16x16x32_bf16 v[128:131], v[32:35], v[80:83], v[128:131]
buffer_load_dwordx4 v3, s[8:11], s95 offen  lds
v_mfma_f32_16x16x32_bf16 v[132:135], v[32:35], v[84:87], v[132:135]
ds_read_b64_tr_b16 v[44:45], v14 offset:18464
v_mfma_f32_16x16x32_bf16 v[136:139], v[32:35], v[88:91], v[136:139]
s_add_u32 m0, s83, 108544
v_mfma_f32_16x16x32_bf16 v[140:143], v[32:35], v[92:95], v[140:143]
buffer_load_dwordx4 v2, s[12:15], s95 offen  lds
ds_read_b64_tr_b16 v[46:47], v14 offset:20768
s_waitcnt lgkmcnt(4)
v_mfma_f32_16x16x32_bf16 v[144:147], v[36:39], v[80:83], v[144:147]
v_mfma_f32_16x16x32_bf16 v[148:151], v[36:39], v[84:87], v[148:151]
s_add_u32 m0, s83, 109568
ds_read_b64_tr_b16 v[48:49], v11 offset:64
v_mfma_f32_16x16x32_bf16 v[152:155], v[36:39], v[88:91], v[152:155]
buffer_load_dwordx4 v3, s[12:15], s95 offen  lds
v_mfma_f32_16x16x32_bf16 v[156:159], v[36:39], v[92:95], v[156:159]
ds_read_b64_tr_b16 v[50:51], v11 offset:2368
s_waitcnt lgkmcnt(4)
v_mfma_f32_16x16x32_bf16 v[160:163], v[40:43], v[80:83], v[160:163]
s_add_u32 m0, s85, 90112
v_mfma_f32_16x16x32_bf16 v[164:167], v[40:43], v[84:87], v[164:167]
buffer_load_dwordx4 v4, s[32:35], s95 offen  lds
ds_read_b64_tr_b16 v[52:53], v11 offset:18496
v_mfma_f32_16x16x32_bf16 v[168:171], v[40:43], v[88:91], v[168:171]
v_mfma_f32_16x16x32_bf16 v[172:175], v[40:43], v[92:95], v[172:175]
s_mov_b32 s94, 1843200
ds_read_b64_tr_b16 v[54:55], v11 offset:20800
s_waitcnt lgkmcnt(4)
v_mfma_f32_16x16x32_bf16 v[176:179], v[44:47], v[80:83], v[176:179]
buffer_load_dword v28, v31, s[44:47], s94 offen
v_mfma_f32_16x16x32_bf16 v[180:183], v[44:47], v[84:87], v[180:183]
ds_read_b64_tr_b16 v[56:57], v14 offset:96
v_mfma_f32_16x16x32_bf16 v[184:187], v[44:47], v[88:91], v[184:187]
v_mfma_f32_16x16x32_bf16 v[188:191], v[44:47], v[92:95], v[188:191]
ds_read_b64_tr_b16 v[58:59], v14 offset:2400
s_waitcnt lgkmcnt(4)
v_mfma_f32_16x16x32_bf16 v[192:195], v[48:51], v[80:83], v[192:195]
v_mfma_f32_16x16x32_bf16 v[196:199], v[48:51], v[84:87], v[196:199]
ds_read_b64_tr_b16 v[60:61], v14 offset:18528
v_mfma_f32_16x16x32_bf16 v[200:203], v[48:51], v[88:91], v[200:203]
v_mfma_f32_16x16x32_bf16 v[204:207], v[48:51], v[92:95], v[204:207]
ds_read_b64_tr_b16 v[62:63], v14 offset:20832
s_waitcnt lgkmcnt(4)
v_mfma_f32_16x16x32_bf16 v[208:211], v[52:55], v[80:83], v[208:211]
v_mfma_f32_16x16x32_bf16 v[212:215], v[52:55], v[84:87], v[212:215]
v_mfma_f32_16x16x32_bf16 v[216:219], v[52:55], v[88:91], v[216:219]
v_mfma_f32_16x16x32_bf16 v[220:223], v[52:55], v[92:95], v[220:223]
s_waitcnt lgkmcnt(0)
s_waitcnt vmcnt(8)
s_barrier
ds_read_b128 v[64:67], v9 offset:0
ds_read_b128 v[68:71], v9 offset:1024
ds_read_b128 v[72:75], v9 offset:2048
ds_read_b128 v[76:79], v9 offset:3072
ds_read_b64_tr_b16 v[32:33], v12 offset:0
ds_read_b64_tr_b16 v[34:35], v12 offset:2304
ds_read_b64_tr_b16 v[36:37], v12 offset:18432
ds_read_b64_tr_b16 v[38:39], v12 offset:20736
ds_read_b64_tr_b16 v[40:41], v15 offset:32
ds_read_b64_tr_b16 v[42:43], v15 offset:2336
v_mfma_f32_16x16x32_bf16 v[224:227], v[56:59], v[80:83], v[224:227]
v_mfma_f32_16x16x32_bf16 v[228:231], v[56:59], v[84:87], v[228:231]
s_add_u32 m0, s84, 0
s_add_u32 s94, s82, 6144
v_mfma_f32_16x16x32_bf16 v[232:235], v[56:59], v[88:91], v[232:235]
buffer_load_dwordx4 v1, s[20:23], s94 offen sc1 lds
v_mfma_f32_16x16x32_bf16 v[236:239], v[56:59], v[92:95], v[236:239]
v_mfma_f32_16x16x32_bf16 v[240:243], v[60:63], v[80:83], v[240:243]
s_add_u32 m0, s83, 0
s_add_u32 s95, s81, 1769472
v_mfma_f32_16x16x32_bf16 v[244:247], v[60:63], v[84:87], v[244:247]
buffer_load_dwordx4 v2, s[8:11], s95 offen  lds
v_mfma_f32_16x16x32_bf16 v[248:251], v[60:63], v[88:91], v[248:251]
v_mfma_f32_16x16x32_bf16 v[252:255], v[60:63], v[92:95], v[252:255]
s_add_u32 m0, s83, 1024
s_waitcnt lgkmcnt(4)
v_mfma_f32_16x16x32_bf16 v[128:131], v[32:35], v[64:67], v[128:131]
buffer_load_dwordx4 v3, s[8:11], s95 offen  lds
v_mfma_f32_16x16x32_bf16 v[132:135], v[32:35], v[68:71], v[132:135]
ds_read_b64_tr_b16 v[44:45], v15 offset:18464
v_mfma_f32_16x16x32_bf16 v[136:139], v[32:35], v[72:75], v[136:139]
s_add_u32 m0, s83, 18432
v_mfma_f32_16x16x32_bf16 v[140:143], v[32:35], v[76:79], v[140:143]
buffer_load_dwordx4 v2, s[12:15], s95 offen  lds
ds_read_b64_tr_b16 v[46:47], v15 offset:20768
s_waitcnt lgkmcnt(4)
v_mfma_f32_16x16x32_bf16 v[144:147], v[36:39], v[64:67], v[144:147]
v_mfma_f32_16x16x32_bf16 v[148:151], v[36:39], v[68:71], v[148:151]
s_add_u32 m0, s83, 19456
ds_read_b64_tr_b16 v[48:49], v12 offset:64
v_mfma_f32_16x16x32_bf16 v[152:155], v[36:39], v[72:75], v[152:155]
buffer_load_dwordx4 v3, s[12:15], s95 offen  lds
v_mfma_f32_16x16x32_bf16 v[156:159], v[36:39], v[76:79], v[156:159]
ds_read_b64_tr_b16 v[50:51], v12 offset:2368
s_waitcnt lgkmcnt(4)
v_mfma_f32_16x16x32_bf16 v[160:163], v[40:43], v[64:67], v[160:163]
s_add_u32 m0, s85, 0
v_mfma_f32_16x16x32_bf16 v[164:167], v[40:43], v[68:71], v[164:167]
buffer_load_dwordx4 v4, s[32:35], s95 offen  lds
ds_read_b64_tr_b16 v[52:53], v12 offset:18496
v_mfma_f32_16x16x32_bf16 v[168:171], v[40:43], v[72:75], v[168:171]
v_mfma_f32_16x16x32_bf16 v[172:175], v[40:43], v[76:79], v[172:175]
s_mov_b32 s94, 2359296
ds_read_b64_tr_b16 v[54:55], v12 offset:20800
s_waitcnt lgkmcnt(4)
v_mfma_f32_16x16x32_bf16 v[176:179], v[44:47], v[64:67], v[176:179]
buffer_load_dword v28, v31, s[44:47], s94 offen
v_mfma_f32_16x16x32_bf16 v[180:183], v[44:47], v[68:71], v[180:183]
ds_read_b64_tr_b16 v[56:57], v15 offset:96
v_mfma_f32_16x16x32_bf16 v[184:187], v[44:47], v[72:75], v[184:187]
v_mfma_f32_16x16x32_bf16 v[188:191], v[44:47], v[76:79], v[188:191]
ds_read_b64_tr_b16 v[58:59], v15 offset:2400
s_waitcnt lgkmcnt(4)
v_mfma_f32_16x16x32_bf16 v[192:195], v[48:51], v[64:67], v[192:195]
v_mfma_f32_16x16x32_bf16 v[196:199], v[48:51], v[68:71], v[196:199]
ds_read_b64_tr_b16 v[60:61], v15 offset:18528
v_mfma_f32_16x16x32_bf16 v[200:203], v[48:51], v[72:75], v[200:203]
v_mfma_f32_16x16x32_bf16 v[204:207], v[48:51], v[76:79], v[204:207]
ds_read_b64_tr_b16 v[62:63], v15 offset:20832
s_waitcnt lgkmcnt(4)
v_mfma_f32_16x16x32_bf16 v[208:211], v[52:55], v[64:67], v[208:211]
v_mfma_f32_16x16x32_bf16 v[212:215], v[52:55], v[68:71], v[212:215]
v_mfma_f32_16x16x32_bf16 v[216:219], v[52:55], v[72:75], v[216:219]
v_mfma_f32_16x16x32_bf16 v[220:223], v[52:55], v[76:79], v[220:223]
s_waitcnt lgkmcnt(0)
s_waitcnt vmcnt(8)
s_barrier
ds_read_b128 v[80:83], v10 offset:0
ds_read_b128 v[84:87], v10 offset:1024
ds_read_b128 v[88:91], v10 offset:2048
ds_read_b128 v[92:95], v10 offset:3072
ds_read_b64_tr_b16 v[32:33], v13 offset:0
ds_read_b64_tr_b16 v[34:35], v13 offset:2304
ds_read_b64_tr_b16 v[36:37], v13 offset:18432
ds_read_b64_tr_b16 v[38:39], v13 offset:20736
ds_read_b64_tr_b16 v[40:41], v16 offset:32
ds_read_b64_tr_b16 v[42:43], v16 offset:2336
v_mfma_f32_16x16x32_bf16 v[224:227], v[56:59], v[64:67], v[224:227]
v_mfma_f32_16x16x32_bf16 v[228:231], v[56:59], v[68:71], v[228:231]
s_add_u32 m0, s84, 45056
s_add_u32 s94, s82, 7168
v_mfma_f32_16x16x32_bf16 v[232:235], v[56:59], v[72:75], v[232:235]
buffer_load_dwordx4 v1, s[20:23], s94 offen sc1 lds
v_mfma_f32_16x16x32_bf16 v[236:239], v[56:59], v[76:79], v[236:239]
v_mfma_f32_16x16x32_bf16 v[240:243], v[60:63], v[64:67], v[240:243]
s_add_u32 m0, s83, 45056
s_add_u32 s95, s81, 1843200
v_mfma_f32_16x16x32_bf16 v[244:247], v[60:63], v[68:71], v[244:247]
buffer_load_dwordx4 v2, s[8:11], s95 offen  lds
v_mfma_f32_16x16x32_bf16 v[248:251], v[60:63], v[72:75], v[248:251]
v_mfma_f32_16x16x32_bf16 v[252:255], v[60:63], v[76:79], v[252:255]
s_add_u32 m0, s83, 46080
s_waitcnt lgkmcnt(4)
v_mfma_f32_16x16x32_bf16 v[128:131], v[32:35], v[80:83], v[128:131]
buffer_load_dwordx4 v3, s[8:11], s95 offen  lds
v_mfma_f32_16x16x32_bf16 v[132:135], v[32:35], v[84:87], v[132:135]
ds_read_b64_tr_b16 v[44:45], v16 offset:18464
v_mfma_f32_16x16x32_bf16 v[136:139], v[32:35], v[88:91], v[136:139]
s_add_u32 m0, s83, 63488
v_mfma_f32_16x16x32_bf16 v[140:143], v[32:35], v[92:95], v[140:143]
buffer_load_dwordx4 v2, s[12:15], s95 offen  lds
ds_read_b64_tr_b16 v[46:47], v16 offset:20768
s_waitcnt lgkmcnt(4)
v_mfma_f32_16x16x32_bf16 v[144:147], v[36:39], v[80:83], v[144:147]
v_mfma_f32_16x16x32_bf16 v[148:151], v[36:39], v[84:87], v[148:151]
s_add_u32 m0, s83, 64512
ds_read_b64_tr_b16 v[48:49], v13 offset:64
v_mfma_f32_16x16x32_bf16 v[152:155], v[36:39], v[88:91], v[152:155]
buffer_load_dwordx4 v3, s[12:15], s95 offen  lds
v_mfma_f32_16x16x32_bf16 v[156:159], v[36:39], v[92:95], v[156:159]
ds_read_b64_tr_b16 v[50:51], v13 offset:2368
s_waitcnt lgkmcnt(4)
v_mfma_f32_16x16x32_bf16 v[160:163], v[40:43], v[80:83], v[160:163]
s_add_u32 m0, s85, 45056
v_mfma_f32_16x16x32_bf16 v[164:167], v[40:43], v[84:87], v[164:167]
buffer_load_dwordx4 v4, s[32:35], s95 offen  lds
ds_read_b64_tr_b16 v[52:53], v13 offset:18496
v_mfma_f32_16x16x32_bf16 v[168:171], v[40:43], v[88:91], v[168:171]
v_mfma_f32_16x16x32_bf16 v[172:175], v[40:43], v[92:95], v[172:175]
s_mov_b32 s94, 2433024
ds_read_b64_tr_b16 v[54:55], v13 offset:20800
s_waitcnt lgkmcnt(4)
v_mfma_f32_16x16x32_bf16 v[176:179], v[44:47], v[80:83], v[176:179]
buffer_load_dword v28, v31, s[44:47], s94 offen
v_mfma_f32_16x16x32_bf16 v[180:183], v[44:47], v[84:87], v[180:183]
ds_read_b64_tr_b16 v[56:57], v16 offset:96
v_mfma_f32_16x16x32_bf16 v[184:187], v[44:47], v[88:91], v[184:187]
v_mfma_f32_16x16x32_bf16 v[188:191], v[44:47], v[92:95], v[188:191]
ds_read_b64_tr_b16 v[58:59], v16 offset:2400
s_waitcnt lgkmcnt(4)
v_mfma_f32_16x16x32_bf16 v[192:195], v[48:51], v[80:83], v[192:195]
v_mfma_f32_16x16x32_bf16 v[196:199], v[48:51], v[84:87], v[196:199]
ds_read_b64_tr_b16 v[60:61], v16 offset:18528
v_mfma_f32_16x16x32_bf16 v[200:203], v[48:51], v[88:91], v[200:203]
v_mfma_f32_16x16x32_bf16 v[204:207], v[48:51], v[92:95], v[204:207]
ds_read_b64_tr_b16 v[62:63], v16 offset:20832
s_waitcnt lgkmcnt(4)
v_mfma_f32_16x16x32_bf16 v[208:211], v[52:55], v[80:83], v[208:211]
v_mfma_f32_16x16x32_bf16 v[212:215], v[52:55], v[84:87], v[212:215]
v_mfma_f32_16x16x32_bf16 v[216:219], v[52:55], v[88:91], v[216:219]
v_mfma_f32_16x16x32_bf16 v[220:223], v[52:55], v[92:95], v[220:223]
s_waitcnt lgkmcnt(0)
s_waitcnt vmcnt(8)
s_barrier
ds_read_b128 v[64:67], v8 offset:0
ds_read_b128 v[68:71], v8 offset:1024
ds_read_b128 v[72:75], v8 offset:2048
ds_read_b128 v[76:79], v8 offset:3072
ds_read_b64_tr_b16 v[32:33], v11 offset:0
ds_read_b64_tr_b16 v[34:35], v11 offset:2304
ds_read_b64_tr_b16 v[36:37], v11 offset:18432
ds_read_b64_tr_b16 v[38:39], v11 offset:20736
ds_read_b64_tr_b16 v[40:41], v14 offset:32
ds_read_b64_tr_b16 v[42:43], v14 offset:2336
v_mfma_f32_16x16x32_bf16 v[224:227], v[56:59], v[80:83], v[224:227]
v_mfma_f32_16x16x32_bf16 v[228:231], v[56:59], v[84:87], v[228:231]
s_add_u32 m0, s84, 90112
s_add_u32 s94, s82, 8192
v_mfma_f32_16x16x32_bf16 v[232:235], v[56:59], v[88:91], v[232:235]
buffer_load_dwordx4 v1, s[20:23], s94 offen sc1 lds
v_mfma_f32_16x16x32_bf16 v[236:239], v[56:59], v[92:95], v[236:239]
v_mfma_f32_16x16x32_bf16 v[240:243], v[60:63], v[80:83], v[240:243]
s_add_u32 m0, s83, 90112
s_add_u32 s95, s81, 2359296
v_mfma_f32_16x16x32_bf16 v[244:247], v[60:63], v[84:87], v[244:247]
buffer_load_dwordx4 v2, s[8:11], s95 offen  lds
v_mfma_f32_16x16x32_bf16 v[248:251], v[60:63], v[88:91], v[248:251]
v_mfma_f32_16x16x32_bf16 v[252:255], v[60:63], v[92:95], v[252:255]
s_add_u32 m0, s83, 91136
s_waitcnt lgkmcnt(4)
v_mfma_f32_16x16x32_bf16 v[128:131], v[32:35], v[64:67], v[128:131]
buffer_load_dwordx4 v3, s[8:11], s95 offen  lds
v_mfma_f32_16x16x32_bf16 v[132:135], v[32:35], v[68:71], v[132:135]
ds_read_b64_tr_b16 v[44:45], v14 offset:18464
v_mfma_f32_16x16x32_bf16 v[136:139], v[32:35], v[72:75], v[136:139]
s_add_u32 m0, s83, 108544
v_mfma_f32_16x16x32_bf16 v[140:143], v[32:35], v[76:79], v[140:143]
buffer_load_dwordx4 v2, s[12:15], s95 offen  lds
ds_read_b64_tr_b16 v[46:47], v14 offset:20768
s_waitcnt lgkmcnt(4)
v_mfma_f32_16x16x32_bf16 v[144:147], v[36:39], v[64:67], v[144:147]
v_mfma_f32_16x16x32_bf16 v[148:151], v[36:39], v[68:71], v[148:151]
s_add_u32 m0, s83, 109568
ds_read_b64_tr_b16 v[48:49], v11 offset:64
v_mfma_f32_16x16x32_bf16 v[152:155], v[36:39], v[72:75], v[152:155]
buffer_load_dwordx4 v3, s[12:15], s95 offen  lds
v_mfma_f32_16x16x32_bf16 v[156:159], v[36:39], v[76:79], v[156:159]
ds_read_b64_tr_b16 v[50:51], v11 offset:2368
s_waitcnt lgkmcnt(4)
v_mfma_f32_16x16x32_bf16 v[160:163], v[40:43], v[64:67], v[160:163]
s_add_u32 m0, s85, 90112
v_mfma_f32_16x16x32_bf16 v[164:167], v[40:43], v[68:71], v[164:167]
buffer_load_dwordx4 v4, s[32:35], s95 offen  lds
ds_read_b64_tr_b16 v[52:53], v11 offset:18496
v_mfma_f32_16x16x32_bf16 v[168:171], v[40:43], v[72:75], v[168:171]
v_mfma_f32_16x16x32_bf16 v[172:175], v[40:43], v[76:79], v[172:175]
s_mov_b32 s94, 2949120
ds_read_b64_tr_b16 v[54:55], v11 offset:20800
s_waitcnt lgkmcnt(4)
v_mfma_f32_16x16x32_bf16 v[176:179], v[44:47], v[64:67], v[176:179]
buffer_load_dword v28, v31, s[44:47], s94 offen
v_mfma_f32_16x16x32_bf16 v[180:183], v[44:47], v[68:71], v[180:183]
ds_read_b64_tr_b16 v[56:57], v14 offset:96
v_mfma_f32_16x16x32_bf16 v[184:187], v[44:47], v[72:75], v[184:187]
v_mfma_f32_16x16x32_bf16 v[188:191], v[44:47], v[76:79], v[188:191]
ds_read_b64_tr_b16 v[58:59], v14 offset:2400
s_waitcnt lgkmcnt(4)
v_mfma_f32_16x16x32_bf16 v[192:195], v[48:51], v[64:67], v[192:195]
v_mfma_f32_16x16x32_bf16 v[196:199], v[48:51], v[68:71], v[196:199]
ds_read_b64_tr_b16 v[60:61], v14 offset:18528
v_mfma_f32_16x16x32_bf16 v[200:203], v[48:51], v[72:75], v[200:203]
v_mfma_f32_16x16x32_bf16 v[204:207], v[48:51], v[76:79], v[204:207]
ds_read_b64_tr_b16 v[62:63], v14 offset:20832
s_waitcnt lgkmcnt(4)
v_mfma_f32_16x16x32_bf16 v[208:211], v[52:55], v[64:67], v[208:211]
v_mfma_f32_16x16x32_bf16 v[212:215], v[52:55], v[68:71], v[212:215]
v_mfma_f32_16x16x32_bf16 v[216:219], v[52:55], v[72:75], v[216:219]
v_mfma_f32_16x16x32_bf16 v[220:223], v[52:55], v[76:79], v[220:223]
s_waitcnt lgkmcnt(0)
s_waitcnt vmcnt(8)
s_barrier
ds_read_b128 v[80:83], v9 offset:0
ds_read_b128 v[84:87], v9 offset:1024
ds_read_b128 v[88:91], v9 offset:2048
ds_read_b128 v[92:95], v9 offset:3072
ds_read_b64_tr_b16 v[32:33], v12 offset:0
ds_read_b64_tr_b16 v[34:35], v12 offset:2304
ds_read_b64_tr_b16 v[36:37], v12 offset:18432
ds_read_b64_tr_b16 v[38:39], v12 offset:20736
ds_read_b64_tr_b16 v[40:41], v15 offset:32
ds_read_b64_tr_b16 v[42:43], v15 offset:2336
v_mfma_f32_16x16x32_bf16 v[224:227], v[56:59], v[64:67], v[224:227]
v_mfma_f32_16x16x32_bf16 v[228:231], v[56:59], v[68:71], v[228:231]
s_add_u32 m0, s84, 0
s_add_u32 s94, s82, 9216
v_mfma_f32_16x16x32_bf16 v[232:235], v[56:59], v[72:75], v[232:235]
buffer_load_dwordx4 v1, s[20:23], s94 offen sc1 lds
v_mfma_f32_16x16x32_bf16 v[236:239], v[56:59], v[76:79], v[236:239]
v_mfma_f32_16x16x32_bf16 v[240:243], v[60:63], v[64:67], v[240:243]
s_add_u32 m0, s83, 0
s_add_u32 s95, s81, 2433024
v_mfma_f32_16x16x32_bf16 v[244:247], v[60:63], v[68:71], v[244:247]
buffer_load_dwordx4 v2, s[8:11], s95 offen  lds
v_mfma_f32_16x16x32_bf16 v[248:251], v[60:63], v[72:75], v[248:251]
v_mfma_f32_16x16x32_bf16 v[252:255], v[60:63], v[76:79], v[252:255]
s_add_u32 m0, s83, 1024
s_waitcnt lgkmcnt(4)
v_mfma_f32_16x16x32_bf16 v[128:131], v[32:35], v[80:83], v[128:131]
buffer_load_dwordx4 v3, s[8:11], s95 offen  lds
v_mfma_f32_16x16x32_bf16 v[132:135], v[32:35], v[84:87], v[132:135]
ds_read_b64_tr_b16 v[44:45], v15 offset:18464
v_mfma_f32_16x16x32_bf16 v[136:139], v[32:35], v[88:91], v[136:139]
s_add_u32 m0, s83, 18432
v_mfma_f32_16x16x32_bf16 v[140:143], v[32:35], v[92:95], v[140:143]
buffer_load_dwordx4 v2, s[12:15], s95 offen  lds
ds_read_b64_tr_b16 v[46:47], v15 offset:20768
s_waitcnt lgkmcnt(4)
v_mfma_f32_16x16x32_bf16 v[144:147], v[36:39], v[80:83], v[144:147]
v_mfma_f32_16x16x32_bf16 v[148:151], v[36:39], v[84:87], v[148:151]
s_add_u32 m0, s83, 19456
ds_read_b64_tr_b16 v[48:49], v12 offset:64
v_mfma_f32_16x16x32_bf16 v[152:155], v[36:39], v[88:91], v[152:155]
buffer_load_dwordx4 v3, s[12:15], s95 offen  lds
v_mfma_f32_16x16x32_bf16 v[156:159], v[36:39], v[92:95], v[156:159]
ds_read_b64_tr_b16 v[50:51], v12 offset:2368
s_waitcnt lgkmcnt(4)
v_mfma_f32_16x16x32_bf16 v[160:163], v[40:43], v[80:83], v[160:163]
s_add_u32 m0, s85, 0
v_mfma_f32_16x16x32_bf16 v[164:167], v[40:43], v[84:87], v[164:167]
buffer_load_dwordx4 v4, s[32:35], s95 offen  lds
ds_read_b64_tr_b16 v[52:53], v12 offset:18496
v_mfma_f32_16x16x32_bf16 v[168:171], v[40:43], v[88:91], v[168:171]
v_mfma_f32_16x16x32_bf16 v[172:175], v[40:43], v[92:95], v[172:175]
s_mov_b32 s94, 3022848
ds_read_b64_tr_b16 v[54:55], v12 offset:20800
s_waitcnt lgkmcnt(4)
v_mfma_f32_16x16x32_bf16 v[176:179], v[44:47], v[80:83], v[176:179]
buffer_load_dword v28, v31, s[44:47], s94 offen
v_mfma_f32_16x16x32_bf16 v[180:183], v[44:47], v[84:87], v[180:183]
ds_read_b64_tr_b16 v[56:57], v15 offset:96
v_mfma_f32_16x16x32_bf16 v[184:187], v[44:47], v[88:91], v[184:187]
v_mfma_f32_16x16x32_bf16 v[188:191], v[44:47], v[92:95], v[188:191]
ds_read_b64_tr_b16 v[58:59], v15 offset:2400
s_waitcnt lgkmcnt(4)
v_mfma_f32_16x16x32_bf16 v[192:195], v[48:51], v[80:83], v[192:195]
v_mfma_f32_16x16x32_bf16 v[196:199], v[48:51], v[84:87], v[196:199]
ds_read_b64_tr_b16 v[60:61], v15 offset:18528
v_mfma_f32_16x16x32_bf16 v[200:203], v[48:51], v[88:91], v[200:203]
v_mfma_f32_16x16x32_bf16 v[204:207], v[48:51], v[92:95], v[204:207]
ds_read_b64_tr_b16 v[62:63], v15 offset:20832
s_waitcnt lgkmcnt(4)
v_mfma_f32_16x16x32_bf16 v[208:211], v[52:55], v[80:83], v[208:211]
v_mfma_f32_16x16x32_bf16 v[212:215], v[52:55], v[84:87], v[212:215]
v_mfma_f32_16x16x32_bf16 v[216:219], v[52:55], v[88:91], v[216:219]
v_mfma_f32_16x16x32_bf16 v[220:223], v[52:55], v[92:95], v[220:223]
s_waitcnt lgkmcnt(0)
s_waitcnt vmcnt(8)
s_barrier
ds_read_b128 v[64:67], v10 offset:0
ds_read_b128 v[68:71], v10 offset:1024
ds_read_b128 v[72:75], v10 offset:2048
ds_read_b128 v[76:79], v10 offset:3072
ds_read_b64_tr_b16 v[32:33], v13 offset:0
ds_read_b64_tr_b16 v[34:35], v13 offset:2304
ds_read_b64_tr_b16 v[36:37], v13 offset:18432
ds_read_b64_tr_b16 v[38:39], v13 offset:20736
ds_read_b64_tr_b16 v[40:41], v16 offset:32
ds_read_b64_tr_b16 v[42:43], v16 offset:2336
v_mfma_f32_16x16x32_bf16 v[224:227], v[56:59], v[80:83], v[224:227]
v_mfma_f32_16x16x32_bf16 v[228:231], v[56:59], v[84:87], v[228:231]
s_add_u32 m0, s84, 45056
s_add_u32 s94, s82, 10240
v_mfma_f32_16x16x32_bf16 v[232:235], v[56:59], v[88:91], v[232:235]
buffer_load_dwordx4 v1, s[20:23], s94 offen sc1 lds
v_mfma_f32_16x16x32_bf16 v[236:239], v[56:59], v[92:95], v[236:239]
v_mfma_f32_16x16x32_bf16 v[240:243], v[60:63], v[80:83], v[240:243]
s_add_u32 m0, s83, 45056
s_add_u32 s95, s81, 2949120
v_mfma_f32_16x16x32_bf16 v[244:247], v[60:63], v[84:87], v[244:247]
buffer_load_dwordx4 v2, s[8:11], s95 offen  lds
v_mfma_f32_16x16x32_bf16 v[248:251], v[60:63], v[88:91], v[248:251]
v_mfma_f32_16x16x32_bf16 v[252:255], v[60:63], v[92:95], v[252:255]
s_add_u32 m0, s83, 46080
s_waitcnt lgkmcnt(4)
v_mfma_f32_16x16x32_bf16 v[128:131], v[32:35], v[64:67], v[128:131]
buffer_load_dwordx4 v3, s[8:11], s95 offen  lds
v_mfma_f32_16x16x32_bf16 v[132:135], v[32:35], v[68:71], v[132:135]
ds_read_b64_tr_b16 v[44:45], v16 offset:18464
v_mfma_f32_16x16x32_bf16 v[136:139], v[32:35], v[72:75], v[136:139]
s_add_u32 m0, s83, 63488
v_mfma_f32_16x16x32_bf16 v[140:143], v[32:35], v[76:79], v[140:143]
buffer_load_dwordx4 v2, s[12:15], s95 offen  lds
ds_read_b64_tr_b16 v[46:47], v16 offset:20768
s_waitcnt lgkmcnt(4)
v_mfma_f32_16x16x32_bf16 v[144:147], v[36:39], v[64:67], v[144:147]
v_mfma_f32_16x16x32_bf16 v[148:151], v[36:39], v[68:71], v[148:151]
s_add_u32 m0, s83, 64512
ds_read_b64_tr_b16 v[48:49], v13 offset:64
v_mfma_f32_16x16x32_bf16 v[152:155], v[36:39], v[72:75], v[152:155]
buffer_load_dwordx4 v3, s[12:15], s95 offen  lds
v_mfma_f32_16x16x32_bf16 v[156:159], v[36:39], v[76:79], v[156:159]
ds_read_b64_tr_b16 v[50:51], v13 offset:2368
s_waitcnt lgkmcnt(4)
v_mfma_f32_16x16x32_bf16 v[160:163], v[40:43], v[64:67], v[160:163]
s_add_u32 m0, s85, 45056
v_mfma_f32_16x16x32_bf16 v[164:167], v[40:43], v[68:71], v[164:167]
buffer_load_dwordx4 v4, s[32:35], s95 offen  lds
ds_read_b64_tr_b16 v[52:53], v13 offset:18496
v_mfma_f32_16x16x32_bf16 v[168:171], v[40:43], v[72:75], v[168:171]
v_mfma_f32_16x16x32_bf16 v[172:175], v[40:43], v[76:79], v[172:175]
s_mov_b32 s94, 3538944
ds_read_b64_tr_b16 v[54:55], v13 offset:20800
s_waitcnt lgkmcnt(4)
v_mfma_f32_16x16x32_bf16 v[176:179], v[44:47], v[64:67], v[176:179]
buffer_load_dword v28, v31, s[44:47], s94 offen
v_mfma_f32_16x16x32_bf16 v[180:183], v[44:47], v[68:71], v[180:183]
ds_read_b64_tr_b16 v[56:57], v16 offset:96
v_mfma_f32_16x16x32_bf16 v[184:187], v[44:47], v[72:75], v[184:187]
v_mfma_f32_16x16x32_bf16 v[188:191], v[44:47], v[76:79], v[188:191]
ds_read_b64_tr_b16 v[58:59], v16 offset:2400
s_waitcnt lgkmcnt(4)
v_mfma_f32_16x16x32_bf16 v[192:195], v[48:51], v[64:67], v[192:195]
v_mfma_f32_16x16x32_bf16 v[196:199], v[48:51], v[68:71], v[196:199]
ds_read_b64_tr_b16 v[60:61], v16 offset:18528
v_mfma_f32_16x16x32_bf16 v[200:203], v[48:51], v[72:75], v[200:203]
v_mfma_f32_16x16x32_bf16 v[204:207], v[48:51], v[76:79], v[204:207]
ds_read_b64_tr_b16 v[62:63], v16 offset:20832
s_waitcnt lgkmcnt(4)
v_mfma_f32_16x16x32_bf16 v[208:211], v[52:55], v[64:67], v[208:211]
v_mfma_f32_16x16x32_bf16 v[212:215], v[52:55], v[68:71], v[212:215]
v_mfma_f32_16x16x32_bf16 v[216:219], v[52:55], v[72:75], v[216:219]
v_mfma_f32_16x16x32_bf16 v[220:223], v[52:55], v[76:79], v[220:223]
s_waitcnt lgkmcnt(0)
s_waitcnt vmcnt(8)
s_barrier
ds_read_b128 v[80:83], v8 offset:0
ds_read_b128 v[84:87], v8 offset:1024
ds_read_b128 v[88:91], v8 offset:2048
ds_read_b128 v[92:95], v8 offset:3072
ds_read_b64_tr_b16 v[32:33], v11 offset:0
ds_read_b64_tr_b16 v[34:35], v11 offset:2304
ds_read_b64_tr_b16 v[36:37], v11 offset:18432
ds_read_b64_tr_b16 v[38:39], v11 offset:20736
ds_read_b64_tr_b16 v[40:41], v14 offset:32
ds_read_b64_tr_b16 v[42:43], v14 offset:2336
v_mfma_f32_16x16x32_bf16 v[224:227], v[56:59], v[64:67], v[224:227]
v_mfma_f32_16x16x32_bf16 v[228:231], v[56:59], v[68:71], v[228:231]
s_add_u32 m0, s84, 90112
s_add_u32 s94, s82, 11264
v_mfma_f32_16x16x32_bf16 v[232:235], v[56:59], v[72:75], v[232:235]
buffer_load_dwordx4 v1, s[20:23], s94 offen sc1 lds
v_mfma_f32_16x16x32_bf16 v[236:239], v[56:59], v[76:79], v[236:239]
v_mfma_f32_16x16x32_bf16 v[240:243], v[60:63], v[64:67], v[240:243]
s_add_u32 m0, s83, 90112
s_add_u32 s95, s81, 3022848
v_mfma_f32_16x16x32_bf16 v[244:247], v[60:63], v[68:71], v[244:247]
buffer_load_dwordx4 v2, s[8:11], s95 offen  lds
v_mfma_f32_16x16x32_bf16 v[248:251], v[60:63], v[72:75], v[248:251]
v_mfma_f32_16x16x32_bf16 v[252:255], v[60:63], v[76:79], v[252:255]
s_add_u32 m0, s83, 91136
s_waitcnt lgkmcnt(4)
v_mfma_f32_16x16x32_bf16 v[128:131], v[32:35], v[80:83], v[128:131]
buffer_load_dwordx4 v3, s[8:11], s95 offen  lds
v_mfma_f32_16x16x32_bf16 v[132:135], v[32:35], v[84:87], v[132:135]
ds_read_b64_tr_b16 v[44:45], v14 offset:18464
v_mfma_f32_16x16x32_bf16 v[136:139], v[32:35], v[88:91], v[136:139]
s_add_u32 m0, s83, 108544
v_mfma_f32_16x16x32_bf16 v[140:143], v[32:35], v[92:95], v[140:143]
buffer_load_dwordx4 v2, s[12:15], s95 offen  lds
ds_read_b64_tr_b16 v[46:47], v14 offset:20768
s_waitcnt lgkmcnt(4)
v_mfma_f32_16x16x32_bf16 v[144:147], v[36:39], v[80:83], v[144:147]
v_mfma_f32_16x16x32_bf16 v[148:151], v[36:39], v[84:87], v[148:151]
s_add_u32 m0, s83, 109568
ds_read_b64_tr_b16 v[48:49], v11 offset:64
v_mfma_f32_16x16x32_bf16 v[152:155], v[36:39], v[88:91], v[152:155]
buffer_load_dwordx4 v3, s[12:15], s95 offen  lds
v_mfma_f32_16x16x32_bf16 v[156:159], v[36:39], v[92:95], v[156:159]
ds_read_b64_tr_b16 v[50:51], v11 offset:2368
s_waitcnt lgkmcnt(4)
v_mfma_f32_16x16x32_bf16 v[160:163], v[40:43], v[80:83], v[160:163]
s_add_u32 m0, s85, 90112
v_mfma_f32_16x16x32_bf16 v[164:167], v[40:43], v[84:87], v[164:167]
buffer_load_dwordx4 v4, s[32:35], s95 offen  lds
ds_read_b64_tr_b16 v[52:53], v11 offset:18496
v_mfma_f32_16x16x32_bf16 v[168:171], v[40:43], v[88:91], v[168:171]
v_mfma_f32_16x16x32_bf16 v[172:175], v[40:43], v[92:95], v[172:175]
s_mov_b32 s94, 3612672
ds_read_b64_tr_b16 v[54:55], v11 offset:20800
s_waitcnt lgkmcnt(4)
v_mfma_f32_16x16x32_bf16 v[176:179], v[44:47], v[80:83], v[176:179]
buffer_load_dword v28, v31, s[44:47], s94 offen
v_mfma_f32_16x16x32_bf16 v[180:183], v[44:47], v[84:87], v[180:183]
ds_read_b64_tr_b16 v[56:57], v14 offset:96
v_mfma_f32_16x16x32_bf16 v[184:187], v[44:47], v[88:91], v[184:187]
v_mfma_f32_16x16x32_bf16 v[188:191], v[44:47], v[92:95], v[188:191]
ds_read_b64_tr_b16 v[58:59], v14 offset:2400
s_waitcnt lgkmcnt(4)
v_mfma_f32_16x16x32_bf16 v[192:195], v[48:51], v[80:83], v[192:195]
v_mfma_f32_16x16x32_bf16 v[196:199], v[48:51], v[84:87], v[196:199]
ds_read_b64_tr_b16 v[60:61], v14 offset:18528
v_mfma_f32_16x16x32_bf16 v[200:203], v[48:51], v[88:91], v[200:203]
v_mfma_f32_16x16x32_bf16 v[204:207], v[48:51], v[92:95], v[204:207]
ds_read_b64_tr_b16 v[62:63], v14 offset:20832
s_waitcnt lgkmcnt(4)
v_mfma_f32_16x16x32_bf16 v[208:211], v[52:55], v[80:83], v[208:211]
v_mfma_f32_16x16x32_bf16 v[212:215], v[52:55], v[84:87], v[212:215]
v_mfma_f32_16x16x32_bf16 v[216:219], v[52:55], v[88:91], v[216:219]
v_mfma_f32_16x16x32_bf16 v[220:223], v[52:55], v[92:95], v[220:223]
s_waitcnt lgkmcnt(0)
s_waitcnt vmcnt(8)
s_barrier
ds_read_b128 v[64:67], v9 offset:0
ds_read_b128 v[68:71], v9 offset:1024
ds_read_b128 v[72:75], v9 offset:2048
ds_read_b128 v[76:79], v9 offset:3072
ds_read_b64_tr_b16 v[32:33], v12 offset:0
ds_read_b64_tr_b16 v[34:35], v12 offset:2304
ds_read_b64_tr_b16 v[36:37], v12 offset:18432
ds_read_b64_tr_b16 v[38:39], v12 offset:20736
ds_read_b64_tr_b16 v[40:41], v15 offset:32
ds_read_b64_tr_b16 v[42:43], v15 offset:2336
v_mfma_f32_16x16x32_bf16 v[224:227], v[56:59], v[80:83], v[224:227]
v_mfma_f32_16x16x32_bf16 v[228:231], v[56:59], v[84:87], v[228:231]
s_add_u32 m0, s84, 0
s_add_u32 s94, s82, 12288
v_mfma_f32_16x16x32_bf16 v[232:235], v[56:59], v[88:91], v[232:235]
buffer_load_dwordx4 v1, s[20:23], s94 offen sc1 lds
v_mfma_f32_16x16x32_bf16 v[236:239], v[56:59], v[92:95], v[236:239]
v_mfma_f32_16x16x32_bf16 v[240:243], v[60:63], v[80:83], v[240:243]
s_add_u32 m0, s83, 0
s_add_u32 s95, s81, 3538944
v_mfma_f32_16x16x32_bf16 v[244:247], v[60:63], v[84:87], v[244:247]
buffer_load_dwordx4 v2, s[8:11], s95 offen  lds
v_mfma_f32_16x16x32_bf16 v[248:251], v[60:63], v[88:91], v[248:251]
v_mfma_f32_16x16x32_bf16 v[252:255], v[60:63], v[92:95], v[252:255]
s_add_u32 m0, s83, 1024
s_waitcnt lgkmcnt(4)
v_mfma_f32_16x16x32_bf16 v[128:131], v[32:35], v[64:67], v[128:131]
buffer_load_dwordx4 v3, s[8:11], s95 offen  lds
v_mfma_f32_16x16x32_bf16 v[132:135], v[32:35], v[68:71], v[132:135]
ds_read_b64_tr_b16 v[44:45], v15 offset:18464
v_mfma_f32_16x16x32_bf16 v[136:139], v[32:35], v[72:75], v[136:139]
s_add_u32 m0, s83, 18432
v_mfma_f32_16x16x32_bf16 v[140:143], v[32:35], v[76:79], v[140:143]
buffer_load_dwordx4 v2, s[12:15], s95 offen  lds
ds_read_b64_tr_b16 v[46:47], v15 offset:20768
s_waitcnt lgkmcnt(4)
v_mfma_f32_16x16x32_bf16 v[144:147], v[36:39], v[64:67], v[144:147]
v_mfma_f32_16x16x32_bf16 v[148:151], v[36:39], v[68:71], v[148:151]
s_add_u32 m0, s83, 19456
ds_read_b64_tr_b16 v[48:49], v12 offset:64
v_mfma_f32_16x16x32_bf16 v[152:155], v[36:39], v[72:75], v[152:155]
buffer_load_dwordx4 v3, s[12:15], s95 offen  lds
v_mfma_f32_16x16x32_bf16 v[156:159], v[36:39], v[76:79], v[156:159]
ds_read_b64_tr_b16 v[50:51], v12 offset:2368
s_waitcnt lgkmcnt(4)
v_mfma_f32_16x16x32_bf16 v[160:163], v[40:43], v[64:67], v[160:163]
s_add_u32 m0, s85, 0
v_mfma_f32_16x16x32_bf16 v[164:167], v[40:43], v[68:71], v[164:167]
buffer_load_dwordx4 v4, s[32:35], s95 offen  lds
ds_read_b64_tr_b16 v[52:53], v12 offset:18496
v_mfma_f32_16x16x32_bf16 v[168:171], v[40:43], v[72:75], v[168:171]
v_mfma_f32_16x16x32_bf16 v[172:175], v[40:43], v[76:79], v[172:175]
s_mov_b32 s94, 4128768
ds_read_b64_tr_b16 v[54:55], v12 offset:20800
s_waitcnt lgkmcnt(4)
v_mfma_f32_16x16x32_bf16 v[176:179], v[44:47], v[64:67], v[176:179]
buffer_load_dword v28, v31, s[44:47], s94 offen
v_mfma_f32_16x16x32_bf16 v[180:183], v[44:47], v[68:71], v[180:183]
ds_read_b64_tr_b16 v[56:57], v15 offset:96
v_mfma_f32_16x16x32_bf16 v[184:187], v[44:47], v[72:75], v[184:187]
v_mfma_f32_16x16x32_bf16 v[188:191], v[44:47], v[76:79], v[188:191]
ds_read_b64_tr_b16 v[58:59], v15 offset:2400
s_waitcnt lgkmcnt(4)
v_mfma_f32_16x16x32_bf16 v[192:195], v[48:51], v[64:67], v[192:195]
v_mfma_f32_16x16x32_bf16 v[196:199], v[48:51], v[68:71], v[196:199]
ds_read_b64_tr_b16 v[60:61], v15 offset:18528
v_mfma_f32_16x16x32_bf16 v[200:203], v[48:51], v[72:75], v[200:203]
v_mfma_f32_16x16x32_bf16 v[204:207], v[48:51], v[76:79], v[204:207]
ds_read_b64_tr_b16 v[62:63], v15 offset:20832
s_waitcnt lgkmcnt(4)
v_mfma_f32_16x16x32_bf16 v[208:211], v[52:55], v[64:67], v[208:211]
v_mfma_f32_16x16x32_bf16 v[212:215], v[52:55], v[68:71], v[212:215]
v_mfma_f32_16x16x32_bf16 v[216:219], v[52:55], v[72:75], v[216:219]
v_mfma_f32_16x16x32_bf16 v[220:223], v[52:55], v[76:79], v[220:223]
s_waitcnt lgkmcnt(0)
s_waitcnt vmcnt(8)
s_barrier
ds_read_b128 v[80:83], v10 offset:0
ds_read_b128 v[84:87], v10 offset:1024
ds_read_b128 v[88:91], v10 offset:2048
ds_read_b128 v[92:95], v10 offset:3072
ds_read_b64_tr_b16 v[32:33], v13 offset:0
ds_read_b64_tr_b16 v[34:35], v13 offset:2304
ds_read_b64_tr_b16 v[36:37], v13 offset:18432
ds_read_b64_tr_b16 v[38:39], v13 offset:20736
ds_read_b64_tr_b16 v[40:41], v16 offset:32
ds_read_b64_tr_b16 v[42:43], v16 offset:2336
v_mfma_f32_16x16x32_bf16 v[224:227], v[56:59], v[64:67], v[224:227]
v_mfma_f32_16x16x32_bf16 v[228:231], v[56:59], v[68:71], v[228:231]
s_add_u32 m0, s84, 45056
s_add_u32 s94, s82, 13312
v_mfma_f32_16x16x32_bf16 v[232:235], v[56:59], v[72:75], v[232:235]
buffer_load_dwordx4 v1, s[20:23], s94 offen sc1 lds
v_mfma_f32_16x16x32_bf16 v[236:239], v[56:59], v[76:79], v[236:239]
v_mfma_f32_16x16x32_bf16 v[240:243], v[60:63], v[64:67], v[240:243]
s_add_u32 m0, s83, 45056
s_add_u32 s95, s81, 3612672
v_mfma_f32_16x16x32_bf16 v[244:247], v[60:63], v[68:71], v[244:247]
buffer_load_dwordx4 v2, s[8:11], s95 offen  lds
v_mfma_f32_16x16x32_bf16 v[248:251], v[60:63], v[72:75], v[248:251]
v_mfma_f32_16x16x32_bf16 v[252:255], v[60:63], v[76:79], v[252:255]
s_add_u32 m0, s83, 46080
s_waitcnt lgkmcnt(4)
v_mfma_f32_16x16x32_bf16 v[128:131], v[32:35], v[80:83], v[128:131]
buffer_load_dwordx4 v3, s[8:11], s95 offen  lds
v_mfma_f32_16x16x32_bf16 v[132:135], v[32:35], v[84:87], v[132:135]
ds_read_b64_tr_b16 v[44:45], v16 offset:18464
v_mfma_f32_16x16x32_bf16 v[136:139], v[32:35], v[88:91], v[136:139]
s_add_u32 m0, s83, 63488
v_mfma_f32_16x16x32_bf16 v[140:143], v[32:35], v[92:95], v[140:143]
buffer_load_dwordx4 v2, s[12:15], s95 offen  lds
ds_read_b64_tr_b16 v[46:47], v16 offset:20768
s_waitcnt lgkmcnt(4)
v_mfma_f32_16x16x32_bf16 v[144:147], v[36:39], v[80:83], v[144:147]
v_mfma_f32_16x16x32_bf16 v[148:151], v[36:39], v[84:87], v[148:151]
s_add_u32 m0, s83, 64512
ds_read_b64_tr_b16 v[48:49], v13 offset:64
v_mfma_f32_16x16x32_bf16 v[152:155], v[36:39], v[88:91], v[152:155]
buffer_load_dwordx4 v3, s[12:15], s95 offen  lds
v_mfma_f32_16x16x32_bf16 v[156:159], v[36:39], v[92:95], v[156:159]
ds_read_b64_tr_b16 v[50:51], v13 offset:2368
s_waitcnt lgkmcnt(4)
v_mfma_f32_16x16x32_bf16 v[160:163], v[40:43], v[80:83], v[160:163]
s_add_u32 m0, s85, 45056
v_mfma_f32_16x16x32_bf16 v[164:167], v[40:43], v[84:87], v[164:167]
buffer_load_dwordx4 v4, s[32:35], s95 offen  lds
ds_read_b64_tr_b16 v[52:53], v13 offset:18496
v_mfma_f32_16x16x32_bf16 v[168:171], v[40:43], v[88:91], v[168:171]
v_mfma_f32_16x16x32_bf16 v[172:175], v[40:43], v[92:95], v[172:175]
s_mov_b32 s94, 4202496
ds_read_b64_tr_b16 v[54:55], v13 offset:20800
s_waitcnt lgkmcnt(4)
v_mfma_f32_16x16x32_bf16 v[176:179], v[44:47], v[80:83], v[176:179]
buffer_load_dword v28, v31, s[44:47], s94 offen
v_mfma_f32_16x16x32_bf16 v[180:183], v[44:47], v[84:87], v[180:183]
ds_read_b64_tr_b16 v[56:57], v16 offset:96
v_mfma_f32_16x16x32_bf16 v[184:187], v[44:47], v[88:91], v[184:187]
v_mfma_f32_16x16x32_bf16 v[188:191], v[44:47], v[92:95], v[188:191]
ds_read_b64_tr_b16 v[58:59], v16 offset:2400
s_waitcnt lgkmcnt(4)
v_mfma_f32_16x16x32_bf16 v[192:195], v[48:51], v[80:83], v[192:195]
v_mfma_f32_16x16x32_bf16 v[196:199], v[48:51], v[84:87], v[196:199]
ds_read_b64_tr_b16 v[60:61], v16 offset:18528
v_mfma_f32_16x16x32_bf16 v[200:203], v[48:51], v[88:91], v[200:203]
v_mfma_f32_16x16x32_bf16 v[204:207], v[48:51], v[92:95], v[204:207]
ds_read_b64_tr_b16 v[62:63], v16 offset:20832
s_waitcnt lgkmcnt(4)
v_mfma_f32_16x16x32_bf16 v[208:211], v[52:55], v[80:83], v[208:211]
v_mfma_f32_16x16x32_bf16 v[212:215], v[52:55], v[84:87], v[212:215]
v_mfma_f32_16x16x32_bf16 v[216:219], v[52:55], v[88:91], v[216:219]
v_mfma_f32_16x16x32_bf16 v[220:223], v[52:55], v[92:95], v[220:223]
s_waitcnt lgkmcnt(0)
s_waitcnt vmcnt(8)
s_barrier
ds_read_b128 v[64:67], v8 offset:0
ds_read_b128 v[68:71], v8 offset:1024
ds_read_b128 v[72:75], v8 offset:2048
ds_read_b128 v[76:79], v8 offset:3072
ds_read_b64_tr_b16 v[32:33], v11 offset:0
ds_read_b64_tr_b16 v[34:35], v11 offset:2304
ds_read_b64_tr_b16 v[36:37], v11 offset:18432
ds_read_b64_tr_b16 v[38:39], v11 offset:20736
ds_read_b64_tr_b16 v[40:41], v14 offset:32
ds_read_b64_tr_b16 v[42:43], v14 offset:2336
v_mfma_f32_16x16x32_bf16 v[224:227], v[56:59], v[80:83], v[224:227]
v_mfma_f32_16x16x32_bf16 v[228:231], v[56:59], v[84:87], v[228:231]
s_add_u32 m0, s84, 90112
s_add_u32 s94, s82, 14336
v_mfma_f32_16x16x32_bf16 v[232:235], v[56:59], v[88:91], v[232:235]
buffer_load_dwordx4 v1, s[20:23], s94 offen sc1 lds
v_mfma_f32_16x16x32_bf16 v[236:239], v[56:59], v[92:95], v[236:239]
v_mfma_f32_16x16x32_bf16 v[240:243], v[60:63], v[80:83], v[240:243]
s_add_u32 m0, s83, 90112
s_add_u32 s95, s81, 4128768
v_mfma_f32_16x16x32_bf16 v[244:247], v[60:63], v[84:87], v[244:247]
buffer_load_dwordx4 v2, s[8:11], s95 offen  lds
v_mfma_f32_16x16x32_bf16 v[248:251], v[60:63], v[88:91], v[248:251]
v_mfma_f32_16x16x32_bf16 v[252:255], v[60:63], v[92:95], v[252:255]
s_add_u32 m0, s83, 91136
s_waitcnt lgkmcnt(4)
v_mfma_f32_16x16x32_bf16 v[128:131], v[32:35], v[64:67], v[128:131]
buffer_load_dwordx4 v3, s[8:11], s95 offen  lds
v_mfma_f32_16x16x32_bf16 v[132:135], v[32:35], v[68:71], v[132:135]
ds_read_b64_tr_b16 v[44:45], v14 offset:18464
v_mfma_f32_16x16x32_bf16 v[136:139], v[32:35], v[72:75], v[136:139]
s_add_u32 m0, s83, 108544
v_mfma_f32_16x16x32_bf16 v[140:143], v[32:35], v[76:79], v[140:143]
buffer_load_dwordx4 v2, s[12:15], s95 offen  lds
ds_read_b64_tr_b16 v[46:47], v14 offset:20768
s_waitcnt lgkmcnt(4)
v_mfma_f32_16x16x32_bf16 v[144:147], v[36:39], v[64:67], v[144:147]
v_mfma_f32_16x16x32_bf16 v[148:151], v[36:39], v[68:71], v[148:151]
s_add_u32 m0, s83, 109568
ds_read_b64_tr_b16 v[48:49], v11 offset:64
v_mfma_f32_16x16x32_bf16 v[152:155], v[36:39], v[72:75], v[152:155]
buffer_load_dwordx4 v3, s[12:15], s95 offen  lds
v_mfma_f32_16x16x32_bf16 v[156:159], v[36:39], v[76:79], v[156:159]
ds_read_b64_tr_b16 v[50:51], v11 offset:2368
s_waitcnt lgkmcnt(4)
v_mfma_f32_16x16x32_bf16 v[160:163], v[40:43], v[64:67], v[160:163]
s_add_u32 m0, s85, 90112
v_mfma_f32_16x16x32_bf16 v[164:167], v[40:43], v[68:71], v[164:167]
buffer_load_dwordx4 v4, s[32:35], s95 offen  lds
ds_read_b64_tr_b16 v[52:53], v11 offset:18496
v_mfma_f32_16x16x32_bf16 v[168:171], v[40:43], v[72:75], v[168:171]
v_mfma_f32_16x16x32_bf16 v[172:175], v[40:43], v[76:79], v[172:175]
s_mov_b32 s94, 4718592
ds_read_b64_tr_b16 v[54:55], v11 offset:20800
s_waitcnt lgkmcnt(4)
v_mfma_f32_16x16x32_bf16 v[176:179], v[44:47], v[64:67], v[176:179]
buffer_load_dword v28, v31, s[44:47], s94 offen
v_mfma_f32_16x16x32_bf16 v[180:183], v[44:47], v[68:71], v[180:183]
ds_read_b64_tr_b16 v[56:57], v14 offset:96
v_mfma_f32_16x16x32_bf16 v[184:187], v[44:47], v[72:75], v[184:187]
v_mfma_f32_16x16x32_bf16 v[188:191], v[44:47], v[76:79], v[188:191]
ds_read_b64_tr_b16 v[58:59], v14 offset:2400
s_waitcnt lgkmcnt(4)
v_mfma_f32_16x16x32_bf16 v[192:195], v[48:51], v[64:67], v[192:195]
v_mfma_f32_16x16x32_bf16 v[196:199], v[48:51], v[68:71], v[196:199]
ds_read_b64_tr_b16 v[60:61], v14 offset:18528
v_mfma_f32_16x16x32_bf16 v[200:203], v[48:51], v[72:75], v[200:203]
v_mfma_f32_16x16x32_bf16 v[204:207], v[48:51], v[76:79], v[204:207]
ds_read_b64_tr_b16 v[62:63], v14 offset:20832
s_waitcnt lgkmcnt(4)
v_mfma_f32_16x16x32_bf16 v[208:211], v[52:55], v[64:67], v[208:211]
v_mfma_f32_16x16x32_bf16 v[212:215], v[52:55], v[68:71], v[212:215]
v_mfma_f32_16x16x32_bf16 v[216:219], v[52:55], v[72:75], v[216:219]
v_mfma_f32_16x16x32_bf16 v[220:223], v[52:55], v[76:79], v[220:223]
s_waitcnt lgkmcnt(0)
s_waitcnt vmcnt(8)
s_barrier
ds_read_b128 v[80:83], v9 offset:0
ds_read_b128 v[84:87], v9 offset:1024
ds_read_b128 v[88:91], v9 offset:2048
ds_read_b128 v[92:95], v9 offset:3072
ds_read_b64_tr_b16 v[32:33], v12 offset:0
ds_read_b64_tr_b16 v[34:35], v12 offset:2304
ds_read_b64_tr_b16 v[36:37], v12 offset:18432
ds_read_b64_tr_b16 v[38:39], v12 offset:20736
ds_read_b64_tr_b16 v[40:41], v15 offset:32
ds_read_b64_tr_b16 v[42:43], v15 offset:2336
v_mfma_f32_16x16x32_bf16 v[224:227], v[56:59], v[64:67], v[224:227]
v_mfma_f32_16x16x32_bf16 v[228:231], v[56:59], v[68:71], v[228:231]
s_add_u32 m0, s84, 0
s_add_u32 s94, s82, 15360
v_mfma_f32_16x16x32_bf16 v[232:235], v[56:59], v[72:75], v[232:235]
buffer_load_dwordx4 v1, s[20:23], s94 offen sc1 lds
v_mfma_f32_16x16x32_bf16 v[236:239], v[56:59], v[76:79], v[236:239]
v_mfma_f32_16x16x32_bf16 v[240:243], v[60:63], v[64:67], v[240:243]
s_add_u32 m0, s83, 0
s_add_u32 s95, s81, 4202496
v_mfma_f32_16x16x32_bf16 v[244:247], v[60:63], v[68:71], v[244:247]
buffer_load_dwordx4 v2, s[8:11], s95 offen  lds
v_mfma_f32_16x16x32_bf16 v[248:251], v[60:63], v[72:75], v[248:251]
v_mfma_f32_16x16x32_bf16 v[252:255], v[60:63], v[76:79], v[252:255]
s_add_u32 m0, s83, 1024
s_waitcnt lgkmcnt(4)
v_mfma_f32_16x16x32_bf16 v[128:131], v[32:35], v[80:83], v[128:131]
buffer_load_dwordx4 v3, s[8:11], s95 offen  lds
v_mfma_f32_16x16x32_bf16 v[132:135], v[32:35], v[84:87], v[132:135]
ds_read_b64_tr_b16 v[44:45], v15 offset:18464
v_mfma_f32_16x16x32_bf16 v[136:139], v[32:35], v[88:91], v[136:139]
s_add_u32 m0, s83, 18432
v_mfma_f32_16x16x32_bf16 v[140:143], v[32:35], v[92:95], v[140:143]
buffer_load_dwordx4 v2, s[12:15], s95 offen  lds
ds_read_b64_tr_b16 v[46:47], v15 offset:20768
s_waitcnt lgkmcnt(4)
v_mfma_f32_16x16x32_bf16 v[144:147], v[36:39], v[80:83], v[144:147]
v_mfma_f32_16x16x32_bf16 v[148:151], v[36:39], v[84:87], v[148:151]
s_add_u32 m0, s83, 19456
ds_read_b64_tr_b16 v[48:49], v12 offset:64
v_mfma_f32_16x16x32_bf16 v[152:155], v[36:39], v[88:91], v[152:155]
buffer_load_dwordx4 v3, s[12:15], s95 offen  lds
v_mfma_f32_16x16x32_bf16 v[156:159], v[36:39], v[92:95], v[156:159]
ds_read_b64_tr_b16 v[50:51], v12 offset:2368
s_waitcnt lgkmcnt(4)
v_mfma_f32_16x16x32_bf16 v[160:163], v[40:43], v[80:83], v[160:163]
s_add_u32 m0, s85, 0
v_mfma_f32_16x16x32_bf16 v[164:167], v[40:43], v[84:87], v[164:167]
buffer_load_dwordx4 v4, s[32:35], s95 offen  lds
ds_read_b64_tr_b16 v[52:53], v12 offset:18496
v_mfma_f32_16x16x32_bf16 v[168:171], v[40:43], v[88:91], v[168:171]
v_mfma_f32_16x16x32_bf16 v[172:175], v[40:43], v[92:95], v[172:175]
s_mov_b32 s94, 4792320
ds_read_b64_tr_b16 v[54:55], v12 offset:20800
s_waitcnt lgkmcnt(4)
v_mfma_f32_16x16x32_bf16 v[176:179], v[44:47], v[80:83], v[176:179]
buffer_load_dword v28, v31, s[44:47], s94 offen
v_mfma_f32_16x16x32_bf16 v[180:183], v[44:47], v[84:87], v[180:183]
ds_read_b64_tr_b16 v[56:57], v15 offset:96
v_mfma_f32_16x16x32_bf16 v[184:187], v[44:47], v[88:91], v[184:187]
v_mfma_f32_16x16x32_bf16 v[188:191], v[44:47], v[92:95], v[188:191]
ds_read_b64_tr_b16 v[58:59], v15 offset:2400
s_waitcnt lgkmcnt(4)
v_mfma_f32_16x16x32_bf16 v[192:195], v[48:51], v[80:83], v[192:195]
v_mfma_f32_16x16x32_bf16 v[196:199], v[48:51], v[84:87], v[196:199]
ds_read_b64_tr_b16 v[60:61], v15 offset:18528
v_mfma_f32_16x16x32_bf16 v[200:203], v[48:51], v[88:91], v[200:203]
v_mfma_f32_16x16x32_bf16 v[204:207], v[48:51], v[92:95], v[204:207]
ds_read_b64_tr_b16 v[62:63], v15 offset:20832
s_waitcnt lgkmcnt(4)
v_mfma_f32_16x16x32_bf16 v[208:211], v[52:55], v[80:83], v[208:211]
v_mfma_f32_16x16x32_bf16 v[212:215], v[52:55], v[84:87], v[212:215]
v_mfma_f32_16x16x32_bf16 v[216:219], v[52:55], v[88:91], v[216:219]
v_mfma_f32_16x16x32_bf16 v[220:223], v[52:55], v[92:95], v[220:223]
s_waitcnt lgkmcnt(0)
s_waitcnt vmcnt(8)
s_barrier
ds_read_b128 v[64:67], v10 offset:0
ds_read_b128 v[68:71], v10 offset:1024
ds_read_b128 v[72:75], v10 offset:2048
ds_read_b128 v[76:79], v10 offset:3072
ds_read_b64_tr_b16 v[32:33], v13 offset:0
ds_read_b64_tr_b16 v[34:35], v13 offset:2304
ds_read_b64_tr_b16 v[36:37], v13 offset:18432
ds_read_b64_tr_b16 v[38:39], v13 offset:20736
ds_read_b64_tr_b16 v[40:41], v16 offset:32
ds_read_b64_tr_b16 v[42:43], v16 offset:2336
v_mfma_f32_16x16x32_bf16 v[224:227], v[56:59], v[80:83], v[224:227]
v_mfma_f32_16x16x32_bf16 v[228:231], v[56:59], v[84:87], v[228:231]
s_add_u32 m0, s84, 45056
s_add_u32 s94, s82, 16384
v_mfma_f32_16x16x32_bf16 v[232:235], v[56:59], v[88:91], v[232:235]
buffer_load_dwordx4 v1, s[20:23], s94 offen sc1 lds
v_mfma_f32_16x16x32_bf16 v[236:239], v[56:59], v[92:95], v[236:239]
v_mfma_f32_16x16x32_bf16 v[240:243], v[60:63], v[80:83], v[240:243]
s_add_u32 m0, s83, 45056
s_add_u32 s95, s81, 4718592
v_mfma_f32_16x16x32_bf16 v[244:247], v[60:63], v[84:87], v[244:247]
buffer_load_dwordx4 v2, s[8:11], s95 offen  lds
v_mfma_f32_16x16x32_bf16 v[248:251], v[60:63], v[88:91], v[248:251]
v_mfma_f32_16x16x32_bf16 v[252:255], v[60:63], v[92:95], v[252:255]
s_add_u32 m0, s83, 46080
s_waitcnt lgkmcnt(4)
v_mfma_f32_16x16x32_bf16 v[128:131], v[32:35], v[64:67], v[128:131]
buffer_load_dwordx4 v3, s[8:11], s95 offen  lds
v_mfma_f32_16x16x32_bf16 v[132:135], v[32:35], v[68:71], v[132:135]
ds_read_b64_tr_b16 v[44:45], v16 offset:18464
v_mfma_f32_16x16x32_bf16 v[136:139], v[32:35], v[72:75], v[136:139]
s_add_u32 m0, s83, 63488
v_mfma_f32_16x16x32_bf16 v[140:143], v[32:35], v[76:79], v[140:143]
buffer_load_dwordx4 v2, s[12:15], s95 offen  lds
ds_read_b64_tr_b16 v[46:47], v16 offset:20768
s_waitcnt lgkmcnt(4)
v_mfma_f32_16x16x32_bf16 v[144:147], v[36:39], v[64:67], v[144:147]
v_mfma_f32_16x16x32_bf16 v[148:151], v[36:39], v[68:71], v[148:151]
s_add_u32 m0, s83, 64512
ds_read_b64_tr_b16 v[48:49], v13 offset:64
v_mfma_f32_16x16x32_bf16 v[152:155], v[36:39], v[72:75], v[152:155]
buffer_load_dwordx4 v3, s[12:15], s95 offen  lds
v_mfma_f32_16x16x32_bf16 v[156:159], v[36:39], v[76:79], v[156:159]
ds_read_b64_tr_b16 v[50:51], v13 offset:2368
s_waitcnt lgkmcnt(4)
v_mfma_f32_16x16x32_bf16 v[160:163], v[40:43], v[64:67], v[160:163]
s_add_u32 m0, s85, 45056
v_mfma_f32_16x16x32_bf16 v[164:167], v[40:43], v[68:71], v[164:167]
buffer_load_dwordx4 v4, s[32:35], s95 offen  lds
ds_read_b64_tr_b16 v[52:53], v13 offset:18496
v_mfma_f32_16x16x32_bf16 v[168:171], v[40:43], v[72:75], v[168:171]
v_mfma_f32_16x16x32_bf16 v[172:175], v[40:43], v[76:79], v[172:175]
ds_read_b64_tr_b16 v[54:55], v13 offset:20800
s_waitcnt lgkmcnt(4)
v_mfma_f32_16x16x32_bf16 v[176:179], v[44:47], v[64:67], v[176:179]
v_mfma_f32_16x16x32_bf16 v[180:183], v[44:47], v[68:71], v[180:183]
ds_read_b64_tr_b16 v[56:57], v16 offset:96
v_mfma_f32_16x16x32_bf16 v[184:187], v[44:47], v[72:75], v[184:187]
v_mfma_f32_16x16x32_bf16 v[188:191], v[44:47], v[76:79], v[188:191]
ds_read_b64_tr_b16 v[58:59], v16 offset:2400
s_waitcnt lgkmcnt(4)
v_mfma_f32_16x16x32_bf16 v[192:195], v[48:51], v[64:67], v[192:195]
v_mfma_f32_16x16x32_bf16 v[196:199], v[48:51], v[68:71], v[196:199]
ds_read_b64_tr_b16 v[60:61], v16 offset:18528
v_mfma_f32_16x16x32_bf16 v[200:203], v[48:51], v[72:75], v[200:203]
v_mfma_f32_16x16x32_bf16 v[204:207], v[48:51], v[76:79], v[204:207]
ds_read_b64_tr_b16 v[62:63], v16 offset:20832
s_waitcnt lgkmcnt(4)
v_mfma_f32_16x16x32_bf16 v[208:211], v[52:55], v[64:67], v[208:211]
v_mfma_f32_16x16x32_bf16 v[212:215], v[52:55], v[68:71], v[212:215]
v_mfma_f32_16x16x32_bf16 v[216:219], v[52:55], v[72:75], v[216:219]
v_mfma_f32_16x16x32_bf16 v[220:223], v[52:55], v[76:79], v[220:223]
s_waitcnt lgkmcnt(0)
s_waitcnt vmcnt(7)
s_barrier
ds_read_b128 v[80:83], v8 offset:0
ds_read_b128 v[84:87], v8 offset:1024
ds_read_b128 v[88:91], v8 offset:2048
ds_read_b128 v[92:95], v8 offset:3072
ds_read_b64_tr_b16 v[32:33], v11 offset:0
ds_read_b64_tr_b16 v[34:35], v11 offset:2304
ds_read_b64_tr_b16 v[36:37], v11 offset:18432
ds_read_b64_tr_b16 v[38:39], v11 offset:20736
ds_read_b64_tr_b16 v[40:41], v14 offset:32
ds_read_b64_tr_b16 v[42:43], v14 offset:2336
v_mfma_f32_16x16x32_bf16 v[224:227], v[56:59], v[64:67], v[224:227]
v_mfma_f32_16x16x32_bf16 v[228:231], v[56:59], v[68:71], v[228:231]
s_add_u32 m0, s84, 90112
s_add_u32 s94, s82, 17408
v_mfma_f32_16x16x32_bf16 v[232:235], v[56:59], v[72:75], v[232:235]
buffer_load_dwordx4 v1, s[20:23], s94 offen sc1 lds
v_mfma_f32_16x16x32_bf16 v[236:239], v[56:59], v[76:79], v[236:239]
v_mfma_f32_16x16x32_bf16 v[240:243], v[60:63], v[64:67], v[240:243]
s_add_u32 m0, s83, 90112
s_add_u32 s95, s81, 4792320
v_mfma_f32_16x16x32_bf16 v[244:247], v[60:63], v[68:71], v[244:247]
buffer_load_dwordx4 v2, s[8:11], s95 offen  lds
v_mfma_f32_16x16x32_bf16 v[248:251], v[60:63], v[72:75], v[248:251]
v_mfma_f32_16x16x32_bf16 v[252:255], v[60:63], v[76:79], v[252:255]
s_add_u32 m0, s83, 91136
s_waitcnt lgkmcnt(4)
v_mfma_f32_16x16x32_bf16 v[128:131], v[32:35], v[80:83], v[128:131]
buffer_load_dwordx4 v3, s[8:11], s95 offen  lds
v_mfma_f32_16x16x32_bf16 v[132:135], v[32:35], v[84:87], v[132:135]
ds_read_b64_tr_b16 v[44:45], v14 offset:18464
v_mfma_f32_16x16x32_bf16 v[136:139], v[32:35], v[88:91], v[136:139]
s_add_u32 m0, s83, 108544
v_mfma_f32_16x16x32_bf16 v[140:143], v[32:35], v[92:95], v[140:143]
buffer_load_dwordx4 v2, s[12:15], s95 offen  lds
ds_read_b64_tr_b16 v[46:47], v14 offset:20768
s_waitcnt lgkmcnt(4)
v_mfma_f32_16x16x32_bf16 v[144:147], v[36:39], v[80:83], v[144:147]
v_mfma_f32_16x16x32_bf16 v[148:151], v[36:39], v[84:87], v[148:151]
s_add_u32 m0, s83, 109568
ds_read_b64_tr_b16 v[48:49], v11 offset:64
v_mfma_f32_16x16x32_bf16 v[152:155], v[36:39], v[88:91], v[152:155]
buffer_load_dwordx4 v3, s[12:15], s95 offen  lds
v_mfma_f32_16x16x32_bf16 v[156:159], v[36:39], v[92:95], v[156:159]
ds_read_b64_tr_b16 v[50:51], v11 offset:2368
s_waitcnt lgkmcnt(4)
v_mfma_f32_16x16x32_bf16 v[160:163], v[40:43], v[80:83], v[160:163]
s_add_u32 m0, s85, 90112
v_mfma_f32_16x16x32_bf16 v[164:167], v[40:43], v[84:87], v[164:167]
buffer_load_dwordx4 v4, s[32:35], s95 offen  lds
ds_read_b64_tr_b16 v[52:53], v11 offset:18496
v_mfma_f32_16x16x32_bf16 v[168:171], v[40:43], v[88:91], v[168:171]
v_mfma_f32_16x16x32_bf16 v[172:175], v[40:43], v[92:95], v[172:175]
ds_read_b64_tr_b16 v[54:55], v11 offset:20800
s_waitcnt lgkmcnt(4)
v_mfma_f32_16x16x32_bf16 v[176:179], v[44:47], v[80:83], v[176:179]
v_mfma_f32_16x16x32_bf16 v[180:183], v[44:47], v[84:87], v[180:183]
ds_read_b64_tr_b16 v[56:57], v14 offset:96
v_mfma_f32_16x16x32_bf16 v[184:187], v[44:47], v[88:91], v[184:187]
v_mfma_f32_16x16x32_bf16 v[188:191], v[44:47], v[92:95], v[188:191]
ds_read_b64_tr_b16 v[58:59], v14 offset:2400
s_waitcnt lgkmcnt(4)
v_mfma_f32_16x16x32_bf16 v[192:195], v[48:51], v[80:83], v[192:195]
v_mfma_f32_16x16x32_bf16 v[196:199], v[48:51], v[84:87], v[196:199]
ds_read_b64_tr_b16 v[60:61], v14 offset:18528
v_mfma_f32_16x16x32_bf16 v[200:203], v[48:51], v[88:91], v[200:203]
v_mfma_f32_16x16x32_bf16 v[204:207], v[48:51], v[92:95], v[204:207]
ds_read_b64_tr_b16 v[62:63], v14 offset:20832
s_waitcnt lgkmcnt(4)
v_mfma_f32_16x16x32_bf16 v[208:211], v[52:55], v[80:83], v[208:211]
v_mfma_f32_16x16x32_bf16 v[212:215], v[52:55], v[84:87], v[212:215]
v_mfma_f32_16x16x32_bf16 v[216:219], v[52:55], v[88:91], v[216:219]
v_mfma_f32_16x16x32_bf16 v[220:223], v[52:55], v[92:95], v[220:223]
s_waitcnt lgkmcnt(0)
s_waitcnt vmcnt(6)
s_barrier
ds_read_b128 v[64:67], v9 offset:0
ds_read_b128 v[68:71], v9 offset:1024
ds_read_b128 v[72:75], v9 offset:2048
ds_read_b128 v[76:79], v9 offset:3072
ds_read_b64_tr_b16 v[32:33], v12 offset:0
ds_read_b64_tr_b16 v[34:35], v12 offset:2304
ds_read_b64_tr_b16 v[36:37], v12 offset:18432
ds_read_b64_tr_b16 v[38:39], v12 offset:20736
ds_read_b64_tr_b16 v[40:41], v15 offset:32
ds_read_b64_tr_b16 v[42:43], v15 offset:2336
v_mfma_f32_16x16x32_bf16 v[224:227], v[56:59], v[80:83], v[224:227]
v_mfma_f32_16x16x32_bf16 v[228:231], v[56:59], v[84:87], v[228:231]
s_add_u32 m0, s87, 0
s_add_u32 s94, s86, 0
v_mfma_f32_16x16x32_bf16 v[232:235], v[56:59], v[88:91], v[232:235]
buffer_load_dwordx4 v17, s[16:19], s94 offen  lds
v_mfma_f32_16x16x32_bf16 v[236:239], v[56:59], v[92:95], v[236:239]
v_mfma_f32_16x16x32_bf16 v[240:243], v[60:63], v[80:83], v[240:243]
s_add_u32 m0, s87, 1024
s_add_u32 s94, s86, 9216
v_mfma_f32_16x16x32_bf16 v[244:247], v[60:63], v[84:87], v[244:247]
buffer_load_dwordx4 v17, s[16:19], s94 offen  lds
v_mfma_f32_16x16x32_bf16 v[248:251], v[60:63], v[88:91], v[248:251]
v_mfma_f32_16x16x32_bf16 v[252:255], v[60:63], v[92:95], v[252:255]
s_add_u32 m0, s87, 2048
s_add_u32 s94, s86, 18432
s_waitcnt lgkmcnt(4)
v_mfma_f32_16x16x32_bf16 v[128:131], v[32:35], v[64:67], v[128:131]
buffer_load_dwordx4 v17, s[16:19], s94 offen  lds
v_mfma_f32_16x16x32_bf16 v[132:135], v[32:35], v[68:71], v[132:135]
ds_read_b64_tr_b16 v[44:45], v15 offset:18464
v_mfma_f32_16x16x32_bf16 v[136:139], v[32:35], v[72:75], v[136:139]
s_add_u32 m0, s87, 3072
s_add_u32 s94, s86, 27648
v_mfma_f32_16x16x32_bf16 v[140:143], v[32:35], v[76:79], v[140:143]
buffer_load_dwordx4 v17, s[16:19], s94 offen  lds
ds_read_b64_tr_b16 v[46:47], v15 offset:20768
s_waitcnt lgkmcnt(4)
v_mfma_f32_16x16x32_bf16 v[144:147], v[36:39], v[64:67], v[144:147]
v_mfma_f32_16x16x32_bf16 v[148:151], v[36:39], v[68:71], v[148:151]
s_add_u32 m0, s87, 4096
s_add_u32 s94, s86, 36864
ds_read_b64_tr_b16 v[48:49], v12 offset:64
v_mfma_f32_16x16x32_bf16 v[152:155], v[36:39], v[72:75], v[152:155]
buffer_load_dwordx4 v17, s[16:19], s94 offen  lds
v_mfma_f32_16x16x32_bf16 v[156:159], v[36:39], v[76:79], v[156:159]
ds_read_b64_tr_b16 v[50:51], v12 offset:2368
s_waitcnt lgkmcnt(4)
v_mfma_f32_16x16x32_bf16 v[160:163], v[40:43], v[64:67], v[160:163]
v_mfma_f32_16x16x32_bf16 v[164:167], v[40:43], v[68:71], v[164:167]
ds_read_b64_tr_b16 v[52:53], v12 offset:18496
v_mfma_f32_16x16x32_bf16 v[168:171], v[40:43], v[72:75], v[168:171]
v_mfma_f32_16x16x32_bf16 v[172:175], v[40:43], v[76:79], v[172:175]
ds_read_b64_tr_b16 v[54:55], v12 offset:20800
s_waitcnt lgkmcnt(4)
v_mfma_f32_16x16x32_bf16 v[176:179], v[44:47], v[64:67], v[176:179]
v_mfma_f32_16x16x32_bf16 v[180:183], v[44:47], v[68:71], v[180:183]
ds_read_b64_tr_b16 v[56:57], v15 offset:96
v_mfma_f32_16x16x32_bf16 v[184:187], v[44:47], v[72:75], v[184:187]
v_mfma_f32_16x16x32_bf16 v[188:191], v[44:47], v[76:79], v[188:191]
ds_read_b64_tr_b16 v[58:59], v15 offset:2400
s_waitcnt lgkmcnt(4)
v_mfma_f32_16x16x32_bf16 v[192:195], v[48:51], v[64:67], v[192:195]
v_mfma_f32_16x16x32_bf16 v[196:199], v[48:51], v[68:71], v[196:199]
ds_read_b64_tr_b16 v[60:61], v15 offset:18528
v_mfma_f32_16x16x32_bf16 v[200:203], v[48:51], v[72:75], v[200:203]
v_mfma_f32_16x16x32_bf16 v[204:207], v[48:51], v[76:79], v[204:207]
ds_read_b64_tr_b16 v[62:63], v15 offset:20832
s_waitcnt lgkmcnt(4)
v_mfma_f32_16x16x32_bf16 v[208:211], v[52:55], v[64:67], v[208:211]
v_mfma_f32_16x16x32_bf16 v[212:215], v[52:55], v[68:71], v[212:215]
v_mfma_f32_16x16x32_bf16 v[216:219], v[52:55], v[72:75], v[216:219]
v_mfma_f32_16x16x32_bf16 v[220:223], v[52:55], v[76:79], v[220:223]
s_waitcnt lgkmcnt(0)
s_waitcnt vmcnt(5)
s_barrier
ds_read_b128 v[80:83], v10 offset:0
ds_read_b128 v[84:87], v10 offset:1024
ds_read_b128 v[88:91], v10 offset:2048
ds_read_b128 v[92:95], v10 offset:3072
ds_read_b64_tr_b16 v[32:33], v13 offset:0
ds_read_b64_tr_b16 v[34:35], v13 offset:2304
ds_read_b64_tr_b16 v[36:37], v13 offset:18432
ds_read_b64_tr_b16 v[38:39], v13 offset:20736
ds_read_b64_tr_b16 v[40:41], v16 offset:32
ds_read_b64_tr_b16 v[42:43], v16 offset:2336
v_mfma_f32_16x16x32_bf16 v[224:227], v[56:59], v[64:67], v[224:227]
v_mfma_f32_16x16x32_bf16 v[228:231], v[56:59], v[68:71], v[228:231]
s_add_u32 m0, s87, 36864
s_add_u32 s94, s86, 128
v_mfma_f32_16x16x32_bf16 v[232:235], v[56:59], v[72:75], v[232:235]
buffer_load_dwordx4 v17, s[16:19], s94 offen  lds
v_mfma_f32_16x16x32_bf16 v[236:239], v[56:59], v[76:79], v[236:239]
v_mfma_f32_16x16x32_bf16 v[240:243], v[60:63], v[64:67], v[240:243]
s_add_u32 m0, s87, 37888
s_add_u32 s94, s86, 9344
v_mfma_f32_16x16x32_bf16 v[244:247], v[60:63], v[68:71], v[244:247]
buffer_load_dwordx4 v17, s[16:19], s94 offen  lds
v_mfma_f32_16x16x32_bf16 v[248:251], v[60:63], v[72:75], v[248:251]
v_mfma_f32_16x16x32_bf16 v[252:255], v[60:63], v[76:79], v[252:255]
s_add_u32 m0, s87, 38912
s_add_u32 s94, s86, 18560
s_waitcnt lgkmcnt(4)
v_mfma_f32_16x16x32_bf16 v[128:131], v[32:35], v[80:83], v[128:131]
buffer_load_dwordx4 v17, s[16:19], s94 offen  lds
ds_read_b64_tr_b16 v[44:45], v16 offset:18464
ds_read_b64_tr_b16 v[46:47], v16 offset:20768
v_mov_b32 v9, 1073741824
v_lshrrev_b32 v5, 4, v0
v_mfma_f32_16x16x32_bf16 v[132:135], v[32:35], v[84:87], v[132:135]
v_and_b32 v6, 3, v0
v_bfe_u32 v7, v0, 3, 1
s_and_b32 s4, s58, 3
v_xor_b32 v14, s4, v5
v_mfma_f32_16x16x32_bf16 v[136:139], v[32:35], v[88:91], v[136:139]
s_add_u32 m0, s87, 39936
s_add_u32 s94, s86, 27776
v_mul_u32_u24 v2, 147456, v14
v_lshlrev_b32 v11, 8, v7
v_and_b32 v14, 7, v0
v_lshl_add_u32 v11, v14, 4, v11
v_mfma_f32_16x16x32_bf16 v[140:143], v[32:35], v[92:95], v[140:143]
buffer_load_dwordx4 v17, s[16:19], s94 offen  lds
v_add_u32 v2, v2, v11
s_lshl_b32 s4, s59, 1
v_add_u32 v7, s4, v7
s_lshl_b32 s4, s80, 7
s_lshl_b32 s5, s59, 9
s_waitcnt lgkmcnt(4)
v_mfma_f32_16x16x32_bf16 v[144:147], v[36:39], v[80:83], v[144:147]
ds_read_b64_tr_b16 v[48:49], v13 offset:64
ds_read_b64_tr_b16 v[50:51], v13 offset:2368
s_add_u32 s4, s4, s5
s_add_u32 s5, s4, 73728
v_mfma_f32_16x16x32_bf16 v[148:151], v[36:39], v[84:87], v[148:151]
s_add_u32 m0, s87, 40960
s_add_u32 s94, s86, 36992
v_add_u32 v11, s5, v11
s_add_u32 s90, s90, s4
s_lshl_b32 s4, s58, 10
s_add_u32 s90, s90, s4
v_mfma_f32_16x16x32_bf16 v[152:155], v[36:39], v[88:91], v[152:155]
buffer_load_dwordx4 v17, s[16:19], s94 offen  lds
s_and_b32 s4, s58, 12
s_mul_i32 s44, s4, 147456
s_add_u32 s44, s44, s90
s_xor_b32 s5, s4, 4
v_mfma_f32_16x16x32_bf16 v[156:159], v[36:39], v[92:95], v[156:159]
s_mul_i32 s45, s5, 147456
s_add_u32 s45, s45, s90
s_xor_b32 s5, s4, 8
s_mul_i32 s46, s5, 147456
s_add_u32 s46, s46, s90
s_waitcnt lgkmcnt(4)
v_mfma_f32_16x16x32_bf16 v[160:163], v[40:43], v[80:83], v[160:163]
ds_read_b64_tr_b16 v[52:53], v13 offset:18496
ds_read_b64_tr_b16 v[54:55], v13 offset:20800
s_xor_b32 s5, s4, 12
s_mul_i32 s47, s5, 147456
v_mfma_f32_16x16x32_bf16 v[164:167], v[40:43], v[84:87], v[164:167]
s_add_u32 s47, s47, s90
v_and_b32 v10, 1023, v18
s_lshl_b32 s4, s89, 8
s_add_u32 s4, s4, 73728
v_mfma_f32_16x16x32_bf16 v[168:171], v[40:43], v[88:91], v[168:171]
v_add_u32 v10, s4, v10
s_lshr_b32 s3, s58, 3
s_and_b32 s5, s58, 7
v_lshrrev_b32 v14, 10, v18
v_mfma_f32_16x16x32_bf16 v[172:175], v[40:43], v[92:95], v[172:175]
v_cmp_eq_u32 s[48:49], s5, v14
s_cmp_eq_u32 s3, s59
s_cselect_b64 s[48:49], s[48:49], 0
v_cndmask_b32 v18, v18, v9, s[48:49]
s_lshl_b32 s5, s5, 7
s_lshl_b32 s91, s57, 2
s_waitcnt lgkmcnt(4)
v_mfma_f32_16x16x32_bf16 v[176:179], v[44:47], v[80:83], v[176:179]
ds_read_b64_tr_b16 v[56:57], v16 offset:96
ds_read_b64_tr_b16 v[58:59], v16 offset:2400
s_lshl_b32 s3, s3, 1
s_add_u32 s91, s91, s3
v_mfma_f32_16x16x32_bf16 v[180:183], v[44:47], v[84:87], v[180:183]
s_add_u32 s91, s91, s80
s_lshl_b32 s3, s91, 1
v_add_u32 v3, s3, v5
v_mul_u32_u24 v3, 18432, v3
v_mfma_f32_16x16x32_bf16 v[184:187], v[44:47], v[88:91], v[184:187]
v_lshrrev_b32 v14, 1, v6
v_lshl_add_u32 v3, v14, 10, v3
v_lshl_add_u32 v3, v7, 4, v3
v_and_b32 v14, 1, v6
v_mfma_f32_16x16x32_bf16 v[188:191], v[44:47], v[92:95], v[188:191]
v_lshl_add_u32 v3, v14, 3, v3
v_add_u32 v3, s5, v3
v_bfe_u32 v14, v0, 2, 1
v_lshl_add_u32 v3, v14, 6, v3
s_lshr_b32 s4, s5, 6
s_waitcnt lgkmcnt(4)
v_mfma_f32_16x16x32_bf16 v[192:195], v[48:51], v[80:83], v[192:195]
ds_read_b64_tr_b16 v[60:61], v16 offset:18528
ds_read_b64_tr_b16 v[62:63], v16 offset:20832
v_lshl_add_u32 v4, v5, 4, s4
v_add_u32 v4, v4, v14
v_mfma_f32_16x16x32_bf16 v[196:199], v[48:51], v[84:87], v[196:199]
v_lshl_add_u32 v4, v4, 6, s91
v_mul_u32_u24 v4, 1152, v4
v_lshl_add_u32 v4, v7, 5, v4
v_lshl_add_u32 v4, v6, 3, v4
v_mfma_f32_16x16x32_bf16 v[200:203], v[48:51], v[88:91], v[200:203]
v_cmp_gt_u32 vcc, 32, v0
s_nop 1
v_cndmask_b32 v3, v9, v3, vcc
v_cndmask_b32 v4, v9, v4, vcc
v_lshlrev_b32 v14, 4, v14
v_mfma_f32_16x16x32_bf16 v[204:207], v[48:51], v[92:95], v[204:207]
v_lshl_add_u32 v14, v5, 2, v14
s_lshl_b32 s4, s58, 5
s_lshl_b32 s5, s80, 3
s_add_u32 s4, s4, s5
s_lshl_b32 s5, s57, 9
s_waitcnt lgkmcnt(4)
v_mfma_f32_16x16x32_bf16 v[208:211], v[52:55], v[80:83], v[208:211]
s_add_u32 s4, s4, s5
s_add_u32 s4, s4, 196608
v_add_u32 v27, s4, v14
v_mfma_f32_16x16x32_bf16 v[212:215], v[52:55], v[84:87], v[212:215]
s_lshl_b32 s4, s57, 11
s_add_u32 s4, s4, 32768
s_lshl_b32 s5, s58, 2
s_add_u32 s5, s5, s4
v_mfma_f32_16x16x32_bf16 v[216:219], v[52:55], v[88:91], v[216:219]
v_lshl_add_u32 v5, v0, 7, s5
v_cmp_gt_u32 vcc, 16, v0
s_nop 1
v_cndmask_b32 v9, v9, v5, vcc
s_lshl_b32 s5, s58, 7
v_mfma_f32_16x16x32_bf16 v[220:223], v[52:55], v[92:95], v[220:223]
s_add_u32 s5, s5, s4
v_and_b32 v5, 15, v0
v_lshl_add_u32 v8, v5, 2, s5
s_mov_b32 s91, 0.6931471805599453
s_lshr_b32 s3, s2, 3
s_mul_i32 s3, s3, 18
s_mul_i32 s4, s98, 576
s_add_u32 s3, s3, s4
v_add_u32 v28, s3, v0
v_mul_u32_u24 v28, 1152, v28
v_mov_b32 v29, 1073741824
v_cmp_gt_u32 vcc, 18, v0
s_nop 1
v_cndmask_b32 v28, v29, v28, vcc
s_lshl_b32 s3, s56, 7
s_add_u32 s3, s3, 256
s_cmp_eq_u32 s56, 7
s_cselect_b32 s3, 1073741824, s3
buffer_load_dword v26, v28, s[16:19], s3 offen
s_waitcnt lgkmcnt(0)
s_barrier
v_mfma_f32_16x16x32_bf16 v[224:227], v[56:59], v[80:83], v[224:227]
v_mfma_f32_16x16x32_bf16 v[228:231], v[56:59], v[84:87], v[228:231]
v_mfma_f32_16x16x32_bf16 v[232:235], v[56:59], v[88:91], v[232:235]
v_mfma_f32_16x16x32_bf16 v[236:239], v[56:59], v[92:95], v[236:239]
v_mfma_f32_16x16x32_bf16 v[240:243], v[60:63], v[80:83], v[240:243]
v_mfma_f32_16x16x32_bf16 v[244:247], v[60:63], v[84:87], v[244:247]
v_mfma_f32_16x16x32_bf16 v[248:251], v[60:63], v[88:91], v[248:251]
v_mfma_f32_16x16x32_bf16 v[252:255], v[60:63], v[92:95], v[252:255]
s_mov_b32 s4, 1.0
s_mov_b32 s5, 1.0
v_exp_f32 v128, -v128
v_exp_f32 v129, -v129
v_exp_f32 v130, -v130
v_exp_f32 v131, -v131
v_exp_f32 v132, -v132
v_exp_f32 v133, -v133
v_exp_f32 v134, -v134
v_exp_f32 v135, -v135
v_pk_add_f32 v[128:129], v[128:129], s[4:5]
v_pk_add_f32 v[130:131], v[130:131], s[4:5]
v_pk_add_f32 v[132:133], v[132:133], s[4:5]
v_pk_add_f32 v[134:135], v[134:135], s[4:5]
v_rcp_f32 v128, v128
v_rcp_f32 v129, v129
v_rcp_f32 v130, v130
v_rcp_f32 v131, v131
v_rcp_f32 v132, v132
v_rcp_f32 v133, v133
v_rcp_f32 v134, v134
v_rcp_f32 v135, v135
v_pk_mul_f32 v[128:129], v[128:129], v[144:145]
v_pk_mul_f32 v[130:131], v[130:131], v[146:147]
v_pk_mul_f32 v[132:133], v[132:133], v[148:149]
v_pk_mul_f32 v[134:135], v[134:135], v[150:151]
v_cvt_pk_bf16_f32 v144, v128, v129
v_cvt_pk_bf16_f32 v145, v130, v131
v_cvt_pk_bf16_f32 v148, v132, v133
v_cvt_pk_bf16_f32 v149, v134, v135
v_exp_f32 v136, -v136
v_exp_f32 v137, -v137
v_exp_f32 v138, -v138
v_exp_f32 v139, -v139
v_exp_f32 v140, -v140
v_exp_f32 v141, -v141
v_exp_f32 v142, -v142
v_exp_f32 v143, -v143
v_pk_add_f32 v[136:137], v[136:137], s[4:5]
v_pk_add_f32 v[138:139], v[138:139], s[4:5]
v_pk_add_f32 v[140:141], v[140:141], s[4:5]
v_pk_add_f32 v[142:143], v[142:143], s[4:5]
v_rcp_f32 v136, v136
v_rcp_f32 v137, v137
v_rcp_f32 v138, v138
v_rcp_f32 v139, v139
v_rcp_f32 v140, v140
v_rcp_f32 v141, v141
v_rcp_f32 v142, v142
v_rcp_f32 v143, v143
v_pk_mul_f32 v[136:137], v[136:137], v[152:153]
v_pk_mul_f32 v[138:139], v[138:139], v[154:155]
v_pk_mul_f32 v[140:141], v[140:141], v[156:157]
v_pk_mul_f32 v[142:143], v[142:143], v[158:159]
v_cvt_pk_bf16_f32 v152, v136, v137
v_cvt_pk_bf16_f32 v153, v138, v139
v_cvt_pk_bf16_f32 v156, v140, v141
v_cvt_pk_bf16_f32 v157, v142, v143
ds_write_b64 v19, v[144:145] offset:0
ds_write_b64 v19, v[148:149] offset:9216
ds_write_b64 v19, v[152:153] offset:18432
ds_write_b64 v19, v[156:157] offset:27648
v_exp_f32 v160, -v160
v_exp_f32 v161, -v161
v_exp_f32 v162, -v162
v_exp_f32 v163, -v163
v_exp_f32 v164, -v164
v_exp_f32 v165, -v165
v_exp_f32 v166, -v166
v_exp_f32 v167, -v167
v_pk_add_f32 v[160:161], v[160:161], s[4:5]
v_pk_add_f32 v[162:163], v[162:163], s[4:5]
v_pk_add_f32 v[164:165], v[164:165], s[4:5]
v_pk_add_f32 v[166:167], v[166:167], s[4:5]
v_rcp_f32 v160, v160
v_rcp_f32 v161, v161
v_rcp_f32 v162, v162
v_rcp_f32 v163, v163
v_rcp_f32 v164, v164
v_rcp_f32 v165, v165
v_rcp_f32 v166, v166
v_rcp_f32 v167, v167
v_pk_mul_f32 v[160:161], v[160:161], v[176:177]
v_pk_mul_f32 v[162:163], v[162:163], v[178:179]
v_pk_mul_f32 v[164:165], v[164:165], v[180:181]
v_pk_mul_f32 v[166:167], v[166:167], v[182:183]
v_cvt_pk_bf16_f32 v176, v160, v161
v_cvt_pk_bf16_f32 v177, v162, v163
v_cvt_pk_bf16_f32 v180, v164, v165
v_cvt_pk_bf16_f32 v181, v166, v167
v_exp_f32 v168, -v168
v_exp_f32 v169, -v169
v_exp_f32 v170, -v170
v_exp_f32 v171, -v171
v_exp_f32 v172, -v172
v_exp_f32 v173, -v173
v_exp_f32 v174, -v174
v_exp_f32 v175, -v175
v_pk_add_f32 v[168:169], v[168:169], s[4:5]
v_pk_add_f32 v[170:171], v[170:171], s[4:5]
v_pk_add_f32 v[172:173], v[172:173], s[4:5]
v_pk_add_f32 v[174:175], v[174:175], s[4:5]
v_rcp_f32 v168, v168
v_rcp_f32 v169, v169
v_rcp_f32 v170, v170
v_rcp_f32 v171, v171
v_rcp_f32 v172, v172
v_rcp_f32 v173, v173
v_rcp_f32 v174, v174
v_rcp_f32 v175, v175
v_pk_mul_f32 v[168:169], v[168:169], v[184:185]
v_pk_mul_f32 v[170:171], v[170:171], v[186:187]
v_pk_mul_f32 v[172:173], v[172:173], v[188:189]
v_pk_mul_f32 v[174:175], v[174:175], v[190:191]
v_cvt_pk_bf16_f32 v184, v168, v169
v_cvt_pk_bf16_f32 v185, v170, v171
v_cvt_pk_bf16_f32 v188, v172, v173
v_cvt_pk_bf16_f32 v189, v174, v175
ds_write_b64 v25, v[176:177] offset:0
ds_write_b64 v25, v[180:181] offset:9216
ds_write_b64 v25, v[184:185] offset:18432
ds_write_b64 v25, v[188:189] offset:27648
v_exp_f32 v192, -v192
v_exp_f32 v193, -v193
v_exp_f32 v194, -v194
v_exp_f32 v195, -v195
v_exp_f32 v196, -v196
v_exp_f32 v197, -v197
v_exp_f32 v198, -v198
v_exp_f32 v199, -v199
v_pk_add_f32 v[192:193], v[192:193], s[4:5]
v_pk_add_f32 v[194:195], v[194:195], s[4:5]
v_pk_add_f32 v[196:197], v[196:197], s[4:5]
v_pk_add_f32 v[198:199], v[198:199], s[4:5]
v_rcp_f32 v192, v192
v_rcp_f32 v193, v193
v_rcp_f32 v194, v194
v_rcp_f32 v195, v195
v_rcp_f32 v196, v196
v_rcp_f32 v197, v197
v_rcp_f32 v198, v198
v_rcp_f32 v199, v199
v_pk_mul_f32 v[192:193], v[192:193], v[208:209]
v_pk_mul_f32 v[194:195], v[194:195], v[210:211]
v_pk_mul_f32 v[196:197], v[196:197], v[212:213]
v_pk_mul_f32 v[198:199], v[198:199], v[214:215]
v_cvt_pk_bf16_f32 v208, v192, v193
v_cvt_pk_bf16_f32 v209, v194, v195
v_cvt_pk_bf16_f32 v212, v196, v197
v_cvt_pk_bf16_f32 v213, v198, v199
v_exp_f32 v200, -v200
v_exp_f32 v201, -v201
v_exp_f32 v202, -v202
v_exp_f32 v203, -v203
v_exp_f32 v204, -v204
v_exp_f32 v205, -v205
v_exp_f32 v206, -v206
v_exp_f32 v207, -v207
v_pk_add_f32 v[200:201], v[200:201], s[4:5]
v_pk_add_f32 v[202:203], v[202:203], s[4:5]
v_pk_add_f32 v[204:205], v[204:205], s[4:5]
v_pk_add_f32 v[206:207], v[206:207], s[4:5]
v_rcp_f32 v200, v200
v_rcp_f32 v201, v201
v_rcp_f32 v202, v202
v_rcp_f32 v203, v203
v_rcp_f32 v204, v204
v_rcp_f32 v205, v205
v_rcp_f32 v206, v206
v_rcp_f32 v207, v207
v_pk_mul_f32 v[200:201], v[200:201], v[216:217]
v_pk_mul_f32 v[202:203], v[202:203], v[218:219]
v_pk_mul_f32 v[204:205], v[204:205], v[220:221]
v_pk_mul_f32 v[206:207], v[206:207], v[222:223]
v_cvt_pk_bf16_f32 v216, v200, v201
v_cvt_pk_bf16_f32 v217, v202, v203
v_cvt_pk_bf16_f32 v220, v204, v205
v_cvt_pk_bf16_f32 v221, v206, v207
ds_write_b64 v19, v[208:209] offset:1024
ds_write_b64 v19, v[212:213] offset:10240
ds_write_b64 v19, v[216:217] offset:19456
ds_write_b64 v19, v[220:221] offset:28672
v_exp_f32 v224, -v224
v_exp_f32 v225, -v225
v_exp_f32 v226, -v226
v_exp_f32 v227, -v227
v_exp_f32 v228, -v228
v_exp_f32 v229, -v229
v_exp_f32 v230, -v230
v_exp_f32 v231, -v231
v_pk_add_f32 v[224:225], v[224:225], s[4:5]
v_pk_add_f32 v[226:227], v[226:227], s[4:5]
v_pk_add_f32 v[228:229], v[228:229], s[4:5]
v_pk_add_f32 v[230:231], v[230:231], s[4:5]
v_rcp_f32 v224, v224
v_rcp_f32 v225, v225
v_rcp_f32 v226, v226
v_rcp_f32 v227, v227
v_rcp_f32 v228, v228
v_rcp_f32 v229, v229
v_rcp_f32 v230, v230
v_rcp_f32 v231, v231
v_pk_mul_f32 v[224:225], v[224:225], v[240:241]
v_pk_mul_f32 v[226:227], v[226:227], v[242:243]
v_pk_mul_f32 v[228:229], v[228:229], v[244:245]
v_pk_mul_f32 v[230:231], v[230:231], v[246:247]
v_cvt_pk_bf16_f32 v240, v224, v225
v_cvt_pk_bf16_f32 v241, v226, v227
v_cvt_pk_bf16_f32 v244, v228, v229
v_cvt_pk_bf16_f32 v245, v230, v231
v_exp_f32 v232, -v232
v_exp_f32 v233, -v233
v_exp_f32 v234, -v234
v_exp_f32 v235, -v235
v_exp_f32 v236, -v236
v_exp_f32 v237, -v237
v_exp_f32 v238, -v238
v_exp_f32 v239, -v239
v_pk_add_f32 v[232:233], v[232:233], s[4:5]
v_pk_add_f32 v[234:235], v[234:235], s[4:5]
v_pk_add_f32 v[236:237], v[236:237], s[4:5]
v_pk_add_f32 v[238:239], v[238:239], s[4:5]
v_rcp_f32 v232, v232
v_rcp_f32 v233, v233
v_rcp_f32 v234, v234
v_rcp_f32 v235, v235
v_rcp_f32 v236, v236
v_rcp_f32 v237, v237
v_rcp_f32 v238, v238
v_rcp_f32 v239, v239
v_pk_mul_f32 v[232:233], v[232:233], v[248:249]
v_pk_mul_f32 v[234:235], v[234:235], v[250:251]
v_pk_mul_f32 v[236:237], v[236:237], v[252:253]
v_pk_mul_f32 v[238:239], v[238:239], v[254:255]
v_cvt_pk_bf16_f32 v248, v232, v233
v_cvt_pk_bf16_f32 v249, v234, v235
v_cvt_pk_bf16_f32 v252, v236, v237
v_cvt_pk_bf16_f32 v253, v238, v239
ds_write_b64 v25, v[240:241] offset:1024
ds_write_b64 v25, v[244:245] offset:10240
ds_write_b64 v25, v[248:249] offset:19456
ds_write_b64 v25, v[252:253] offset:28672
v_and_b32 v5, 1, v0
v_lshlrev_b32 v5, 4, v5
s_movk_i32 s3, 0x3f80
v_lshlrev_b32 v5, v5, s3
v_bfe_u32 v6, v0, 1, 3
v_cmp_eq_u32 vcc, 0, v6
s_nop 1
v_cndmask_b32 v12, 0, v5, vcc
v_cmp_eq_u32 vcc, 1, v6
s_nop 1
v_cndmask_b32 v13, 0, v5, vcc
v_cmp_eq_u32 vcc, 2, v6
s_nop 1
v_cndmask_b32 v14, 0, v5, vcc
v_cmp_eq_u32 vcc, 3, v6
s_nop 1
v_cndmask_b32 v15, 0, v5, vcc
v_mov_b32 v5, 1
v_mov_b32 v16, 0x10001
s_waitcnt lgkmcnt(0)
s_waitcnt vmcnt(6)
s_barrier
ds_read_b64_tr_b16 v[28:29], v20 offset:0
ds_read_b64_tr_b16 v[30:31], v20 offset:2048
ds_read_b64_tr_b16 v[32:33], v20 offset:4096
ds_read_b64_tr_b16 v[34:35], v20 offset:6144
ds_read_b64_tr_b16 v[36:37], v20 offset:8192
ds_read_b64_tr_b16 v[38:39], v20 offset:10240
ds_read_b128 v[112:115], v24 offset:0
ds_read_b128 v[116:119], v24 offset:9216
ds_read_b128 v[120:123], v24 offset:18432
ds_read_b128 v[124:127], v24 offset:27648
ds_read_b128 v[128:131], v24 offset:1024
ds_read_b128 v[132:135], v24 offset:10240
ds_read_b128 v[136:139], v24 offset:19456
ds_read_b128 v[140:143], v24 offset:28672
ds_read_b128 v[144:147], v24 offset:2048
ds_read_b128 v[148:151], v24 offset:11264
ds_read_b128 v[152:155], v24 offset:20480
ds_read_b128 v[156:159], v24 offset:29696
s_waitcnt lgkmcnt(11)
v_mfma_f32_16x16x32_bf16 v[80:83], v[28:31], v[112:115], 0
ds_read_b64_tr_b16 v[40:41], v20 offset:12288
s_waitcnt lgkmcnt(8)
v_mfma_f32_16x16x32_bf16 v[80:83], v[32:35], v[128:131], v[80:83]
ds_read_b64_tr_b16 v[42:43], v20 offset:14336
ds_read_b64_tr_b16 v[44:45], v20 offset:16384
s_waitcnt lgkmcnt(6)
v_mfma_f32_16x16x32_bf16 v[80:83], v[36:39], v[144:147], v[80:83]
ds_read_b64_tr_b16 v[46:47], v20 offset:18432
v_mfma_f32_16x16x32_bf16 v[84:87], v[28:31], v[116:119], 0
ds_read_b64_tr_b16 v[48:49], v20 offset:20480
ds_read_b64_tr_b16 v[50:51], v20 offset:22528
v_mfma_f32_16x16x32_bf16 v[84:87], v[32:35], v[132:135], v[84:87]
ds_read_b128 v[160:163], v24 offset:3072
s_waitcnt lgkmcnt(9)
v_mfma_f32_16x16x32_bf16 v[84:87], v[36:39], v[148:151], v[84:87]
ds_read_b128 v[164:167], v24 offset:12288
ds_read_b128 v[168:171], v24 offset:21504
v_mfma_f32_16x16x32_bf16 v[88:91], v[28:31], v[120:123], 0
ds_read_b128 v[172:175], v24 offset:30720
v_mfma_f32_16x16x32_bf16 v[88:91], v[32:35], v[136:139], v[88:91]
ds_read_b128 v[176:179], v24 offset:4096
ds_read_b128 v[180:183], v24 offset:13312
s_waitcnt lgkmcnt(13)
v_mfma_f32_16x16x32_bf16 v[88:91], v[36:39], v[152:155], v[88:91]
ds_read_b128 v[184:187], v24 offset:22528
v_mfma_f32_16x16x32_bf16 v[92:95], v[28:31], v[124:127], 0
ds_read_b128 v[188:191], v24 offset:31744
ds_read_b128 v[192:195], v24 offset:5120
v_mfma_f32_16x16x32_bf16 v[92:95], v[32:35], v[140:143], v[92:95]
ds_read_b128 v[196:199], v24 offset:14336
s_waitcnt lgkmcnt(15)
v_mfma_f32_16x16x32_bf16 v[92:95], v[36:39], v[156:159], v[92:95]
ds_read_b128 v[200:203], v24 offset:23552
ds_read_b128 v[204:207], v24 offset:32768
s_waitcnt lgkmcnt(11)
v_mfma_f32_16x16x32_bf16 v[80:83], v[40:43], v[160:163], v[80:83]
ds_read_b64_tr_b16 v[52:53], v20 offset:24576
s_waitcnt lgkmcnt(8)
v_mfma_f32_16x16x32_bf16 v[80:83], v[44:47], v[176:179], v[80:83]
ds_read_b64_tr_b16 v[54:55], v20 offset:26624
ds_read_b64_tr_b16 v[56:57], v20 offset:28672
s_waitcnt lgkmcnt(6)
v_mfma_f32_16x16x32_bf16 v[80:83], v[48:51], v[192:195], v[80:83]
ds_read_b64_tr_b16 v[58:59], v20 offset:30720
v_mfma_f32_16x16x32_bf16 v[84:87], v[40:43], v[164:167], v[84:87]
ds_read_b64_tr_b16 v[60:61], v20 offset:32768
ds_read_b64_tr_b16 v[62:63], v20 offset:34816
v_mfma_f32_16x16x32_bf16 v[84:87], v[44:47], v[180:183], v[84:87]
ds_read_b128 v[208:211], v24 offset:6144
s_waitcnt lgkmcnt(9)
v_mfma_f32_16x16x32_bf16 v[84:87], v[48:51], v[196:199], v[84:87]
ds_read_b128 v[212:215], v24 offset:15360
ds_read_b128 v[216:219], v24 offset:24576
v_mfma_f32_16x16x32_bf16 v[88:91], v[40:43], v[168:171], v[88:91]
ds_read_b128 v[220:223], v24 offset:33792
v_mfma_f32_16x16x32_bf16 v[88:91], v[44:47], v[184:187], v[88:91]
ds_read_b128 v[224:227], v24 offset:7168
ds_read_b128 v[228:231], v24 offset:16384
s_waitcnt lgkmcnt(13)
v_mfma_f32_16x16x32_bf16 v[88:91], v[48:51], v[200:203], v[88:91]
ds_read_b128 v[232:235], v24 offset:25600
v_mfma_f32_16x16x32_bf16 v[92:95], v[40:43], v[172:175], v[92:95]
ds_read_b128 v[236:239], v24 offset:34816
ds_read_b128 v[240:243], v24 offset:8192
v_mfma_f32_16x16x32_bf16 v[92:95], v[44:47], v[188:191], v[92:95]
ds_read_b128 v[244:247], v24 offset:17408
s_waitcnt lgkmcnt(15)
v_mfma_f32_16x16x32_bf16 v[92:95], v[48:51], v[204:207], v[92:95]
ds_read_b128 v[248:251], v24 offset:26624
ds_read_b128 v[252:255], v24 offset:35840
s_waitcnt lgkmcnt(0)
s_waitcnt vmcnt(1)
s_barrier
ds_read_b64_tr_b16 v[28:29], v21 offset:0
ds_read_b64_tr_b16 v[30:31], v21 offset:2048
ds_read_b64_tr_b16 v[32:33], v21 offset:4096
ds_read_b64_tr_b16 v[34:35], v21 offset:6144
ds_read_b64_tr_b16 v[36:37], v21 offset:8192
ds_read_b64_tr_b16 v[38:39], v21 offset:10240
v_mfma_f32_16x16x32_bf16 v[80:83], v[52:55], v[208:211], v[80:83]
s_add_u32 m0, s87, 90112
s_add_u32 s94, s86, 256
v_mfma_f32_16x16x32_bf16 v[80:83], v[56:59], v[224:227], v[80:83]
buffer_load_dwordx4 v17, s[16:19], s94 offen  lds
v_mfma_f32_16x16x32_bf16 v[80:83], v[60:63], v[240:243], v[80:83]
s_add_u32 m0, s87, 91136
s_add_u32 s94, s86, 9472
v_mfma_f32_16x16x32_bf16 v[84:87], v[52:55], v[212:215], v[84:87]
buffer_load_dwordx4 v17, s[16:19], s94 offen  lds
v_mfma_f32_16x16x32_bf16 v[84:87], v[56:59], v[228:231], v[84:87]
s_add_u32 m0, s87, 92160
s_add_u32 s94, s86, 18688
v_mfma_f32_16x16x32_bf16 v[84:87], v[60:63], v[244:247], v[84:87]
buffer_load_dwordx4 v17, s[16:19], s94 offen  lds
v_mfma_f32_16x16x32_bf16 v[88:91], v[52:55], v[216:219], v[88:91]
s_add_u32 m0, s87, 93184
s_add_u32 s94, s86, 27904
v_mfma_f32_16x16x32_bf16 v[88:91], v[56:59], v[232:235], v[88:91]
buffer_load_dwordx4 v17, s[16:19], s94 offen  lds
v_mfma_f32_16x16x32_bf16 v[88:91], v[60:63], v[248:251], v[88:91]
s_add_u32 m0, s87, 94208
s_add_u32 s94, s86, 37120
v_mfma_f32_16x16x32_bf16 v[92:95], v[52:55], v[220:223], v[92:95]
buffer_load_dwordx4 v17, s[16:19], s94 offen  lds
v_mfma_f32_16x16x32_bf16 v[92:95], v[56:59], v[236:239], v[92:95]
s_add_u32 m0, s87, 126976
s_add_u32 s94, s86, 384
v_mfma_f32_16x16x32_bf16 v[92:95], v[60:63], v[252:255], v[92:95]
buffer_load_dwordx4 v17, s[16:19], s94 offen  lds
s_add_u32 m0, s87, 128000
s_add_u32 s94, s86, 9600
buffer_load_dwordx4 v17, s[16:19], s94 offen  lds
s_add_u32 m0, s87, 129024
s_add_u32 s94, s86, 18816
buffer_load_dwordx4 v17, s[16:19], s94 offen  lds
s_add_u32 m0, s87, 130048
s_add_u32 s94, s86, 28032
buffer_load_dwordx4 v17, s[16:19], s94 offen  lds
s_add_u32 m0, s87, 131072
s_add_u32 s94, s86, 37248
buffer_load_dwordx4 v17, s[16:19], s94 offen  lds
s_waitcnt lgkmcnt(4)
v_mfma_f32_16x16x32_bf16 v[96:99], v[28:31], v[112:115], 0
ds_read_b64_tr_b16 v[40:41], v21 offset:12288
s_waitcnt lgkmcnt(3)
v_mfma_f32_16x16x32_bf16 v[96:99], v[32:35], v[128:131], v[96:99]
ds_read_b64_tr_b16 v[42:43], v21 offset:14336
s_waitcnt lgkmcnt(2)
v_mfma_f32_16x16x32_bf16 v[96:99], v[36:39], v[144:147], v[96:99]
ds_read_b64_tr_b16 v[44:45], v21 offset:16384
ds_read_b64_tr_b16 v[46:47], v21 offset:18432
v_mfma_f32_16x16x32_bf16 v[100:103], v[28:31], v[116:119], 0
ds_read_b64_tr_b16 v[48:49], v21 offset:20480
v_mfma_f32_16x16x32_bf16 v[100:103], v[32:35], v[132:135], v[100:103]
ds_read_b64_tr_b16 v[50:51], v21 offset:22528
v_cvt_pk_bf16_f32 v80, v80, v81
v_mfma_f32_16x16x32_bf16 v[100:103], v[36:39], v[148:151], v[100:103]
v_cvt_pk_bf16_f32 v81, v82, v83
v_mfma_f32_16x16x32_bf16 v[104:107], v[28:31], v[120:123], 0
v_cvt_pk_bf16_f32 v82, v84, v85
v_mfma_f32_16x16x32_bf16 v[104:107], v[32:35], v[136:139], v[104:107]
v_cvt_pk_bf16_f32 v83, v86, v87
s_add_u32 s3, s88, 0
buffer_store_dwordx4 v[80:83], v18, s[24:27], s3 offen offset:0 sc1
v_mfma_f32_16x16x32_bf16 v[104:107], v[36:39], v[152:155], v[104:107]
v_cvt_pk_bf16_f32 v88, v88, v89
v_mfma_f32_16x16x32_bf16 v[108:111], v[28:31], v[124:127], 0
v_cvt_pk_bf16_f32 v89, v90, v91
v_cvt_pk_bf16_f32 v90, v92, v93
v_mfma_f32_16x16x32_bf16 v[108:111], v[32:35], v[140:143], v[108:111]
v_cvt_pk_bf16_f32 v91, v94, v95
v_mfma_f32_16x16x32_bf16 v[108:111], v[36:39], v[156:159], v[108:111]
s_add_u32 s3, s88, 0
buffer_store_dwordx4 v[88:91], v18, s[24:27], s3 offen offset:128 sc1
s_mov_b64 exec, s[48:49]
ds_write_b128 v10, v[80:83] offset:0
ds_write_b128 v10, v[88:91] offset:128
s_mov_b64 exec, -1
s_waitcnt lgkmcnt(6)
v_mfma_f32_16x16x32_bf16 v[96:99], v[40:43], v[160:163], v[96:99]
ds_read_b64_tr_b16 v[52:53], v21 offset:24576
s_waitcnt lgkmcnt(5)
v_mfma_f32_16x16x32_bf16 v[96:99], v[44:47], v[176:179], v[96:99]
ds_read_b64_tr_b16 v[54:55], v21 offset:26624
s_waitcnt lgkmcnt(4)
v_mfma_f32_16x16x32_bf16 v[96:99], v[48:51], v[192:195], v[96:99]
ds_read_b64_tr_b16 v[56:57], v21 offset:28672
v_mfma_f32_16x16x32_bf16 v[100:103], v[40:43], v[164:167], v[100:103]
ds_read_b64_tr_b16 v[58:59], v21 offset:30720
v_mfma_f32_16x16x32_bf16 v[100:103], v[44:47], v[180:183], v[100:103]
ds_read_b64_tr_b16 v[60:61], v21 offset:32768
v_mfma_f32_16x16x32_bf16 v[100:103], v[48:51], v[196:199], v[100:103]
ds_read_b64_tr_b16 v[62:63], v21 offset:34816
v_mfma_f32_16x16x32_bf16 v[104:107], v[40:43], v[168:171], v[104:107]
v_mfma_f32_16x16x32_bf16 v[104:107], v[44:47], v[184:187], v[104:107]
v_mfma_f32_16x16x32_bf16 v[104:107], v[48:51], v[200:203], v[104:107]
v_mfma_f32_16x16x32_bf16 v[108:111], v[40:43], v[172:175], v[108:111]
v_mfma_f32_16x16x32_bf16 v[108:111], v[44:47], v[188:191], v[108:111]
v_mfma_f32_16x16x32_bf16 v[108:111], v[48:51], v[204:207], v[108:111]
s_waitcnt lgkmcnt(0)
s_waitcnt vmcnt(7)
s_barrier
ds_read_b64_tr_b16 v[28:29], v22 offset:0
ds_read_b64_tr_b16 v[30:31], v22 offset:2048
ds_read_b64_tr_b16 v[32:33], v22 offset:4096
ds_read_b64_tr_b16 v[34:35], v22 offset:6144
ds_read_b64_tr_b16 v[36:37], v22 offset:8192
ds_read_b64_tr_b16 v[38:39], v22 offset:10240
v_mfma_f32_16x16x32_bf16 v[96:99], v[52:55], v[208:211], v[96:99]
s_add_u32 m0, s87, 0
s_add_u32 s94, s86, 512
v_mfma_f32_16x16x32_bf16 v[96:99], v[56:59], v[224:227], v[96:99]
buffer_load_dwordx4 v17, s[16:19], s94 offen  lds
v_mfma_f32_16x16x32_bf16 v[96:99], v[60:63], v[240:243], v[96:99]
s_add_u32 m0, s87, 1024
s_add_u32 s94, s86, 9728
v_mfma_f32_16x16x32_bf16 v[100:103], v[52:55], v[212:215], v[100:103]
buffer_load_dwordx4 v17, s[16:19], s94 offen  lds
v_mfma_f32_16x16x32_bf16 v[100:103], v[56:59], v[228:231], v[100:103]
s_add_u32 m0, s87, 2048
s_add_u32 s94, s86, 18944
v_mfma_f32_16x16x32_bf16 v[100:103], v[60:63], v[244:247], v[100:103]
buffer_load_dwordx4 v17, s[16:19], s94 offen  lds
v_mfma_f32_16x16x32_bf16 v[104:107], v[52:55], v[216:219], v[104:107]
s_add_u32 m0, s87, 3072
s_add_u32 s94, s86, 28160
v_mfma_f32_16x16x32_bf16 v[104:107], v[56:59], v[232:235], v[104:107]
buffer_load_dwordx4 v17, s[16:19], s94 offen  lds
v_mfma_f32_16x16x32_bf16 v[104:107], v[60:63], v[248:251], v[104:107]
s_add_u32 m0, s87, 4096
s_add_u32 s94, s86, 37376
v_mfma_f32_16x16x32_bf16 v[108:111], v[52:55], v[220:223], v[108:111]
buffer_load_dwordx4 v17, s[16:19], s94 offen  lds
v_mfma_f32_16x16x32_bf16 v[108:111], v[56:59], v[236:239], v[108:111]
v_mfma_f32_16x16x32_bf16 v[108:111], v[60:63], v[252:255], v[108:111]
s_waitcnt lgkmcnt(4)
v_mfma_f32_16x16x32_bf16 v[80:83], v[28:31], v[112:115], 0
ds_read_b64_tr_b16 v[40:41], v22 offset:12288
s_waitcnt lgkmcnt(3)
v_mfma_f32_16x16x32_bf16 v[80:83], v[32:35], v[128:131], v[80:83]
ds_read_b64_tr_b16 v[42:43], v22 offset:14336
s_waitcnt lgkmcnt(2)
v_mfma_f32_16x16x32_bf16 v[80:83], v[36:39], v[144:147], v[80:83]
ds_read_b64_tr_b16 v[44:45], v22 offset:16384
ds_read_b64_tr_b16 v[46:47], v22 offset:18432
v_mfma_f32_16x16x32_bf16 v[84:87], v[28:31], v[116:119], 0
ds_read_b64_tr_b16 v[48:49], v22 offset:20480
v_mfma_f32_16x16x32_bf16 v[84:87], v[32:35], v[132:135], v[84:87]
ds_read_b64_tr_b16 v[50:51], v22 offset:22528
v_cvt_pk_bf16_f32 v96, v96, v97
v_mfma_f32_16x16x32_bf16 v[84:87], v[36:39], v[148:151], v[84:87]
v_cvt_pk_bf16_f32 v97, v98, v99
v_mfma_f32_16x16x32_bf16 v[88:91], v[28:31], v[120:123], 0
v_cvt_pk_bf16_f32 v98, v100, v101
v_mfma_f32_16x16x32_bf16 v[88:91], v[32:35], v[136:139], v[88:91]
v_cvt_pk_bf16_f32 v99, v102, v103
s_add_u32 s3, s88, 16384
buffer_store_dwordx4 v[96:99], v18, s[24:27], s3 offen offset:0 sc1
v_mfma_f32_16x16x32_bf16 v[88:91], v[36:39], v[152:155], v[88:91]
v_cvt_pk_bf16_f32 v104, v104, v105
v_mfma_f32_16x16x32_bf16 v[92:95], v[28:31], v[124:127], 0
v_cvt_pk_bf16_f32 v105, v106, v107
v_cvt_pk_bf16_f32 v106, v108, v109
v_mfma_f32_16x16x32_bf16 v[92:95], v[32:35], v[140:143], v[92:95]
v_cvt_pk_bf16_f32 v107, v110, v111
v_mfma_f32_16x16x32_bf16 v[92:95], v[36:39], v[156:159], v[92:95]
s_add_u32 s3, s88, 16384
buffer_store_dwordx4 v[104:107], v18, s[24:27], s3 offen offset:128 sc1
s_mov_b64 exec, s[48:49]
ds_write_b128 v10, v[96:99] offset:1024
ds_write_b128 v10, v[104:107] offset:1152
s_mov_b64 exec, -1
s_waitcnt lgkmcnt(6)
v_mfma_f32_16x16x32_bf16 v[80:83], v[40:43], v[160:163], v[80:83]
ds_read_b64_tr_b16 v[52:53], v22 offset:24576
s_waitcnt lgkmcnt(5)
v_mfma_f32_16x16x32_bf16 v[80:83], v[44:47], v[176:179], v[80:83]
ds_read_b64_tr_b16 v[54:55], v22 offset:26624
s_waitcnt lgkmcnt(4)
v_mfma_f32_16x16x32_bf16 v[80:83], v[48:51], v[192:195], v[80:83]
ds_read_b64_tr_b16 v[56:57], v22 offset:28672
v_mfma_f32_16x16x32_bf16 v[84:87], v[40:43], v[164:167], v[84:87]
ds_read_b64_tr_b16 v[58:59], v22 offset:30720
v_mfma_f32_16x16x32_bf16 v[84:87], v[44:47], v[180:183], v[84:87]
ds_read_b64_tr_b16 v[60:61], v22 offset:32768
v_mfma_f32_16x16x32_bf16 v[84:87], v[48:51], v[196:199], v[84:87]
ds_read_b64_tr_b16 v[62:63], v22 offset:34816
v_mfma_f32_16x16x32_bf16 v[88:91], v[40:43], v[168:171], v[88:91]
v_mfma_f32_16x16x32_bf16 v[88:91], v[44:47], v[184:187], v[88:91]
v_mfma_f32_16x16x32_bf16 v[88:91], v[48:51], v[200:203], v[88:91]
v_mfma_f32_16x16x32_bf16 v[92:95], v[40:43], v[172:175], v[92:95]
v_mfma_f32_16x16x32_bf16 v[92:95], v[44:47], v[188:191], v[92:95]
v_mfma_f32_16x16x32_bf16 v[92:95], v[48:51], v[204:207], v[92:95]
s_waitcnt lgkmcnt(0)
s_waitcnt vmcnt(9)
s_barrier
ds_read_b64_tr_b16 v[28:29], v23 offset:0
ds_read_b64_tr_b16 v[30:31], v23 offset:2048
ds_read_b64_tr_b16 v[32:33], v23 offset:4096
ds_read_b64_tr_b16 v[34:35], v23 offset:6144
ds_read_b64_tr_b16 v[36:37], v23 offset:8192
ds_read_b64_tr_b16 v[38:39], v23 offset:10240
v_mfma_f32_16x16x32_bf16 v[80:83], v[52:55], v[208:211], v[80:83]
s_add_u32 m0, s87, 36864
s_add_u32 s94, s86, 640
v_mfma_f32_16x16x32_bf16 v[80:83], v[56:59], v[224:227], v[80:83]
buffer_load_dwordx4 v17, s[16:19], s94 offen  lds
v_mfma_f32_16x16x32_bf16 v[80:83], v[60:63], v[240:243], v[80:83]
s_add_u32 m0, s87, 37888
s_add_u32 s94, s86, 9856
v_mfma_f32_16x16x32_bf16 v[84:87], v[52:55], v[212:215], v[84:87]
buffer_load_dwordx4 v17, s[16:19], s94 offen  lds
v_mfma_f32_16x16x32_bf16 v[84:87], v[56:59], v[228:231], v[84:87]
s_add_u32 m0, s87, 38912
s_add_u32 s94, s86, 19072
v_mfma_f32_16x16x32_bf16 v[84:87], v[60:63], v[244:247], v[84:87]
buffer_load_dwordx4 v17, s[16:19], s94 offen  lds
v_mfma_f32_16x16x32_bf16 v[88:91], v[52:55], v[216:219], v[88:91]
s_add_u32 m0, s87, 39936
s_add_u32 s94, s86, 28288
v_mfma_f32_16x16x32_bf16 v[88:91], v[56:59], v[232:235], v[88:91]
buffer_load_dwordx4 v17, s[16:19], s94 offen  lds
v_mfma_f32_16x16x32_bf16 v[88:91], v[60:63], v[248:251], v[88:91]
s_add_u32 m0, s87, 40960
s_add_u32 s94, s86, 37504
v_mfma_f32_16x16x32_bf16 v[92:95], v[52:55], v[220:223], v[92:95]
buffer_load_dwordx4 v17, s[16:19], s94 offen  lds
v_mfma_f32_16x16x32_bf16 v[92:95], v[56:59], v[236:239], v[92:95]
v_mfma_f32_16x16x32_bf16 v[92:95], v[60:63], v[252:255], v[92:95]
s_waitcnt lgkmcnt(4)
v_mfma_f32_16x16x32_bf16 v[96:99], v[28:31], v[112:115], 0
ds_read_b64_tr_b16 v[40:41], v23 offset:12288
s_waitcnt lgkmcnt(3)
v_mfma_f32_16x16x32_bf16 v[96:99], v[32:35], v[128:131], v[96:99]
ds_read_b64_tr_b16 v[42:43], v23 offset:14336
s_waitcnt lgkmcnt(2)
v_mfma_f32_16x16x32_bf16 v[96:99], v[36:39], v[144:147], v[96:99]
ds_read_b64_tr_b16 v[44:45], v23 offset:16384
ds_read_b64_tr_b16 v[46:47], v23 offset:18432
v_mfma_f32_16x16x32_bf16 v[100:103], v[28:31], v[116:119], 0
ds_read_b64_tr_b16 v[48:49], v23 offset:20480
v_mfma_f32_16x16x32_bf16 v[100:103], v[32:35], v[132:135], v[100:103]
ds_read_b64_tr_b16 v[50:51], v23 offset:22528
v_cvt_pk_bf16_f32 v80, v80, v81
v_mfma_f32_16x16x32_bf16 v[100:103], v[36:39], v[148:151], v[100:103]
v_cvt_pk_bf16_f32 v81, v82, v83
v_mfma_f32_16x16x32_bf16 v[104:107], v[28:31], v[120:123], 0
v_cvt_pk_bf16_f32 v82, v84, v85
v_mfma_f32_16x16x32_bf16 v[104:107], v[32:35], v[136:139], v[104:107]
v_cvt_pk_bf16_f32 v83, v86, v87
s_add_u32 s3, s88, 32768
buffer_store_dwordx4 v[80:83], v18, s[24:27], s3 offen offset:0 sc1
v_mfma_f32_16x16x32_bf16 v[104:107], v[36:39], v[152:155], v[104:107]
v_cvt_pk_bf16_f32 v88, v88, v89
v_mfma_f32_16x16x32_bf16 v[108:111], v[28:31], v[124:127], 0
v_cvt_pk_bf16_f32 v89, v90, v91
v_cvt_pk_bf16_f32 v90, v92, v93
v_mfma_f32_16x16x32_bf16 v[108:111], v[32:35], v[140:143], v[108:111]
v_cvt_pk_bf16_f32 v91, v94, v95
v_mfma_f32_16x16x32_bf16 v[108:111], v[36:39], v[156:159], v[108:111]
s_add_u32 s3, s88, 32768
buffer_store_dwordx4 v[88:91], v18, s[24:27], s3 offen offset:128 sc1
s_mov_b64 exec, s[48:49]
ds_write_b128 v10, v[80:83] offset:2048
ds_write_b128 v10, v[88:91] offset:2176
s_mov_b64 exec, -1
s_waitcnt lgkmcnt(6)
v_mfma_f32_16x16x32_bf16 v[96:99], v[40:43], v[160:163], v[96:99]
ds_read_b64_tr_b16 v[52:53], v23 offset:24576
s_waitcnt lgkmcnt(5)
v_mfma_f32_16x16x32_bf16 v[96:99], v[44:47], v[176:179], v[96:99]
ds_read_b64_tr_b16 v[54:55], v23 offset:26624
s_waitcnt lgkmcnt(4)
v_mfma_f32_16x16x32_bf16 v[96:99], v[48:51], v[192:195], v[96:99]
ds_read_b64_tr_b16 v[56:57], v23 offset:28672
v_mfma_f32_16x16x32_bf16 v[100:103], v[40:43], v[164:167], v[100:103]
ds_read_b64_tr_b16 v[58:59], v23 offset:30720
v_mfma_f32_16x16x32_bf16 v[100:103], v[44:47], v[180:183], v[100:103]
ds_read_b64_tr_b16 v[60:61], v23 offset:32768
v_mfma_f32_16x16x32_bf16 v[100:103], v[48:51], v[196:199], v[100:103]
ds_read_b64_tr_b16 v[62:63], v23 offset:34816
v_mfma_f32_16x16x32_bf16 v[104:107], v[40:43], v[168:171], v[104:107]
v_mfma_f32_16x16x32_bf16 v[104:107], v[44:47], v[184:187], v[104:107]
v_mfma_f32_16x16x32_bf16 v[104:107], v[48:51], v[200:203], v[104:107]
v_mfma_f32_16x16x32_bf16 v[108:111], v[40:43], v[172:175], v[108:111]
v_mfma_f32_16x16x32_bf16 v[108:111], v[44:47], v[188:191], v[108:111]
v_mfma_f32_16x16x32_bf16 v[108:111], v[48:51], v[204:207], v[108:111]
s_waitcnt lgkmcnt(0)
s_waitcnt vmcnt(7)
s_barrier
ds_read_b64_tr_b16 v[28:29], v20 offset:0
ds_read_b64_tr_b16 v[30:31], v20 offset:2048
ds_read_b64_tr_b16 v[32:33], v20 offset:4096
ds_read_b64_tr_b16 v[34:35], v20 offset:6144
ds_read_b64_tr_b16 v[36:37], v20 offset:8192
ds_read_b64_tr_b16 v[38:39], v20 offset:10240
v_mfma_f32_16x16x32_bf16 v[96:99], v[52:55], v[208:211], v[96:99]
s_add_u32 m0, s87, 90112
s_add_u32 s94, s86, 768
v_mfma_f32_16x16x32_bf16 v[96:99], v[56:59], v[224:227], v[96:99]
buffer_load_dwordx4 v17, s[16:19], s94 offen  lds
v_mfma_f32_16x16x32_bf16 v[96:99], v[60:63], v[240:243], v[96:99]
s_add_u32 m0, s87, 91136
s_add_u32 s94, s86, 9984
v_mfma_f32_16x16x32_bf16 v[100:103], v[52:55], v[212:215], v[100:103]
buffer_load_dwordx4 v17, s[16:19], s94 offen  lds
v_mfma_f32_16x16x32_bf16 v[100:103], v[56:59], v[228:231], v[100:103]
s_add_u32 m0, s87, 92160
s_add_u32 s94, s86, 19200
v_mfma_f32_16x16x32_bf16 v[100:103], v[60:63], v[244:247], v[100:103]
buffer_load_dwordx4 v17, s[16:19], s94 offen  lds
v_mfma_f32_16x16x32_bf16 v[104:107], v[52:55], v[216:219], v[104:107]
s_add_u32 m0, s87, 93184
s_add_u32 s94, s86, 28416
v_mfma_f32_16x16x32_bf16 v[104:107], v[56:59], v[232:235], v[104:107]
buffer_load_dwordx4 v17, s[16:19], s94 offen  lds
v_mfma_f32_16x16x32_bf16 v[104:107], v[60:63], v[248:251], v[104:107]
s_add_u32 m0, s87, 94208
s_add_u32 s94, s86, 37632
v_mfma_f32_16x16x32_bf16 v[108:111], v[52:55], v[220:223], v[108:111]
buffer_load_dwordx4 v17, s[16:19], s94 offen  lds
v_mfma_f32_16x16x32_bf16 v[108:111], v[56:59], v[236:239], v[108:111]
v_mfma_f32_16x16x32_bf16 v[108:111], v[60:63], v[252:255], v[108:111]
s_waitcnt lgkmcnt(4)
v_mfma_f32_16x16x32_bf16 v[80:83], v[28:31], v[112:115], 0
ds_read_b64_tr_b16 v[40:41], v20 offset:12288
s_waitcnt lgkmcnt(3)
v_mfma_f32_16x16x32_bf16 v[80:83], v[32:35], v[128:131], v[80:83]
ds_read_b64_tr_b16 v[42:43], v20 offset:14336
s_waitcnt lgkmcnt(2)
v_mfma_f32_16x16x32_bf16 v[80:83], v[36:39], v[144:147], v[80:83]
ds_read_b64_tr_b16 v[44:45], v20 offset:16384
ds_read_b64_tr_b16 v[46:47], v20 offset:18432
v_mfma_f32_16x16x32_bf16 v[84:87], v[28:31], v[116:119], 0
ds_read_b64_tr_b16 v[48:49], v20 offset:20480
v_mfma_f32_16x16x32_bf16 v[84:87], v[32:35], v[132:135], v[84:87]
ds_read_b64_tr_b16 v[50:51], v20 offset:22528
v_cvt_pk_bf16_f32 v96, v96, v97
v_mfma_f32_16x16x32_bf16 v[84:87], v[36:39], v[148:151], v[84:87]
v_cvt_pk_bf16_f32 v97, v98, v99
v_mfma_f32_16x16x32_bf16 v[88:91], v[28:31], v[120:123], 0
v_cvt_pk_bf16_f32 v98, v100, v101
v_mfma_f32_16x16x32_bf16 v[88:91], v[32:35], v[136:139], v[88:91]
v_cvt_pk_bf16_f32 v99, v102, v103
s_add_u32 s3, s88, 49152
buffer_store_dwordx4 v[96:99], v18, s[24:27], s3 offen offset:0 sc1
v_mfma_f32_16x16x32_bf16 v[88:91], v[36:39], v[152:155], v[88:91]
v_cvt_pk_bf16_f32 v104, v104, v105
v_mfma_f32_16x16x32_bf16 v[92:95], v[28:31], v[124:127], 0
v_cvt_pk_bf16_f32 v105, v106, v107
v_cvt_pk_bf16_f32 v106, v108, v109
v_mfma_f32_16x16x32_bf16 v[92:95], v[32:35], v[140:143], v[92:95]
v_cvt_pk_bf16_f32 v107, v110, v111
v_mfma_f32_16x16x32_bf16 v[92:95], v[36:39], v[156:159], v[92:95]
s_add_u32 s3, s88, 49152
buffer_store_dwordx4 v[104:107], v18, s[24:27], s3 offen offset:128 sc1
s_mov_b64 exec, s[48:49]
ds_write_b128 v10, v[96:99] offset:3072
ds_write_b128 v10, v[104:107] offset:3200
s_mov_b64 exec, -1
s_waitcnt lgkmcnt(6)
v_mfma_f32_16x16x32_bf16 v[80:83], v[40:43], v[160:163], v[80:83]
ds_read_b64_tr_b16 v[52:53], v20 offset:24576
s_waitcnt lgkmcnt(5)
v_mfma_f32_16x16x32_bf16 v[80:83], v[44:47], v[176:179], v[80:83]
ds_read_b64_tr_b16 v[54:55], v20 offset:26624
s_waitcnt lgkmcnt(4)
v_mfma_f32_16x16x32_bf16 v[80:83], v[48:51], v[192:195], v[80:83]
ds_read_b64_tr_b16 v[56:57], v20 offset:28672
v_mfma_f32_16x16x32_bf16 v[84:87], v[40:43], v[164:167], v[84:87]
ds_read_b64_tr_b16 v[58:59], v20 offset:30720
v_mfma_f32_16x16x32_bf16 v[84:87], v[44:47], v[180:183], v[84:87]
ds_read_b64_tr_b16 v[60:61], v20 offset:32768
v_mfma_f32_16x16x32_bf16 v[84:87], v[48:51], v[196:199], v[84:87]
ds_read_b64_tr_b16 v[62:63], v20 offset:34816
v_mfma_f32_16x16x32_bf16 v[88:91], v[40:43], v[168:171], v[88:91]
v_mfma_f32_16x16x32_bf16 v[88:91], v[44:47], v[184:187], v[88:91]
v_mfma_f32_16x16x32_bf16 v[88:91], v[48:51], v[200:203], v[88:91]
v_mfma_f32_16x16x32_bf16 v[92:95], v[40:43], v[172:175], v[92:95]
v_mfma_f32_16x16x32_bf16 v[92:95], v[44:47], v[188:191], v[92:95]
v_mfma_f32_16x16x32_bf16 v[92:95], v[48:51], v[204:207], v[92:95]
s_waitcnt lgkmcnt(0)
s_waitcnt vmcnt(9)
s_barrier
s_mov_b32 s3, 0
buffer_load_dword v19, v8, s[28:31], s3 offen sc1
ds_read_b64_tr_b16 v[28:29], v21 offset:0
ds_read_b64_tr_b16 v[30:31], v21 offset:2048
ds_read_b64_tr_b16 v[32:33], v21 offset:4096
ds_read_b64_tr_b16 v[34:35], v21 offset:6144
ds_read_b64_tr_b16 v[36:37], v21 offset:8192
ds_read_b64_tr_b16 v[38:39], v21 offset:10240
v_mfma_f32_16x16x32_bf16 v[80:83], v[52:55], v[208:211], v[80:83]
s_add_u32 m0, s87, 126976
s_add_u32 s94, s86, 896
v_mfma_f32_16x16x32_bf16 v[80:83], v[56:59], v[224:227], v[80:83]
buffer_load_dwordx4 v17, s[16:19], s94 offen  lds
v_mfma_f32_16x16x32_bf16 v[80:83], v[60:63], v[240:243], v[80:83]
s_add_u32 m0, s87, 128000
s_add_u32 s94, s86, 10112
v_mfma_f32_16x16x32_bf16 v[84:87], v[52:55], v[212:215], v[84:87]
buffer_load_dwordx4 v17, s[16:19], s94 offen  lds
v_mfma_f32_16x16x32_bf16 v[84:87], v[56:59], v[228:231], v[84:87]
s_add_u32 m0, s87, 129024
s_add_u32 s94, s86, 19328
v_mfma_f32_16x16x32_bf16 v[84:87], v[60:63], v[244:247], v[84:87]
buffer_load_dwordx4 v17, s[16:19], s94 offen  lds
v_mfma_f32_16x16x32_bf16 v[88:91], v[52:55], v[216:219], v[88:91]
s_add_u32 m0, s87, 130048
s_add_u32 s94, s86, 28544
v_mfma_f32_16x16x32_bf16 v[88:91], v[56:59], v[232:235], v[88:91]
buffer_load_dwordx4 v17, s[16:19], s94 offen  lds
v_mfma_f32_16x16x32_bf16 v[88:91], v[60:63], v[248:251], v[88:91]
s_add_u32 m0, s87, 131072
s_add_u32 s94, s86, 37760
v_mfma_f32_16x16x32_bf16 v[92:95], v[52:55], v[220:223], v[92:95]
buffer_load_dwordx4 v17, s[16:19], s94 offen  lds
v_mfma_f32_16x16x32_bf16 v[92:95], v[56:59], v[236:239], v[92:95]
v_mfma_f32_16x16x32_bf16 v[92:95], v[60:63], v[252:255], v[92:95]
s_waitcnt lgkmcnt(4)
v_mfma_f32_16x16x32_bf16 v[96:99], v[28:31], v[112:115], 0
ds_read_b64_tr_b16 v[40:41], v21 offset:12288
s_waitcnt lgkmcnt(3)
v_mfma_f32_16x16x32_bf16 v[96:99], v[32:35], v[128:131], v[96:99]
ds_read_b64_tr_b16 v[42:43], v21 offset:14336
s_waitcnt lgkmcnt(2)
v_mfma_f32_16x16x32_bf16 v[96:99], v[36:39], v[144:147], v[96:99]
ds_read_b64_tr_b16 v[44:45], v21 offset:16384
ds_read_b64_tr_b16 v[46:47], v21 offset:18432
v_mfma_f32_16x16x32_bf16 v[100:103], v[28:31], v[116:119], 0
ds_read_b64_tr_b16 v[48:49], v21 offset:20480
v_mfma_f32_16x16x32_bf16 v[100:103], v[32:35], v[132:135], v[100:103]
ds_read_b64_tr_b16 v[50:51], v21 offset:22528
v_cvt_pk_bf16_f32 v80, v80, v81
v_mfma_f32_16x16x32_bf16 v[100:103], v[36:39], v[148:151], v[100:103]
v_cvt_pk_bf16_f32 v81, v82, v83
v_mfma_f32_16x16x32_bf16 v[104:107], v[28:31], v[120:123], 0
v_cvt_pk_bf16_f32 v82, v84, v85
v_mfma_f32_16x16x32_bf16 v[104:107], v[32:35], v[136:139], v[104:107]
v_cvt_pk_bf16_f32 v83, v86, v87
s_add_u32 s3, s88, 65536
buffer_store_dwordx4 v[80:83], v18, s[24:27], s3 offen offset:0 sc1
v_mfma_f32_16x16x32_bf16 v[104:107], v[36:39], v[152:155], v[104:107]
v_cvt_pk_bf16_f32 v88, v88, v89
v_mfma_f32_16x16x32_bf16 v[108:111], v[28:31], v[124:127], 0
v_cvt_pk_bf16_f32 v89, v90, v91
v_cvt_pk_bf16_f32 v90, v92, v93
v_mfma_f32_16x16x32_bf16 v[108:111], v[32:35], v[140:143], v[108:111]
v_cvt_pk_bf16_f32 v91, v94, v95
v_mfma_f32_16x16x32_bf16 v[108:111], v[36:39], v[156:159], v[108:111]
s_add_u32 s3, s88, 65536
buffer_store_dwordx4 v[88:91], v18, s[24:27], s3 offen offset:128 sc1
s_mov_b64 exec, s[48:49]
ds_write_b128 v10, v[80:83] offset:4096
ds_write_b128 v10, v[88:91] offset:4224
s_mov_b64 exec, -1
s_mov_b32 s3, 0
s_waitcnt vmcnt(7)
v_cmp_eq_u32 vcc, 0, v19
s_cbranch_vccnz pf_bc0_slow
pf_bc0_ok:
s_waitcnt lgkmcnt(6)
v_mfma_f32_16x16x32_bf16 v[96:99], v[40:43], v[160:163], v[96:99]
ds_read_b64_tr_b16 v[52:53], v21 offset:24576
s_waitcnt lgkmcnt(5)
v_mfma_f32_16x16x32_bf16 v[96:99], v[44:47], v[176:179], v[96:99]
ds_read_b64_tr_b16 v[54:55], v21 offset:26624
s_waitcnt lgkmcnt(4)
v_mfma_f32_16x16x32_bf16 v[96:99], v[48:51], v[192:195], v[96:99]
ds_read_b64_tr_b16 v[56:57], v21 offset:28672
v_mfma_f32_16x16x32_bf16 v[100:103], v[40:43], v[164:167], v[100:103]
ds_read_b64_tr_b16 v[58:59], v21 offset:30720
v_mfma_f32_16x16x32_bf16 v[100:103], v[44:47], v[180:183], v[100:103]
ds_read_b64_tr_b16 v[60:61], v21 offset:32768
v_mfma_f32_16x16x32_bf16 v[100:103], v[48:51], v[196:199], v[100:103]
ds_read_b64_tr_b16 v[62:63], v21 offset:34816
v_mfma_f32_16x16x32_bf16 v[104:107], v[40:43], v[168:171], v[104:107]
v_mfma_f32_16x16x32_bf16 v[104:107], v[44:47], v[184:187], v[104:107]
v_mfma_f32_16x16x32_bf16 v[104:107], v[48:51], v[200:203], v[104:107]
v_mfma_f32_16x16x32_bf16 v[108:111], v[40:43], v[172:175], v[108:111]
v_mfma_f32_16x16x32_bf16 v[108:111], v[44:47], v[188:191], v[108:111]
s_add_u32 s3, s44, 16384
s_mov_b64 exec, 0xffff
ds_read_b128 v[64:67], v11 offset:1024
s_mov_b32 exec_hi, -1
s_mov_b32 exec_lo, 0xffff0000
s_waitcnt lgkmcnt(0)
buffer_load_dwordx4 v[64:67], v2, s[24:27], s3 offen sc1
s_mov_b64 exec, -1
v_mfma_f32_16x16x32_bf16 v[108:111], v[48:51], v[204:207], v[108:111]
s_add_u32 s3, s45, 16384
buffer_load_dwordx4 v[68:71], v2, s[24:27], s3 offen sc1
s_barrier
ds_read_b64_tr_b16 v[28:29], v22 offset:0
ds_read_b64_tr_b16 v[30:31], v22 offset:2048
ds_read_b64_tr_b16 v[32:33], v22 offset:4096
ds_read_b64_tr_b16 v[34:35], v22 offset:6144
ds_read_b64_tr_b16 v[36:37], v22 offset:8192
ds_read_b64_tr_b16 v[38:39], v22 offset:10240
v_mfma_f32_16x16x32_bf16 v[96:99], v[52:55], v[208:211], v[96:99]
s_add_u32 m0, s87, 0
s_add_u32 s94, s86, 1024
v_mfma_f32_16x16x32_bf16 v[96:99], v[56:59], v[224:227], v[96:99]
buffer_load_dwordx4 v17, s[16:19], s94 offen  lds
v_mfma_f32_16x16x32_bf16 v[96:99], v[60:63], v[240:243], v[96:99]
s_add_u32 m0, s87, 1024
s_add_u32 s94, s86, 10240
v_mfma_f32_16x16x32_bf16 v[100:103], v[52:55], v[212:215], v[100:103]
buffer_load_dwordx4 v17, s[16:19], s94 offen  lds
v_mfma_f32_16x16x32_bf16 v[100:103], v[56:59], v[228:231], v[100:103]
s_add_u32 m0, s87, 2048
s_add_u32 s94, s86, 19456
v_mfma_f32_16x16x32_bf16 v[100:103], v[60:63], v[244:247], v[100:103]
buffer_load_dwordx4 v17, s[16:19], s94 offen  lds
v_mfma_f32_16x16x32_bf16 v[104:107], v[52:55], v[216:219], v[104:107]
s_add_u32 m0, s87, 3072
s_add_u32 s94, s86, 28672
v_mfma_f32_16x16x32_bf16 v[104:107], v[56:59], v[232:235], v[104:107]
buffer_load_dwordx4 v17, s[16:19], s94 offen  lds
v_mfma_f32_16x16x32_bf16 v[104:107], v[60:63], v[248:251], v[104:107]
s_add_u32 m0, s87, 4096
s_add_u32 s94, s86, 37888
v_mfma_f32_16x16x32_bf16 v[108:111], v[52:55], v[220:223], v[108:111]
buffer_load_dwordx4 v17, s[16:19], s94 offen  lds
v_mfma_f32_16x16x32_bf16 v[108:111], v[56:59], v[236:239], v[108:111]
v_mfma_f32_16x16x32_bf16 v[108:111], v[60:63], v[252:255], v[108:111]
s_waitcnt lgkmcnt(4)
v_mfma_f32_16x16x32_bf16 v[80:83], v[28:31], v[112:115], 0
ds_read_b64_tr_b16 v[40:41], v22 offset:12288
s_waitcnt lgkmcnt(3)
v_mfma_f32_16x16x32_bf16 v[80:83], v[32:35], v[128:131], v[80:83]
ds_read_b64_tr_b16 v[42:43], v22 offset:14336
s_waitcnt lgkmcnt(2)
v_mfma_f32_16x16x32_bf16 v[80:83], v[36:39], v[144:147], v[80:83]
ds_read_b64_tr_b16 v[44:45], v22 offset:16384
ds_read_b64_tr_b16 v[46:47], v22 offset:18432
v_mfma_f32_16x16x32_bf16 v[84:87], v[28:31], v[116:119], 0
ds_read_b64_tr_b16 v[48:49], v22 offset:20480
v_mfma_f32_16x16x32_bf16 v[84:87], v[32:35], v[132:135], v[84:87]
ds_read_b64_tr_b16 v[50:51], v22 offset:22528
v_cvt_pk_bf16_f32 v96, v96, v97
v_mfma_f32_16x16x32_bf16 v[84:87], v[36:39], v[148:151], v[84:87]
v_cvt_pk_bf16_f32 v97, v98, v99
v_mfma_f32_16x16x32_bf16 v[88:91], v[28:31], v[120:123], 0
v_cvt_pk_bf16_f32 v98, v100, v101
v_mfma_f32_16x16x32_bf16 v[88:91], v[32:35], v[136:139], v[88:91]
v_cvt_pk_bf16_f32 v99, v102, v103
s_add_u32 s3, s88, 81920
buffer_store_dwordx4 v[96:99], v18, s[24:27], s3 offen offset:0 sc1
v_mfma_f32_16x16x32_bf16 v[88:91], v[36:39], v[152:155], v[88:91]
v_cvt_pk_bf16_f32 v104, v104, v105
v_mfma_f32_16x16x32_bf16 v[92:95], v[28:31], v[124:127], 0
v_cvt_pk_bf16_f32 v105, v106, v107
v_cvt_pk_bf16_f32 v106, v108, v109
v_mfma_f32_16x16x32_bf16 v[92:95], v[32:35], v[140:143], v[92:95]
v_cvt_pk_bf16_f32 v107, v110, v111
v_mfma_f32_16x16x32_bf16 v[92:95], v[36:39], v[156:159], v[92:95]
s_add_u32 s3, s88, 81920
buffer_store_dwordx4 v[104:107], v18, s[24:27], s3 offen offset:128 sc1
s_mov_b64 exec, s[48:49]
ds_write_b128 v10, v[96:99] offset:5120
ds_write_b128 v10, v[104:107] offset:5248
s_mov_b64 exec, -1
s_waitcnt lgkmcnt(6)
v_mfma_f32_16x16x32_bf16 v[80:83], v[40:43], v[160:163], v[80:83]
ds_read_b64_tr_b16 v[52:53], v22 offset:24576
s_waitcnt lgkmcnt(5)
v_mfma_f32_16x16x32_bf16 v[80:83], v[44:47], v[176:179], v[80:83]
ds_read_b64_tr_b16 v[54:55], v22 offset:26624
s_waitcnt lgkmcnt(4)
v_mfma_f32_16x16x32_bf16 v[80:83], v[48:51], v[192:195], v[80:83]
ds_read_b64_tr_b16 v[56:57], v22 offset:28672
v_mfma_f32_16x16x32_bf16 v[84:87], v[40:43], v[164:167], v[84:87]
ds_read_b64_tr_b16 v[58:59], v22 offset:30720
v_mfma_f32_16x16x32_bf16 v[84:87], v[44:47], v[180:183], v[84:87]
ds_read_b64_tr_b16 v[60:61], v22 offset:32768
v_mfma_f32_16x16x32_bf16 v[84:87], v[48:51], v[196:199], v[84:87]
ds_read_b64_tr_b16 v[62:63], v22 offset:34816
v_mfma_f32_16x16x32_bf16 v[88:91], v[40:43], v[168:171], v[88:91]
v_mfma_f32_16x16x32_bf16 v[88:91], v[44:47], v[184:187], v[88:91]
v_mfma_f32_16x16x32_bf16 v[88:91], v[48:51], v[200:203], v[88:91]
v_mfma_f32_16x16x32_bf16 v[92:95], v[40:43], v[172:175], v[92:95]
v_mfma_f32_16x16x32_bf16 v[92:95], v[44:47], v[188:191], v[92:95]
v_mfma_f32_16x16x32_bf16 v[92:95], v[48:51], v[204:207], v[92:95]
s_add_u32 s3, s46, 16384
buffer_load_dwordx4 v[72:75], v2, s[24:27], s3 offen sc1
s_waitcnt lgkmcnt(0)
s_waitcnt vmcnt(10)
s_barrier
ds_read_b64_tr_b16 v[28:29], v23 offset:0
ds_read_b64_tr_b16 v[30:31], v23 offset:2048
ds_read_b64_tr_b16 v[32:33], v23 offset:4096
ds_read_b64_tr_b16 v[34:35], v23 offset:6144
ds_read_b64_tr_b16 v[36:37], v23 offset:8192
ds_read_b64_tr_b16 v[38:39], v23 offset:10240
v_mfma_f32_16x16x32_bf16 v[80:83], v[52:55], v[208:211], v[80:83]
v_mfma_f32_16x16x32_bf16 v[80:83], v[56:59], v[224:227], v[80:83]
v_mfma_f32_16x16x32_bf16 v[80:83], v[60:63], v[240:243], v[80:83]
v_mfma_f32_16x16x32_bf16 v[84:87], v[52:55], v[212:215], v[84:87]
v_mfma_f32_16x16x32_bf16 v[84:87], v[56:59], v[228:231], v[84:87]
v_mfma_f32_16x16x32_bf16 v[84:87], v[60:63], v[244:247], v[84:87]
v_mfma_f32_16x16x32_bf16 v[88:91], v[52:55], v[216:219], v[88:91]
v_mfma_f32_16x16x32_bf16 v[88:91], v[56:59], v[232:235], v[88:91]
v_mfma_f32_16x16x32_bf16 v[88:91], v[60:63], v[248:251], v[88:91]
v_mfma_f32_16x16x32_bf16 v[92:95], v[52:55], v[220:223], v[92:95]
v_mfma_f32_16x16x32_bf16 v[92:95], v[56:59], v[236:239], v[92:95]
v_mfma_f32_16x16x32_bf16 v[92:95], v[60:63], v[252:255], v[92:95]
s_waitcnt lgkmcnt(4)
v_mfma_f32_16x16x32_bf16 v[96:99], v[28:31], v[112:115], 0
ds_read_b64_tr_b16 v[40:41], v23 offset:12288
s_waitcnt lgkmcnt(3)
v_mfma_f32_16x16x32_bf16 v[96:99], v[32:35], v[128:131], v[96:99]
ds_read_b64_tr_b16 v[42:43], v23 offset:14336
s_waitcnt lgkmcnt(2)
v_mfma_f32_16x16x32_bf16 v[96:99], v[36:39], v[144:147], v[96:99]
ds_read_b64_tr_b16 v[44:45], v23 offset:16384
ds_read_b64_tr_b16 v[46:47], v23 offset:18432
v_mfma_f32_16x16x32_bf16 v[100:103], v[28:31], v[116:119], 0
ds_read_b64_tr_b16 v[48:49], v23 offset:20480
v_mfma_f32_16x16x32_bf16 v[100:103], v[32:35], v[132:135], v[100:103]
ds_read_b64_tr_b16 v[50:51], v23 offset:22528
v_cvt_pk_bf16_f32 v80, v80, v81
v_mfma_f32_16x16x32_bf16 v[100:103], v[36:39], v[148:151], v[100:103]
v_cvt_pk_bf16_f32 v81, v82, v83
v_mfma_f32_16x16x32_bf16 v[104:107], v[28:31], v[120:123], 0
v_cvt_pk_bf16_f32 v82, v84, v85
v_mfma_f32_16x16x32_bf16 v[104:107], v[32:35], v[136:139], v[104:107]
v_cvt_pk_bf16_f32 v83, v86, v87
s_add_u32 s3, s88, 98304
buffer_store_dwordx4 v[80:83], v18, s[24:27], s3 offen offset:0 sc1
v_mfma_f32_16x16x32_bf16 v[104:107], v[36:39], v[152:155], v[104:107]
v_cvt_pk_bf16_f32 v88, v88, v89
v_mfma_f32_16x16x32_bf16 v[108:111], v[28:31], v[124:127], 0
v_cvt_pk_bf16_f32 v89, v90, v91
v_cvt_pk_bf16_f32 v90, v92, v93
v_mfma_f32_16x16x32_bf16 v[108:111], v[32:35], v[140:143], v[108:111]
v_cvt_pk_bf16_f32 v91, v94, v95
v_mfma_f32_16x16x32_bf16 v[108:111], v[36:39], v[156:159], v[108:111]
s_add_u32 s3, s88, 98304
buffer_store_dwordx4 v[88:91], v18, s[24:27], s3 offen offset:128 sc1
s_mov_b64 exec, s[48:49]
ds_write_b128 v10, v[80:83] offset:6144
ds_write_b128 v10, v[88:91] offset:6272
s_mov_b64 exec, -1
s_waitcnt lgkmcnt(6)
v_mfma_f32_16x16x32_bf16 v[96:99], v[40:43], v[160:163], v[96:99]
ds_read_b64_tr_b16 v[52:53], v23 offset:24576
s_waitcnt lgkmcnt(5)
v_mfma_f32_16x16x32_bf16 v[96:99], v[44:47], v[176:179], v[96:99]
ds_read_b64_tr_b16 v[54:55], v23 offset:26624
s_waitcnt lgkmcnt(4)
v_mfma_f32_16x16x32_bf16 v[96:99], v[48:51], v[192:195], v[96:99]
ds_read_b64_tr_b16 v[56:57], v23 offset:28672
v_mfma_f32_16x16x32_bf16 v[100:103], v[40:43], v[164:167], v[100:103]
ds_read_b64_tr_b16 v[58:59], v23 offset:30720
v_mfma_f32_16x16x32_bf16 v[100:103], v[44:47], v[180:183], v[100:103]
ds_read_b64_tr_b16 v[60:61], v23 offset:32768
v_mfma_f32_16x16x32_bf16 v[100:103], v[48:51], v[196:199], v[100:103]
ds_read_b64_tr_b16 v[62:63], v23 offset:34816
v_mfma_f32_16x16x32_bf16 v[104:107], v[40:43], v[168:171], v[104:107]
v_mfma_f32_16x16x32_bf16 v[104:107], v[44:47], v[184:187], v[104:107]
v_mfma_f32_16x16x32_bf16 v[104:107], v[48:51], v[200:203], v[104:107]
v_mfma_f32_16x16x32_bf16 v[108:111], v[40:43], v[172:175], v[108:111]
v_mfma_f32_16x16x32_bf16 v[108:111], v[44:47], v[188:191], v[108:111]
v_mfma_f32_16x16x32_bf16 v[108:111], v[48:51], v[204:207], v[108:111]
s_add_u32 s3, s47, 16384
buffer_load_dwordx4 v[76:79], v2, s[24:27], s3 offen sc1
s_waitcnt lgkmcnt(0)
s_waitcnt vmcnt(6)
s_barrier
ds_read_b64_tr_b16 v[28:29], v20 offset:0
ds_read_b64_tr_b16 v[30:31], v20 offset:2048
ds_read_b64_tr_b16 v[32:33], v20 offset:4096
ds_read_b64_tr_b16 v[34:35], v20 offset:6144
ds_read_b64_tr_b16 v[36:37], v20 offset:8192
ds_read_b64_tr_b16 v[38:39], v20 offset:10240
v_mfma_f32_16x16x32_bf16 v[96:99], v[52:55], v[208:211], v[96:99]
v_mfma_f32_16x16x32_bf16 v[96:99], v[56:59], v[224:227], v[96:99]
v_mfma_f32_16x16x32_bf16 v[96:99], v[60:63], v[240:243], v[96:99]
v_mfma_f32_16x16x32_bf16 v[100:103], v[52:55], v[212:215], v[100:103]
v_mfma_f32_16x16x32_bf16 v[100:103], v[56:59], v[228:231], v[100:103]
v_mfma_f32_16x16x32_bf16 v[100:103], v[60:63], v[244:247], v[100:103]
v_mfma_f32_16x16x32_bf16 v[104:107], v[52:55], v[216:219], v[104:107]
v_mfma_f32_16x16x32_bf16 v[104:107], v[56:59], v[232:235], v[104:107]
v_mfma_f32_16x16x32_bf16 v[104:107], v[60:63], v[248:251], v[104:107]
v_mfma_f32_16x16x32_bf16 v[108:111], v[52:55], v[220:223], v[108:111]
v_mfma_f32_16x16x32_bf16 v[108:111], v[56:59], v[236:239], v[108:111]
v_mfma_f32_16x16x32_bf16 v[108:111], v[60:63], v[252:255], v[108:111]
s_waitcnt lgkmcnt(4)
v_mfma_f32_16x16x32_bf16 v[80:83], v[28:31], v[112:115], 0
ds_read_b64_tr_b16 v[40:41], v20 offset:12288
s_waitcnt lgkmcnt(3)
v_mfma_f32_16x16x32_bf16 v[80:83], v[32:35], v[128:131], v[80:83]
ds_read_b64_tr_b16 v[42:43], v20 offset:14336
s_waitcnt lgkmcnt(2)
v_mfma_f32_16x16x32_bf16 v[80:83], v[36:39], v[144:147], v[80:83]
ds_read_b64_tr_b16 v[44:45], v20 offset:16384
ds_read_b64_tr_b16 v[46:47], v20 offset:18432
v_mfma_f32_16x16x32_bf16 v[84:87], v[28:31], v[116:119], 0
ds_read_b64_tr_b16 v[48:49], v20 offset:20480
v_mfma_f32_16x16x32_bf16 v[84:87], v[32:35], v[132:135], v[84:87]
ds_read_b64_tr_b16 v[50:51], v20 offset:22528
v_cvt_pk_bf16_f32 v96, v96, v97
v_mfma_f32_16x16x32_bf16 v[84:87], v[36:39], v[148:151], v[84:87]
v_cvt_pk_bf16_f32 v97, v98, v99
v_mfma_f32_16x16x32_bf16 v[88:91], v[28:31], v[120:123], 0
v_cvt_pk_bf16_f32 v98, v100, v101
v_mfma_f32_16x16x32_bf16 v[88:91], v[32:35], v[136:139], v[88:91]
v_cvt_pk_bf16_f32 v99, v102, v103
s_add_u32 s3, s88, 114688
buffer_store_dwordx4 v[96:99], v18, s[24:27], s3 offen offset:0 sc1
v_mfma_f32_16x16x32_bf16 v[88:91], v[36:39], v[152:155], v[88:91]
v_cvt_pk_bf16_f32 v104, v104, v105
v_mfma_f32_16x16x32_bf16 v[92:95], v[28:31], v[124:127], 0
v_cvt_pk_bf16_f32 v105, v106, v107
v_cvt_pk_bf16_f32 v106, v108, v109
v_mfma_f32_16x16x32_bf16 v[92:95], v[32:35], v[140:143], v[92:95]
v_cvt_pk_bf16_f32 v107, v110, v111
v_mfma_f32_16x16x32_bf16 v[92:95], v[36:39], v[156:159], v[92:95]
s_add_u32 s3, s88, 114688
buffer_store_dwordx4 v[104:107], v18, s[24:27], s3 offen offset:128 sc1
s_mov_b64 exec, s[48:49]
ds_write_b128 v10, v[96:99] offset:7168
ds_write_b128 v10, v[104:107] offset:7296
s_mov_b64 exec, -1
s_waitcnt lgkmcnt(6)
v_mfma_f32_16x16x32_bf16 v[80:83], v[40:43], v[160:163], v[80:83]
ds_read_b64_tr_b16 v[52:53], v20 offset:24576
s_waitcnt lgkmcnt(5)
v_mfma_f32_16x16x32_bf16 v[80:83], v[44:47], v[176:179], v[80:83]
ds_read_b64_tr_b16 v[54:55], v20 offset:26624
s_waitcnt lgkmcnt(4)
v_mfma_f32_16x16x32_bf16 v[80:83], v[48:51], v[192:195], v[80:83]
ds_read_b64_tr_b16 v[56:57], v20 offset:28672
v_mfma_f32_16x16x32_bf16 v[84:87], v[40:43], v[164:167], v[84:87]
ds_read_b64_tr_b16 v[58:59], v20 offset:30720
v_mfma_f32_16x16x32_bf16 v[84:87], v[44:47], v[180:183], v[84:87]
ds_read_b64_tr_b16 v[60:61], v20 offset:32768
v_mfma_f32_16x16x32_bf16 v[84:87], v[48:51], v[196:199], v[84:87]
ds_read_b64_tr_b16 v[62:63], v20 offset:34816
v_mfma_f32_16x16x32_bf16 v[88:91], v[40:43], v[168:171], v[88:91]
v_mfma_f32_16x16x32_bf16 v[88:91], v[44:47], v[184:187], v[88:91]
v_mfma_f32_16x16x32_bf16 v[88:91], v[48:51], v[200:203], v[88:91]
v_mfma_f32_16x16x32_bf16 v[92:95], v[40:43], v[172:175], v[92:95]
v_mfma_f32_16x16x32_bf16 v[92:95], v[44:47], v[188:191], v[92:95]
v_mfma_f32_16x16x32_bf16 v[92:95], v[48:51], v[204:207], v[92:95]
s_movk_i32 s3, 2048
buffer_load_dwordx2 v[6:7], v3, s[36:39], s3 offen sc1
s_mov_b32 s3, 32768
buffer_load_dword v29, v8, s[28:31], s3 offen sc1
s_waitcnt lgkmcnt(4)
v_mfma_f32_16x16x32_bf16 v[80:83], v[52:55], v[208:211], v[80:83]
s_waitcnt lgkmcnt(2)
v_mfma_f32_16x16x32_bf16 v[80:83], v[56:59], v[224:227], v[80:83]
s_waitcnt lgkmcnt(0)
v_mfma_f32_16x16x32_bf16 v[80:83], v[60:63], v[240:243], v[80:83]
v_mfma_f32_16x16x32_bf16 v[84:87], v[52:55], v[212:215], v[84:87]
v_mfma_f32_16x16x32_bf16 v[84:87], v[56:59], v[228:231], v[84:87]
v_mfma_f32_16x16x32_bf16 v[84:87], v[60:63], v[244:247], v[84:87]
v_mfma_f32_16x16x32_bf16 v[88:91], v[52:55], v[216:219], v[88:91]
v_mfma_f32_16x16x32_bf16 v[88:91], v[56:59], v[232:235], v[88:91]
v_mfma_f32_16x16x32_bf16 v[88:91], v[60:63], v[248:251], v[88:91]
v_mfma_f32_16x16x32_bf16 v[92:95], v[52:55], v[220:223], v[92:95]
v_mfma_f32_16x16x32_bf16 v[92:95], v[56:59], v[236:239], v[92:95]
v_mfma_f32_16x16x32_bf16 v[92:95], v[60:63], v[252:255], v[92:95]
v_cvt_pk_bf16_f32 v80, v80, v81
v_cvt_pk_bf16_f32 v81, v82, v83
v_cvt_pk_bf16_f32 v82, v84, v85
v_cvt_pk_bf16_f32 v83, v86, v87
s_add_u32 s3, s88, 131072
buffer_store_dwordx4 v[80:83], v18, s[24:27], s3 offen offset:0 sc1
v_cvt_pk_bf16_f32 v88, v88, v89
v_cvt_pk_bf16_f32 v89, v90, v91
v_cvt_pk_bf16_f32 v90, v92, v93
v_cvt_pk_bf16_f32 v91, v94, v95
s_add_u32 s3, s88, 131072
buffer_store_dwordx4 v[88:91], v18, s[24:27], s3 offen offset:128 sc1
s_mov_b64 exec, s[48:49]
ds_write_b128 v10, v[80:83] offset:8192
ds_write_b128 v10, v[88:91] offset:8320
s_mov_b64 exec, -1
s_waitcnt vmcnt(4)
s_barrier
s_mov_b32 s3, 32768
s_waitcnt vmcnt(2)
v_cmp_eq_u32 vcc, 0, v29
s_cbranch_vccnz pf_bc1_slow
pf_bc1_ok:
s_add_u32 s3, s44, 49152
s_mov_b64 exec, 0xffff
ds_read_b128 v[136:139], v11 offset:3072
s_mov_b32 exec_hi, -1
s_mov_b32 exec_lo, 0xffff0000
s_waitcnt lgkmcnt(0)
buffer_load_dwordx4 v[136:139], v2, s[24:27], s3 offen sc1
s_mov_b64 exec, -1
s_add_u32 s3, s45, 49152
buffer_load_dwordx4 v[140:143], v2, s[24:27], s3 offen sc1
s_add_u32 s3, s46, 49152
buffer_load_dwordx4 v[144:147], v2, s[24:27], s3 offen sc1
s_add_u32 s3, s47, 49152
buffer_load_dwordx4 v[148:151], v2, s[24:27], s3 offen sc1
s_movk_i32 s3, 6144
buffer_load_dwordx2 v[152:153], v3, s[36:39], s3 offen sc1
s_waitcnt vmcnt(5)
s_barrier
s_mov_b32 s3, 65536
buffer_load_dword v19, v8, s[28:31], s3 offen sc1
v_mfma_f32_16x16x32_bf16 v[24:27], v[12:15], v[76:79], 0
v_mfma_f32_16x16x32_bf16 v[24:27], v[12:15], v[72:75], v[24:27]
v_mfma_f32_16x16x32_bf16 v[24:27], v[12:15], v[68:71], v[24:27]
v_mfma_f32_16x16x32_bf16 v[24:27], v[12:15], v[64:67], v[24:27]
v_lshlrev_b32 v64, 16, v6
v_and_b32 v65, 0xffff0000, v6
v_lshlrev_b32 v66, 16, v7
v_and_b32 v67, 0xffff0000, v7
s_nop 3
v_fma_f32 v64, v24, s91, v64
v_fma_f32 v65, v25, s91, v65
v_fma_f32 v66, v26, s91, v66
v_fma_f32 v67, v27, s91, v67
v_cvt_pk_bf16_f32 v6, v64, v65
v_cvt_pk_bf16_f32 v7, v66, v67
s_mov_b32 s3, 65536
s_waitcnt vmcnt(0)
v_cmp_eq_u32 vcc, 0, v19
s_cbranch_vccnz pf_bc2_slow
pf_bc2_ok:
s_add_u32 s3, s44, 81920
s_mov_b64 exec, 0xffff
ds_read_b128 v[160:163], v11 offset:5120
s_mov_b32 exec_hi, -1
s_mov_b32 exec_lo, 0xffff0000
s_waitcnt lgkmcnt(0)
buffer_load_dwordx4 v[160:163], v2, s[24:27], s3 offen sc1
s_mov_b64 exec, -1
s_add_u32 s3, s45, 81920
buffer_load_dwordx4 v[164:167], v2, s[24:27], s3 offen sc1
s_add_u32 s3, s46, 81920
buffer_load_dwordx4 v[168:171], v2, s[24:27], s3 offen sc1
s_add_u32 s3, s47, 81920
buffer_load_dwordx4 v[172:175], v2, s[24:27], s3 offen sc1
s_movk_i32 s3, 10240
buffer_load_dwordx2 v[176:177], v3, s[36:39], s3 offen sc1
s_add_u32 s3, s44, 114688
s_mov_b64 exec, 0xffff
ds_read_b128 v[184:187], v11 offset:7168
s_mov_b32 exec_hi, -1
s_mov_b32 exec_lo, 0xffff0000
s_waitcnt lgkmcnt(0)
buffer_load_dwordx4 v[184:187], v2, s[24:27], s3 offen sc1
s_mov_b64 exec, -1
s_add_u32 s3, s45, 114688
buffer_load_dwordx4 v[188:191], v2, s[24:27], s3 offen sc1
s_add_u32 s3, s46, 114688
buffer_load_dwordx4 v[192:195], v2, s[24:27], s3 offen sc1
s_add_u32 s3, s47, 114688
buffer_load_dwordx4 v[196:199], v2, s[24:27], s3 offen sc1
s_movk_i32 s3, 14336
buffer_load_dwordx2 v[200:201], v3, s[36:39], s3 offen sc1
buffer_store_dwordx2 v[6:7], v4, s[40:43], 0 offen offset:128
v_mfma_f32_16x16x32_bf16 v[156:159], v[12:15], v[148:151], 0
v_mfma_f32_16x16x32_bf16 v[156:159], v[12:15], v[144:147], v[156:159]
v_mfma_f32_16x16x32_bf16 v[156:159], v[12:15], v[140:143], v[156:159]
v_mfma_f32_16x16x32_bf16 v[156:159], v[12:15], v[136:139], v[156:159]
v_lshlrev_b32 v136, 16, v152
v_and_b32 v137, 0xffff0000, v152
v_lshlrev_b32 v138, 16, v153
v_and_b32 v139, 0xffff0000, v153
s_nop 3
v_fma_f32 v136, v156, s91, v136
v_fma_f32 v137, v157, s91, v137
v_fma_f32 v138, v158, s91, v138
v_fma_f32 v139, v159, s91, v139
v_cvt_pk_bf16_f32 v152, v136, v137
v_cvt_pk_bf16_f32 v153, v138, v139
buffer_store_dwordx2 v[152:153], v4, s[40:43], 0 offen offset:384
s_waitcnt vmcnt(8)
v_mfma_f32_16x16x32_bf16 v[180:183], v[12:15], v[172:175], 0
v_mfma_f32_16x16x32_bf16 v[180:183], v[12:15], v[168:171], v[180:183]
v_mfma_f32_16x16x32_bf16 v[180:183], v[12:15], v[164:167], v[180:183]
v_mfma_f32_16x16x32_bf16 v[180:183], v[12:15], v[160:163], v[180:183]
s_waitcnt vmcnt(7)
v_lshlrev_b32 v160, 16, v176
v_and_b32 v161, 0xffff0000, v176
v_lshlrev_b32 v162, 16, v177
v_and_b32 v163, 0xffff0000, v177
s_nop 2
v_fma_f32 v160, v180, s91, v160
v_fma_f32 v161, v181, s91, v161
v_fma_f32 v162, v182, s91, v162
v_fma_f32 v163, v183, s91, v163
v_cvt_pk_bf16_f32 v176, v160, v161
v_cvt_pk_bf16_f32 v177, v162, v163
buffer_store_dwordx2 v[176:177], v4, s[40:43], 0 offen offset:640
s_waitcnt vmcnt(4)
v_mfma_f32_16x16x32_bf16 v[204:207], v[12:15], v[196:199], 0
v_mfma_f32_16x16x32_bf16 v[204:207], v[12:15], v[192:195], v[204:207]
v_mfma_f32_16x16x32_bf16 v[204:207], v[12:15], v[188:191], v[204:207]
v_mfma_f32_16x16x32_bf16 v[204:207], v[12:15], v[184:187], v[204:207]
s_waitcnt vmcnt(3)
v_lshlrev_b32 v184, 16, v200
v_and_b32 v185, 0xffff0000, v200
v_lshlrev_b32 v186, 16, v201
v_and_b32 v187, 0xffff0000, v201
s_nop 2
v_fma_f32 v184, v204, s91, v184
v_fma_f32 v185, v205, s91, v185
v_fma_f32 v186, v206, s91, v186
v_fma_f32 v187, v207, s91, v187
v_cvt_pk_bf16_f32 v200, v184, v185
v_cvt_pk_bf16_f32 v201, v186, v187
buffer_store_dwordx2 v[200:201], v4, s[40:43], 0 offen offset:896
s_endpgm
pf_v_slow:
s_waitcnt vmcnt(0) lgkmcnt(0)
s_mov_b32 s5, 4000000
pf_v_spin:
s_sub_u32 s5, s5, 1
s_cbranch_scc1 pf_v_ok
s_add_u32 s3, s100, 0
buffer_load_dwordx4 v[48:51], v36, s[44:47], s3 offen sc1
s_add_u32 s3, s100, 81920
buffer_load_dwordx4 v[52:55], v36, s[44:47], s3 offen sc1
s_add_u32 s3, s100, 163840
buffer_load_dwordx4 v[56:59], v36, s[44:47], s3 offen sc1
s_add_u32 s3, s100, 245760
buffer_load_dwordx4 v[60:63], v36, s[44:47], s3 offen sc1
s_add_u32 s3, s100, 1310720
buffer_load_dwordx4 v[64:67], v36, s[44:47], s3 offen sc1
s_add_u32 s3, s100, 1392640
buffer_load_dwordx4 v[68:71], v36, s[44:47], s3 offen sc1
s_add_u32 s3, s100, 1474560
buffer_load_dwordx4 v[72:75], v36, s[44:47], s3 offen sc1
s_add_u32 s3, s100, 1556480
buffer_load_dwordx4 v[76:79], v36, s[44:47], s3 offen sc1
s_waitcnt vmcnt(0)
v_and_b32 v42, v48, v52
v_and_b32 v42, v42, v56
v_and_b32 v42, v42, v60
v_and_b32 v42, v42, v64
v_and_b32 v42, v42, v68
v_and_b32 v42, v42, v72
v_and_b32 v42, v42, v76
v_or_b32 v42, v42, v37
v_and_b32 v42, 1, v42
v_cmp_eq_u32 vcc, 0, v42
s_cbranch_vccnz pf_v_spin
s_branch pf_v_ok
pf_fin2:
s_waitcnt vmcnt(0)
v_lshlrev_b32 v96, 16, v192
v_and_b32 v100, s5, v192
v_lshlrev_b32 v104, 16, v193
v_and_b32 v108, s5, v193
v_lshlrev_b32 v97, 16, v194
v_and_b32 v101, s5, v194
v_lshlrev_b32 v105, 16, v195
v_and_b32 v109, s5, v195
v_lshlrev_b32 v98, 16, v196
v_and_b32 v102, s5, v196
v_lshlrev_b32 v106, 16, v197
v_and_b32 v110, s5, v197
v_lshlrev_b32 v99, 16, v198
v_and_b32 v103, s5, v198
v_lshlrev_b32 v107, 16, v199
v_and_b32 v111, s5, v199
v_lshlrev_b32 v112, 16, v200
v_and_b32 v116, s5, v200
v_lshlrev_b32 v120, 16, v201
v_and_b32 v124, s5, v201
v_lshlrev_b32 v113, 16, v202
v_and_b32 v117, s5, v202
v_lshlrev_b32 v121, 16, v203
v_and_b32 v125, s5, v203
v_lshlrev_b32 v114, 16, v204
v_and_b32 v118, s5, v204
v_lshlrev_b32 v122, 16, v205
v_and_b32 v126, s5, v205
v_lshlrev_b32 v115, 16, v206
v_and_b32 v119, s5, v206
v_lshlrev_b32 v123, 16, v207
v_and_b32 v127, s5, v207
s_waitcnt lgkmcnt(0)
s_barrier
ds_read_b128 v[48:51], v41 offset:0
ds_read_b128 v[52:55], v41 offset:5120
ds_read_b128 v[56:59], v41 offset:10240
ds_read_b128 v[60:63], v41 offset:15360
ds_read_b128 v[64:67], v41 offset:1024
ds_read_b128 v[68:71], v41 offset:6144
ds_read_b128 v[72:75], v41 offset:11264
s_waitcnt lgkmcnt(6)
v_mfma_f32_16x16x32_bf16 v[96:99], v[152:155], v[48:51], v[96:99]
v_mfma_f32_16x16x32_bf16 v[112:115], v[172:175], v[48:51], v[112:115]
ds_read_b128 v[76:79], v41 offset:16384
s_waitcnt lgkmcnt(6)
v_mfma_f32_16x16x32_bf16 v[100:103], v[152:155], v[52:55], v[100:103]
v_mfma_f32_16x16x32_bf16 v[116:119], v[172:175], v[52:55], v[116:119]
ds_read_b128 v[48:51], v41 offset:2048
s_waitcnt lgkmcnt(6)
v_mfma_f32_16x16x32_bf16 v[104:107], v[152:155], v[56:59], v[104:107]
v_mfma_f32_16x16x32_bf16 v[120:123], v[172:175], v[56:59], v[120:123]
ds_read_b128 v[52:55], v41 offset:7168
s_waitcnt lgkmcnt(6)
v_mfma_f32_16x16x32_bf16 v[108:111], v[152:155], v[60:63], v[108:111]
v_mfma_f32_16x16x32_bf16 v[124:127], v[172:175], v[60:63], v[124:127]
ds_read_b128 v[56:59], v41 offset:12288
s_waitcnt lgkmcnt(6)
v_mfma_f32_16x16x32_bf16 v[96:99], v[156:159], v[64:67], v[96:99]
v_mfma_f32_16x16x32_bf16 v[112:115], v[176:179], v[64:67], v[112:115]
ds_read_b128 v[60:63], v41 offset:17408
s_waitcnt lgkmcnt(6)
v_mfma_f32_16x16x32_bf16 v[100:103], v[156:159], v[68:71], v[100:103]
v_mfma_f32_16x16x32_bf16 v[116:119], v[176:179], v[68:71], v[116:119]
ds_read_b128 v[64:67], v41 offset:3072
s_waitcnt lgkmcnt(6)
v_mfma_f32_16x16x32_bf16 v[104:107], v[156:159], v[72:75], v[104:107]
v_mfma_f32_16x16x32_bf16 v[120:123], v[176:179], v[72:75], v[120:123]
ds_read_b128 v[68:71], v41 offset:8192
s_waitcnt lgkmcnt(6)
v_mfma_f32_16x16x32_bf16 v[108:111], v[156:159], v[76:79], v[108:111]
v_mfma_f32_16x16x32_bf16 v[124:127], v[176:179], v[76:79], v[124:127]
ds_read_b128 v[72:75], v41 offset:13312
s_waitcnt lgkmcnt(6)
v_mfma_f32_16x16x32_bf16 v[96:99], v[160:163], v[48:51], v[96:99]
v_mfma_f32_16x16x32_bf16 v[112:115], v[180:183], v[48:51], v[112:115]
ds_read_b128 v[76:79], v41 offset:18432
s_waitcnt lgkmcnt(6)
v_mfma_f32_16x16x32_bf16 v[100:103], v[160:163], v[52:55], v[100:103]
v_mfma_f32_16x16x32_bf16 v[116:119], v[180:183], v[52:55], v[116:119]
ds_read_b128 v[48:51], v41 offset:4096
s_waitcnt lgkmcnt(6)
v_mfma_f32_16x16x32_bf16 v[104:107], v[160:163], v[56:59], v[104:107]
v_mfma_f32_16x16x32_bf16 v[120:123], v[180:183], v[56:59], v[120:123]
ds_read_b128 v[52:55], v41 offset:9216
s_waitcnt lgkmcnt(6)
v_mfma_f32_16x16x32_bf16 v[108:111], v[160:163], v[60:63], v[108:111]
v_mfma_f32_16x16x32_bf16 v[124:127], v[180:183], v[60:63], v[124:127]
ds_read_b128 v[56:59], v41 offset:14336
s_waitcnt lgkmcnt(6)
v_mfma_f32_16x16x32_bf16 v[96:99], v[164:167], v[64:67], v[96:99]
v_mfma_f32_16x16x32_bf16 v[112:115], v[184:187], v[64:67], v[112:115]
ds_read_b128 v[60:63], v41 offset:19456
s_waitcnt lgkmcnt(6)
v_mfma_f32_16x16x32_bf16 v[100:103], v[164:167], v[68:71], v[100:103]
v_mfma_f32_16x16x32_bf16 v[116:119], v[184:187], v[68:71], v[116:119]
s_waitcnt lgkmcnt(5)
v_mfma_f32_16x16x32_bf16 v[104:107], v[164:167], v[72:75], v[104:107]
v_mfma_f32_16x16x32_bf16 v[120:123], v[184:187], v[72:75], v[120:123]
s_waitcnt lgkmcnt(4)
v_mfma_f32_16x16x32_bf16 v[108:111], v[164:167], v[76:79], v[108:111]
v_mfma_f32_16x16x32_bf16 v[124:127], v[184:187], v[76:79], v[124:127]
s_waitcnt lgkmcnt(3)
v_mfma_f32_16x16x32_bf16 v[96:99], v[168:171], v[48:51], v[96:99]
v_mfma_f32_16x16x32_bf16 v[112:115], v[188:191], v[48:51], v[112:115]
s_waitcnt lgkmcnt(2)
v_mfma_f32_16x16x32_bf16 v[100:103], v[168:171], v[52:55], v[100:103]
v_mfma_f32_16x16x32_bf16 v[116:119], v[188:191], v[52:55], v[116:119]
s_waitcnt lgkmcnt(1)
v_mfma_f32_16x16x32_bf16 v[104:107], v[168:171], v[56:59], v[104:107]
v_mfma_f32_16x16x32_bf16 v[120:123], v[188:191], v[56:59], v[120:123]
s_waitcnt lgkmcnt(0)
v_mfma_f32_16x16x32_bf16 v[108:111], v[168:171], v[60:63], v[108:111]
v_mfma_f32_16x16x32_bf16 v[124:127], v[188:191], v[60:63], v[124:127]
v_mov_b64 v[42:43], v[96:97]
v_pk_mul_f32 v[44:45], v[96:97], v[96:97]
v_pk_add_f32 v[42:43], v[42:43], v[98:99]
v_pk_fma_f32 v[44:45], v[98:99], v[98:99], v[44:45]
v_pk_add_f32 v[42:43], v[42:43], v[100:101]
v_pk_fma_f32 v[44:45], v[100:101], v[100:101], v[44:45]
v_pk_add_f32 v[42:43], v[42:43], v[102:103]
v_pk_fma_f32 v[44:45], v[102:103], v[102:103], v[44:45]
v_pk_add_f32 v[42:43], v[42:43], v[104:105]
v_pk_fma_f32 v[44:45], v[104:105], v[104:105], v[44:45]
v_pk_add_f32 v[42:43], v[42:43], v[106:107]
v_pk_fma_f32 v[44:45], v[106:107], v[106:107], v[44:45]
v_pk_add_f32 v[42:43], v[42:43], v[108:109]
v_pk_fma_f32 v[44:45], v[108:109], v[108:109], v[44:45]
v_pk_add_f32 v[42:43], v[42:43], v[110:111]
v_pk_fma_f32 v[44:45], v[110:111], v[110:111], v[44:45]
v_pk_add_f32 v[42:43], v[42:43], v[112:113]
v_pk_fma_f32 v[44:45], v[112:113], v[112:113], v[44:45]
v_pk_add_f32 v[42:43], v[42:43], v[114:115]
v_pk_fma_f32 v[44:45], v[114:115], v[114:115], v[44:45]
v_pk_add_f32 v[42:43], v[42:43], v[116:117]
v_pk_fma_f32 v[44:45], v[116:117], v[116:117], v[44:45]
v_pk_add_f32 v[42:43], v[42:43], v[118:119]
v_pk_fma_f32 v[44:45], v[118:119], v[118:119], v[44:45]
v_pk_add_f32 v[42:43], v[42:43], v[120:121]
v_pk_fma_f32 v[44:45], v[120:121], v[120:121], v[44:45]
v_pk_add_f32 v[42:43], v[42:43], v[122:123]
v_pk_fma_f32 v[44:45], v[122:123], v[122:123], v[44:45]
v_pk_add_f32 v[42:43], v[42:43], v[124:125]
v_pk_fma_f32 v[44:45], v[124:125], v[124:125], v[44:45]
v_pk_add_f32 v[42:43], v[42:43], v[126:127]
v_pk_fma_f32 v[44:45], v[126:127], v[126:127], v[44:45]
v_add_f32 v42, v42, v43
v_add_f32 v44, v44, v45
s_nop 1
v_permlane32_swap_b32 v42, v44
v_add_f32 v42, v42, v44
v_mov_b32 v43, v42
s_nop 1
v_permlane16_swap_b32 v42, v43
v_add_f32 v42, v42, v43
ds_write_b32 v46, v42
v_cvt_pk_bf16_f32 v192, v96, v100
v_cvt_pk_bf16_f32 v193, v104, v108
v_cvt_pk_bf16_f32 v194, v97, v101
v_cvt_pk_bf16_f32 v195, v105, v109
v_cvt_pk_bf16_f32 v196, v98, v102
v_cvt_pk_bf16_f32 v197, v106, v110
v_cvt_pk_bf16_f32 v198, v99, v103
v_cvt_pk_bf16_f32 v199, v107, v111
v_cvt_pk_bf16_f32 v200, v112, v116
v_cvt_pk_bf16_f32 v201, v120, v124
v_cvt_pk_bf16_f32 v202, v113, v117
v_cvt_pk_bf16_f32 v203, v121, v125
v_cvt_pk_bf16_f32 v204, v114, v118
v_cvt_pk_bf16_f32 v205, v122, v126
v_cvt_pk_bf16_f32 v206, v115, v119
v_cvt_pk_bf16_f32 v207, v123, v127
s_waitcnt lgkmcnt(0)
s_barrier
ds_read_b128 v[48:51], v47 offset:0
ds_read_b128 v[52:55], v47 offset:16
ds_read_b128 v[56:59], v47 offset:32
ds_read_b128 v[60:63], v47 offset:48
v_lshl_add_u32 v46, v0, 7, s101
v_mov_b32 v47, 1073741824
v_cmp_gt_u32 vcc, 16, v0
s_nop 1
v_cndmask_b32 v47, v47, v46, vcc
v_mov_b32 v46, 1
s_waitcnt lgkmcnt(3)
v_pk_add_f32 v[48:49], v[48:49], v[50:51]
s_waitcnt lgkmcnt(2)
v_pk_add_f32 v[52:53], v[52:53], v[54:55]
s_waitcnt lgkmcnt(1)
v_pk_add_f32 v[56:57], v[56:57], v[58:59]
s_waitcnt lgkmcnt(0)
v_pk_add_f32 v[60:61], v[60:61], v[62:63]
v_pk_add_f32 v[48:49], v[48:49], v[52:53]
v_pk_add_f32 v[56:57], v[56:57], v[60:61]
v_pk_add_f32 v[48:49], v[48:49], v[56:57]
v_mul_f32 v42, 0x3ae38e39, v48
v_mul_f32 v43, v42, v42
v_fmamk_f32 v44, v49, 0x3ae38e39, v43
v_fma_f32 v44, -2.0, v43, v44
v_max_f32 v44, 0, v44
v_add_f32 v44, 0x3727c5ac, v44
v_rsq_f32 v44, v44
s_nop 0
v_mul_f32 v44, 0x3fb8aa3b, v44
v_mul_f32 v42, -v42, v44
v_mov_b32 v45, v44
v_mov_b32 v43, v42
s_cmp_eq_u32 s56, 0
s_cselect_b32 s4, 0x10001, 0
v_pk_fma_f32 v[96:97], v[96:97], v[44:45], v[42:43]
v_pk_fma_f32 v[98:99], v[98:99], v[44:45], v[42:43]
v_pk_fma_f32 v[100:101], v[100:101], v[44:45], v[42:43]
v_pk_fma_f32 v[102:103], v[102:103], v[44:45], v[42:43]
v_pk_fma_f32 v[104:105], v[104:105], v[44:45], v[42:43]
v_pk_fma_f32 v[106:107], v[106:107], v[44:45], v[42:43]
v_pk_fma_f32 v[108:109], v[108:109], v[44:45], v[42:43]
v_pk_fma_f32 v[110:111], v[110:111], v[44:45], v[42:43]
v_cvt_pk_bf16_f32 v48, v96, v100
v_cvt_pk_bf16_f32 v49, v104, v108
v_cvt_pk_bf16_f32 v50, v97, v101
v_cvt_pk_bf16_f32 v51, v105, v109
buffer_store_dwordx4 v[48:51], v1, s[20:23], s50 offen offset:0 sc1
v_cvt_pk_bf16_f32 v52, v98, v102
v_cvt_pk_bf16_f32 v53, v106, v110
v_cvt_pk_bf16_f32 v54, v99, v103
v_cvt_pk_bf16_f32 v55, v107, v111
buffer_store_dwordx4 v[52:55], v1, s[20:23], s50 offen offset:1024 sc1
v_pk_fma_f32 v[112:113], v[112:113], v[44:45], v[42:43]
v_pk_fma_f32 v[114:115], v[114:115], v[44:45], v[42:43]
v_pk_fma_f32 v[116:117], v[116:117], v[44:45], v[42:43]
v_pk_fma_f32 v[118:119], v[118:119], v[44:45], v[42:43]
v_pk_fma_f32 v[120:121], v[120:121], v[44:45], v[42:43]
v_pk_fma_f32 v[122:123], v[122:123], v[44:45], v[42:43]
v_pk_fma_f32 v[124:125], v[124:125], v[44:45], v[42:43]
v_pk_fma_f32 v[126:127], v[126:127], v[44:45], v[42:43]
v_cvt_pk_bf16_f32 v56, v112, v116
v_cvt_pk_bf16_f32 v57, v120, v124
v_cvt_pk_bf16_f32 v58, v113, v117
v_cvt_pk_bf16_f32 v59, v121, v125
buffer_store_dwordx4 v[56:59], v1, s[20:23], s100 offen offset:0 sc1
v_cvt_pk_bf16_f32 v60, v114, v118
v_cvt_pk_bf16_f32 v61, v122, v126
v_cvt_pk_bf16_f32 v62, v115, v119
v_cvt_pk_bf16_f32 v63, v123, v127
buffer_store_dwordx4 v[60:63], v1, s[20:23], s100 offen offset:1024 sc1
s_branch pf_fin
pf_ax_slow:
s_waitcnt vmcnt(0) lgkmcnt(0)
s_mov_b32 s5, 4000000
pf_ax_spin:
s_sub_u32 s5, s5, 1
s_cbranch_scc1 pf_ax_ok
buffer_load_dword v27, v26, s[28:31], s93 offen sc1
s_waitcnt vmcnt(0)
v_cmp_eq_u32 vcc, 0, v27
s_cbranch_vccnz pf_ax_spin
s_branch pf_ax_ok
pf_ac0_slow:
s_waitcnt vmcnt(0) lgkmcnt(0)
s_mov_b32 s5, 4000000
pf_ac0_spin:
s_sub_u32 s5, s5, 1
s_cbranch_scc1 pf_ac0_ok
buffer_load_dword v19, v8, s[28:31], s3 offen sc1
s_waitcnt vmcnt(0)
s_mov_b32 s3, 0
v_cmp_eq_u32 vcc, 0, v19
s_cbranch_vccnz pf_ac0_spin
s_branch pf_ac0_ok
pf_ac1_slow:
s_waitcnt vmcnt(0) lgkmcnt(0)
s_mov_b32 s5, 4000000
pf_ac1_spin:
s_sub_u32 s5, s5, 1
s_cbranch_scc1 pf_ac1_ok
buffer_load_dword v29, v8, s[28:31], s3 offen sc1
s_waitcnt vmcnt(0)
s_mov_b32 s3, 32768
v_cmp_eq_u32 vcc, 0, v29
s_cbranch_vccnz pf_ac1_spin
s_branch pf_ac1_ok
pf_ac2_slow:
s_waitcnt vmcnt(0) lgkmcnt(0)
s_mov_b32 s5, 4000000
pf_ac2_spin:
s_sub_u32 s5, s5, 1
s_cbranch_scc1 pf_ac2_ok
buffer_load_dword v19, v8, s[28:31], s3 offen sc1
s_waitcnt vmcnt(0)
s_mov_b32 s3, 65536
v_cmp_eq_u32 vcc, 0, v19
s_cbranch_vccnz pf_ac2_spin
s_branch pf_ac2_ok
pf_ac3_slow:
s_waitcnt vmcnt(0) lgkmcnt(0)
s_mov_b32 s5, 4000000
pf_ac3_spin:
s_sub_u32 s5, s5, 1
s_cbranch_scc1 pf_ac3_ok
buffer_load_dword v19, v8, s[28:31], s3 offen sc1
s_waitcnt vmcnt(0)
s_mov_b32 s3, 98304
v_cmp_eq_u32 vcc, 0, v19
s_cbranch_vccnz pf_ac3_spin
s_branch pf_ac3_ok
pf_bx_slow:
s_waitcnt vmcnt(0) lgkmcnt(0)
s_mov_b32 s5, 4000000
pf_bx_spin:
s_sub_u32 s5, s5, 1
s_cbranch_scc1 pf_bx_ok
buffer_load_dword v27, v26, s[28:31], s93 offen sc1
s_waitcnt vmcnt(0)
v_cmp_eq_u32 vcc, 0, v27
s_cbranch_vccnz pf_bx_spin
s_branch pf_bx_ok
pf_bc0_slow:
s_waitcnt vmcnt(0) lgkmcnt(0)
s_mov_b32 s5, 4000000
pf_bc0_spin:
s_sub_u32 s5, s5, 1
s_cbranch_scc1 pf_bc0_ok
buffer_load_dword v19, v8, s[28:31], s3 offen sc1
s_waitcnt vmcnt(0)
s_mov_b32 s3, 0
v_cmp_eq_u32 vcc, 0, v19
s_cbranch_vccnz pf_bc0_spin
s_branch pf_bc0_ok
pf_bc1_slow:
s_waitcnt vmcnt(0) lgkmcnt(0)
s_mov_b32 s5, 4000000
pf_bc1_spin:
s_sub_u32 s5, s5, 1
s_cbranch_scc1 pf_bc1_ok
buffer_load_dword v29, v8, s[28:31], s3 offen sc1
s_waitcnt vmcnt(0)
s_mov_b32 s3, 32768
v_cmp_eq_u32 vcc, 0, v29
s_cbranch_vccnz pf_bc1_spin
s_branch pf_bc1_ok
pf_bc2_slow:
s_waitcnt vmcnt(0) lgkmcnt(0)
s_mov_b32 s5, 4000000
pf_bc2_spin:
s_sub_u32 s5, s5, 1
s_cbranch_scc1 pf_bc2_ok
buffer_load_dword v19, v8, s[28:31], s3 offen sc1
s_waitcnt vmcnt(0)
s_mov_b32 s3, 65536
v_cmp_eq_u32 vcc, 0, v19
s_cbranch_vccnz pf_bc2_spin
s_branch pf_bc2_ok
pf_end:
s_endpgm
pf_code_end:

.section .rodata,"a"
.p2align 6
.amdhsa_kernel pf_kernel
  .amdhsa_next_free_vgpr 256
  .amdhsa_next_free_sgpr 102
  .amdhsa_accum_offset 256
  .amdhsa_group_segment_fixed_size 0
  .amdhsa_kernarg_size 80
  .amdhsa_user_sgpr_count 2
  .amdhsa_user_sgpr_kernarg_segment_ptr 1
  .amdhsa_system_sgpr_workgroup_id_x 1
  .amdhsa_float_denorm_mode_32 3
.end_amdhsa_kernel
```
